```python
import torch

def _softmax(x, axis=-1):
    return torch.softmax(x, dim=axis)
def _gelu(x):
    return torch.nn.functional.gelu(x, approximate="tanh")
def _silu(x):
    return torch.nn.functional.silu(x)
def _sigmoid(x):
    return torch.sigmoid(x)
def _layernorm(x, axis=-1, eps=1e-5):
    m = x.mean(dim=axis, keepdim=True)
    v = x.var(dim=axis, keepdim=True, unbiased=False)
    return (x - m) / torch.sqrt(v + eps)
def _scatter_add(tgt, idx, src, axis=0):
    return tgt.clone().index_add_(axis, idx, src)
def _segment_sum(src, seg, n):
    out = torch.zeros((n,) + src.shape[1:], dtype=src.dtype)
    return out.index_add_(0, seg, src)
def _pad(x, pw):
    flat = tuple(v for pair in reversed(pw) for v in pair)
    return torch.nn.functional.pad(x, flat)

kernel_name = 'parallel_sum__ssm_conv_s5__geglu_ffn__prompt'

def setup_inputs():

    _w = (lambda a: (lambda t: t.to(torch.bfloat16) if t.is_floating_point() else t)(torch.as_tensor(a)))
    def _A_setup():
        B, S, D = 1, 2048, 640
        P = D
        Lambda_re = -0.5 * (lambda _x: torch.exp(torch.as_tensor(_x)))((lambda *s: torch.randn(*s, dtype=torch.bfloat16) * 0.8)(P))
        Lambda_im = (lambda *s: torch.randn(*s, dtype=torch.bfloat16) * 0.8)(P) * 1.0
        B_re = (lambda *s: torch.randn(*s, dtype=torch.bfloat16) * 0.8)(P, D) * (D ** -0.5)
        B_im = (lambda *s: torch.randn(*s, dtype=torch.bfloat16) * 0.8)(P, D) * (D ** -0.5)
        C_re = (lambda *s: torch.randn(*s, dtype=torch.bfloat16) * 0.8)(D, P) * (P ** -0.5)
        C_im = (lambda *s: torch.randn(*s, dtype=torch.bfloat16) * 0.8)(D, P) * (P ** -0.5)
        log_dt = (lambda *s: torch.randn(*s, dtype=torch.bfloat16) * 0.8)(P) * 0.3 - 2.0
        Dskip = (lambda *s: torch.randn(*s, dtype=torch.bfloat16) * 0.8)(D)
        return {
            "x": _w((lambda *s: torch.randn(*s, dtype=torch.bfloat16) * 0.05)(B, S, D)),
            "Lambda_re": _w(Lambda_re),
            "Lambda_im": _w(Lambda_im),
            "B_re": _w(B_re),
            "B_im": _w(B_im),
            "C_re": _w(C_re),
            "C_im": _w(C_im),
            "log_dt": _w(log_dt),
            "Dskip": _w(Dskip),
        }
    _A_in = _A_setup()

    def _B_setup():
        B, S, D, F = 1, 2048, 640, 1728
        return {
            "x": _w((lambda *s: torch.randn(*s, dtype=torch.bfloat16) * 0.05)(B, S, D)),
            "w_gate": _w((lambda *s: torch.randn(*s, dtype=torch.bfloat16) * 0.05)(D, F)),
            "w_up": _w((lambda *s: torch.randn(*s, dtype=torch.bfloat16) * 0.05)(D, F)),
            "w_down": _w((lambda *s: torch.randn(*s, dtype=torch.bfloat16) * 0.05)(F, D)),
        }
    _B_in = _B_setup()

    return {
        "A_x": _A_in["x"],
        "A_Lambda_re": _A_in["Lambda_re"],
        "A_Lambda_im": _A_in["Lambda_im"],
        "A_B_re": _A_in["B_re"],
        "A_B_im": _A_in["B_im"],
        "A_C_re": _A_in["C_re"],
        "A_C_im": _A_in["C_im"],
        "A_log_dt": _A_in["log_dt"],
        "A_Dskip": _A_in["Dskip"],
        "B_x": _B_in["x"],
        "B_w_gate": _B_in["w_gate"],
        "B_w_up": _B_in["w_up"],
        "B_w_down": _B_in["w_down"],
    }

def reference(A_x, A_Lambda_re, A_Lambda_im, A_B_re, A_B_im, A_C_re, A_C_im, A_log_dt, A_Dskip, B_x, B_w_gate, B_w_up, B_w_down):
    def _A_ref(x, Lambda_re, Lambda_im, B_re, B_im, C_re, C_im, log_dt, Dskip):
        Bsz, L, H = x.shape
        Lam = Lambda_re + 1j * Lambda_im
        Bmat = B_re + 1j * B_im
        Cmat = C_re + 1j * C_im
        dt = torch.exp(log_dt)
        Lam_bar = torch.exp(dt * Lam)
        B_bar = ((Lam_bar - 1.0) / Lam)[:, None] * Bmat
        Bu = torch.einsum("bld,pd->blp", x + 0j, B_bar)
        h = torch.zeros_like(Bu[:, 0, :])
        hs = []
        for t in range(L):
            h = Lam_bar[None, :] * h + Bu[:, t, :]
            hs.append(h)
        hseq = torch.stack(hs, 1)
        y = 2.0 * torch.einsum("blp,dp->bld", hseq, Cmat).real + x * Dskip[None, None, :]
        return y

    def _B_ref(x, w_gate, w_up, w_down):
        return (_gelu(x @ w_gate) * (x @ w_up)) @ w_down

    x = A_x
    xn = _layernorm(x, axis=-1)
    return x + _A_ref(xn, A_Lambda_re, A_Lambda_im, A_B_re, A_B_im, A_C_re, A_C_im, A_log_dt, A_Dskip) + _B_ref(xn, B_w_gate, B_w_up, B_w_down)
```

```asm
; @launch grid=(256,1,1) block=(512,1,1) lds=163840
.amdgcn_target "amdgcn-amd-amdhsa--gfx950"
.text
.globl parallel_sum__ssm_conv_s5__geglu_ffn__prompt_kernel
.p2align 8
.type parallel_sum__ssm_conv_s5__geglu_ffn__prompt_kernel,@function
parallel_sum__ssm_conv_s5__geglu_ffn__prompt_kernel:
    s_lshr_b32 s72, s2, 3
    s_cmp_ge_u32 s72, 32
    s_cbranch_scc1 L_end
    s_load_dwordx16 s[36:51], s[0:1], 0
    s_load_dwordx16 s[52:67], s[0:1], 64
    s_getpc_b64 s[88:89]
L_pc:
    v_cmp_gt_u32 vcc, 12, v0
    s_mul_i32 s90, s72, 12
    s_and_saveexec_b64 s[92:93], vcc
    s_cbranch_execz L_nopf
    v_add_u32 v2, s90, v0
    v_lshlrev_b32 v2, 7, v2
    v_min_u32 v2, L_code_end-L_pc-4, v2
    v_mov_b32_e64 v3, 0
    v_lshl_add_u64 v[2:3], v[2:3], 0, s[88:89]
    global_load_dword v128, v[2:3], off
L_nopf:
    s_mov_b64 exec, s[92:93]
    v_lshrrev_b32 v5, 6, v0
    v_and_b32 v1, 63, v0
    v_readfirstlane_b32 s68, v5
    s_and_b32 s71, s2, 7
    v_lshrrev_b32 v32, 3, v1
    v_and_b32 v33, 7, v1
    s_and_b32 s69, s68, 3
    s_lshr_b32 s70, s68, 2
    s_lshl_b32 s83, s68, 10
    s_and_b32 s88, s68, 1
    s_lshl_b32 s88, s88, 2
    v_lshrrev_b32 v34, 1, v32
    v_add_u32 v34, s88, v34
    v_xor_b32 v34, v33, v34
    v_lshlrev_b32 v35, 4, v34
    v_mul_u32_u24 v22, 0x500, v32
    v_add_u32 v22, v22, v35
    s_and_b32 s88, s71, 3
    s_lshr_b32 s75, s71, 2
    s_lshl1_add_u32 s75, s88, s75
    s_cmp_ge_u32 s72, 10
    s_cbranch_scc1 L_ffn
    s_lshr_b32 s88, s75, 1
    s_mul_i32 s88, s88, 10
    s_add_u32 s88, s88, s72
    s_lshr_b32 s73, s88, 3
    s_and_b32 s74, s88, 7
    s_and_b32 s88, s75, 1
    s_lshl3_add_u32 s74, s88, s74
    s_lshl_b32 s88, s69, 3
    v_add_u32_e64 v53, s88, v32
    v_bfe_u32 v54, v53, 1, 1
    v_bfe_u32 v55, v53, 3, 2
    v_lshl_add_u32 v54, v55, 1, v54
    v_and_b32_e64 v55, 1, v53
    v_lshl_add_u32 v54, v55, 3, v54
    v_bfe_u32 v55, v53, 2, 1
    v_lshl_add_u32 v54, v55, 4, v54
    v_mul_u32_u24 v20, 0x500, v54
    v_add_u32 v20, v20, v35
    s_lshl_b32 s88, s74, 7
    s_lshl_b32 s89, s70, 5
    s_add_u32 s88, s88, s89
    s_mul_i32 s81, s88, 1280
    s_add_u32 s82, s81, 81920
    s_lshl_b32 s88, s73, 7
    s_lshl_b32 s89, s69, 3
    s_add_u32 s88, s88, s89
    s_mul_i32 s76, s88, 1280
    s_add_u32 s77, s76, 40960
    s_add_u32 s78, s76, 81920
    s_add_u32 s79, s76, 122880
    s_mov_b32 s6, 819200
    s_mov_b32 s7, 0x20000
    s_mov_b32 s14, 2621440
    s_mov_b32 s15, 0x20000
    s_cmp_ge_u32 s68, 4
    s_waitcnt lgkmcnt(0)
    s_mov_b32 s12, s36
    s_mov_b32 s13, s37
    s_cselect_b32 s4, s44, s42
    s_cselect_b32 s5, s45, s43
    s_add_u32 m0, s83, 8192
    s_nop 0
    buffer_load_dwordx4 v20, s[12:15], s81 offen lds
    s_add_u32 m0, s83, 16384
    s_nop 0
    buffer_load_dwordx4 v20, s[12:15], s82 offen lds
    s_add_u32 m0, s83, 24576
    s_nop 0
    buffer_load_dwordx4 v22, s[4:7], s76 offen lds
    s_add_u32 m0, s83, 32768
    s_nop 0
    buffer_load_dwordx4 v22, s[4:7], s77 offen lds
    s_add_u32 m0, s83, 40960
    s_nop 0
    buffer_load_dwordx4 v22, s[4:7], s78 offen lds
    s_add_u32 m0, s83, 49152
    s_nop 0
    buffer_load_dwordx4 v22, s[4:7], s79 offen lds
    s_add_u32 m0, s83, 106368
    s_nop 0
    buffer_load_dwordx4 v20, s[12:15], s81 offen offset:128 lds
    s_add_u32 m0, s83, 114560
    s_nop 0
    buffer_load_dwordx4 v20, s[12:15], s82 offen offset:128 lds
    s_branch L_ssm
L_ffn:
    s_mul_i32 s96, s71, 22
    s_add_u32 s96, s96, s72
    s_sub_u32 s96, s96, 10
    s_waitcnt lgkmcnt(0)
    s_mov_b32 s12, s36
    s_mov_b32 s13, s37
    s_mov_b32 s14, 2621440
    s_mov_b32 s15, 0x20000
    s_cmp_ge_u32 s68, 6
    s_cbranch_scc1 L_eb1
    s_mul_i32 s89, s96, 6
    s_add_u32 s89, s89, s68
    s_mul_i32 s88, s89, 2560
    v_lshrrev_b32 v64, 5, v1
    v_and_b32 v65, 31, v1
    v_mul_u32_u24 v105, 0x500, v64
    v_lshl_add_u32 v104, v65, 4, v105
    v_lshl_add_u32 v105, v65, 3, v105
    buffer_load_dwordx4 v[68:71], v104, s[12:15], s88 offen
    buffer_load_dwordx4 v[72:75], v104, s[12:15], s88 offen offset:512
    buffer_load_dwordx2 v[76:77], v105, s[12:15], s88 offen offset:1024
    v_lshl_add_u32 v64, s89, 1, v64
    v_lshl_add_u32 v65, v65, 11, v64
    v_cmp_gt_u32 vcc, 0x800, v65
    v_lshlrev_b32_e64 v106, 4, v64
    v_add_u32 v106, 16171008, v106
    v_and_b32_e64 v65, 7, v64
    v_bfe_u32 v107, v64, 3, 1
    v_lshl_add_u32 v107, v65, 1, v107
    v_and_or_b32 v107, v64, -16, v107
    v_lshlrev_b32_e64 v107, 2, v107
    v_add_u32 v107, 16203776, v107
    v_mov_b32 v64, 1073741824
    v_cndmask_b32_e64 v106, v64, v106, vcc
    s_branch L_ed2
L_eb1:
    s_cmp_ge_u32 s96, 80
    s_cselect_b32 s28, s44, s42
    s_cselect_b32 s29, s45, s43
    s_cselect_b32 s88, 819200, 0
    s_mov_b32 s30, 819200
    s_mov_b32 s31, 0x20000
    s_lshl_b32 s89, s96, 1
    s_add_u32 s89, s89, s68
    s_sub_u32 s89, s89, 6
    s_mul_i32 s90, s89, 5120
    s_sub_u32 s88, s90, s88
    v_lshrrev_b32 v64, 4, v1
    v_and_b32 v65, 15, v1
    v_mul_u32_u24 v104, 0x500, v64
    v_lshl_add_u32 v104, v65, 4, v104
    buffer_load_dwordx4 v[68:71], v104, s[28:31], s88 offen offset:0
    buffer_load_dwordx4 v[72:75], v104, s[28:31], s88 offen offset:256
    buffer_load_dwordx4 v[76:79], v104, s[28:31], s88 offen offset:512
    buffer_load_dwordx4 v[80:83], v104, s[28:31], s88 offen offset:768
    buffer_load_dwordx4 v[84:87], v104, s[28:31], s88 offen offset:1024
    v_lshl_add_u32 v64, s89, 2, v64
    v_lshl_add_u32 v65, v65, 11, v64
    v_cmp_gt_u32 vcc, 0x500, v65
    v_lshlrev_b32_e64 v107, 2, v64
    v_add_u32 v107, 16211968, v107
    v_mov_b32 v64, 1073741824
    v_mov_b32 v106, v64
L_ed2:
    v_cndmask_b32 v107, v64, v107, vcc
    s_lshr_b32 s88, s75, 1
    s_mul_i32 s88, s88, 22
    s_add_u32 s88, s88, s72
    s_sub_u32 s88, s88, 10
    s_and_b32 s91, s75, 1
    s_mul_i32 s89, s88, 5042
    s_lshr_b32 s89, s89, 16
    s_mul_i32 s90, s89, 13
    s_sub_u32 s90, s88, s90
    s_sub_u32 s90, s90, 1
    s_mul_i32 s73, s90, 43
    s_lshr_b32 s73, s73, 7
    s_sub_u32 s74, s91, s73
    s_mul_i32 s74, s74, 3
    s_add_u32 s74, s74, s90
    s_lshl_b32 s91, s91, 1
    s_cmp_lt_i32 s90, 0
    s_cselect_b32 s74, 6, s74
    s_cselect_b32 s73, s91, s73
    s_lshl2_add_u32 s73, s89, s73
    s_mov_b32 s23, 0x20000
    s_cmp_ge_u32 s68, 6
    s_cselect_b32 s89, 1000, 0
    s_cmp_ge_u32 s96, 88
    s_cselect_b32 s88, 88, 88
    s_cselect_b32 s89, 440, s89
    s_mul_i32 s88, s68, s88
    s_add_u32 s88, s88, s96
    s_add_u32 s88, s88, s89
    s_cmp_eq_u32 s74, 6
    s_cselect_b32 s93, 0, 65536
    s_mul_i32 s89, s68, 4608
    s_add_u32 s93, s93, s89
    s_add_u32 s93, s93, 57344
    s_cmpk_ge_u32 s88, 540
    s_cbranch_scc1 L_jc3
    s_mov_b32 s20, s60
    s_mov_b32 s21, s61
    s_mov_b32 s22, 2211840
    s_mul_i32 s89, s88, 6554
    s_lshr_b32 s89, s89, 16
    s_mul_i32 s90, s89, 10
    s_sub_u32 s90, s88, s90
    s_mul_i32 s0, s89, 5120
    s_lshl_b32 s1, s90, 2
    s_mul_i32 s89, s89, 40960
    s_lshl_b32 s90, s90, 7
    s_add_u32 s94, s89, s90
    v_mul_u32_u24 v64, 0x500, v32
    v_lshl_add_u32 v110, v33, 4, v64
    s_mov_b32 s92, 1
    s_mov_b32 s3, 0
    s_movk_i32 s91, 10240
    s_branch L_jd4
L_jc3:
    s_sub_u32 s88, s88, 540
    s_cmpk_lt_u32 s88, 400
    s_cselect_b32 s92, 0, 1073741824
    s_cselect_b32 s88, s88, 0
    s_mov_b32 s22, 819200
    s_cmpk_ge_u32 s88, 200
    s_cselect_b32 s20, s48, s46
    s_cselect_b32 s21, s49, s47
    s_cselect_b32 s89, 200, 0
    s_cselect_b32 s90, 74, 54
    s_sub_u32 s88, s88, s89
    s_mul_i32 s1, s88, 52429
    s_lshr_b32 s1, s1, 18
    s_mul_i32 s89, s1, 5
    s_sub_u32 s89, s88, s89
    s_lshl_b32 s88, s89, 2
    s_add_u32 s90, s90, s88
    s_mul_i32 s0, s90, 5120
    s_add_u32 s0, s0, s92
    s_mul_i32 s90, s1, 20480
    s_lshl_b32 s89, s89, 8
    s_add_u32 s94, s89, s90
    v_lshrrev_b32 v64, 4, v1
    v_mul_u32_u24 v64, 0x500, v64
    v_and_b32_e64 v65, 15, v1
    v_lshl_add_u32 v110, v65, 4, v64
    s_cmp_lg_u32 s92, 0
    s_mov_b32 s92, 0
    s_movk_i32 s3, 5120
    s_movk_i32 s91, 5120
    s_cbranch_scc1 L_jn5
L_jd4:
    s_add_u32 m0, s93, 0
    s_nop 0
    buffer_load_dwordx4 v110, s[20:23], s94 offen nt lds
    s_add_u32 s94, s94, s91
    s_add_u32 m0, s93, 1088
    s_nop 0
    buffer_load_dwordx4 v110, s[20:23], s94 offen nt lds
    s_add_u32 s94, s94, s91
    s_add_u32 m0, s93, 2176
    s_nop 0
    buffer_load_dwordx4 v110, s[20:23], s94 offen nt lds
    s_add_u32 s94, s94, s91
    s_add_u32 m0, s93, 3264
    s_nop 0
    buffer_load_dwordx4 v110, s[20:23], s94 offen nt lds
L_jn5:
    s_add_u32 s0, s0, 12320768
    s_mul_i32 s88, s1, 52
    s_lshr_b32 s88, s88, 8
    s_mul_i32 s88, s88, 476160
    s_lshl_b32 s89, s1, 10
    s_add_u32 s88, s88, s89
    s_add_u32 s38, s88, s0
    s_add_u32 s1, s1, s92
    s_add_u32 s0, s0, s3
    s_mul_i32 s88, s1, 52
    s_lshr_b32 s88, s88, 8
    s_mul_i32 s88, s88, 476160
    s_lshl_b32 s89, s1, 10
    s_add_u32 s88, s88, s89
    s_add_u32 s39, s88, s0
    s_add_u32 s1, s1, s92
    s_add_u32 s0, s0, s3
    s_mul_i32 s88, s1, 52
    s_lshr_b32 s88, s88, 8
    s_mul_i32 s88, s88, 476160
    s_lshl_b32 s89, s1, 10
    s_add_u32 s88, s88, s89
    s_add_u32 s40, s88, s0
    s_add_u32 s1, s1, s92
    s_add_u32 s0, s0, s3
    s_mul_i32 s88, s1, 52
    s_lshr_b32 s88, s88, 8
    s_mul_i32 s88, s88, 476160
    s_lshl_b32 s89, s1, 10
    s_add_u32 s88, s88, s89
    s_add_u32 s41, s88, s0
    s_lshr_b32 s88, s96, 2
    s_lshl_b32 s88, s88, 4
    s_and_b32 s89, s96, 3
    s_add_u32 s88, s88, s89
    s_lshl_b32 s88, s88, 2
    s_add_u32 s95, s88, 16217088
    s_and_b32 s88, s68, 4
    v_and_b32 v44, 31, v1
    v_lshrrev_b32_e64 v45, 5, v1
    v_bfe_u32 v46, v44, 1, 3
    v_xor_b32 v45, v45, v46
    v_xor_b32 v45, s88, v45
    v_lshlrev_b32 v44, 7, v44
    v_xor_b32 v40, 0, v45
    v_lshl_add_u32 v40, v40, 4, v44
    v_xor_b32_e64 v41, 2, v45
    v_lshl_add_u32 v41, v41, 4, v44
    v_xor_b32_e64 v42, 4, v45
    v_lshl_add_u32 v42, v42, 4, v44
    v_xor_b32_e64 v43, 6, v45
    v_lshl_add_u32 v43, v43, 4, v44
    v_mov_b32 v46, 1073741824
    v_cmp_eq_u32_e64 vcc, 0, v0
    s_nop 1
    v_cndmask_b32 v2, v46, 0, vcc
    s_lshl_b32 s87, s74, 5
    s_add_u32 s87, s87, s73
    s_lshl_b32 s87, s87, 7
    s_add_u32 s87, s87, 16221184
    s_mov_b32 s16, s66
    s_mov_b32 s17, s67
    s_mov_b32 s18, 16647168
    s_mov_b32 s19, 0x20000
    s_mov_b32 s24, s64
    s_mov_b32 s25, s65
    s_mov_b32 s26, 256
    s_mov_b32 s27, 0x20000
    s_mov_b32 s32, s62
    s_mov_b32 s33, s63
    s_mov_b32 s34, 5242880
    s_mov_b32 s35, 0x20000
    v_lshlrev_b32 v4, 4, v1
    v_add_u32 v5, 0x1000, v4
    s_mov_b32 s99, 0x40000
    s_cmp_eq_u32 s68, 0
    s_cselect_b32 s88, 16217088, 1073741824
    v_lshl_add_u32 v67, v1, 6, s88
    s_mul_i32 s75, s74, 320
    s_cmp_eq_u32 s74, 6
    s_cbranch_scc1 L_f4
    s_and_b32 s69, s68, 1
    s_lshl_b32 s88, s69, 2
    v_bfe_u32 v34, v32, 1, 1
    v_xor_b32 v34, v33, v34
    v_xor_b32_e64 v34, s88, v34
    v_mul_u32_u24 v35, 0xd80, v32
    v_lshl_add_u32 v20, v34, 4, v35
    s_lshr_b32 s70, s68, 1
    s_mul_i32 s81, s68, 27648
    s_lshl_b32 s88, s73, 7
    s_add_u32 s81, s81, s88
    s_lshl_b32 s88, s68, 3
    s_add_u32 s88, s88, s75
    s_mul_i32 s76, s88, 1280
    s_add_u32 s77, s76, 81920
    s_add_u32 s78, s76, 163840
    s_add_u32 s79, s76, 245760
    s_add_u32 s80, s76, 327680
    s_mov_b32 s6, 2211840
    s_mov_b32 s7, 0x20000
    s_mov_b32 s10, 2211840
    s_mov_b32 s11, 0x20000
    s_mov_b32 s4, s56
    s_mov_b32 s5, s57
    s_mov_b32 s8, s58
    s_mov_b32 s9, s59
    v_mov_b32 v64, 0
    buffer_store_dword v64, v2, s[16:19], s95 offen sc1
    buffer_store_dword v64, v2, s[16:19], s87 offen sc1
    s_add_u32 m0, s83, 8192
    s_nop 0
    buffer_load_dwordx4 v20, s[4:7], s81 offen lds
    s_add_u32 m0, s83, 16384
    s_nop 0
    buffer_load_dwordx4 v20, s[8:11], s81 offen lds
    s_add_u32 s81, s81, 221184
    v_lshrrev_b32_e64 v32, 4, v1
    v_bfe_u32 v34, v1, 2, 2
    v_lshlrev_b32_e64 v52, 10, v32
    v_lshl_add_u32 v52, v34, 7, v52
    v_and_b32_e64 v53, 2, v1
    v_bfe_u32 v54, v1, 3, 1
    v_or_b32 v53, v53, v54
    v_and_b32 v54, 1, v32
    v_xor_b32_e64 v54, s69, v54
    v_lshl_or_b32 v53, v54, 2, v53
    v_lshl_add_u32 v52, v53, 4, v52
    v_and_b32_e64 v53, 1, v1
    v_lshl_add_u32 v52, v53, 3, v52
    s_and_b32 s91, s68, 2
    s_lshl_b32 s88, s91, 11
    s_add_u32 s89, s88, 8192
    s_sub_u32 s90, 8192, s88
    v_add_u32 v16, s89, v52
    v_add_u32 v18, s90, v52
    v_xor_b32 v17, 16, v16
    v_xor_b32_e64 v19, 16, v18
    s_lshl_b32 s91, s91, 1
    s_mul_i32 s90, s70, 10240
    s_add_u32 s90, s90, 40960
    v_and_b32 v35, 15, v1
    v_lshrrev_b32 v54, 1, v35
    v_xor_b32 v54, v54, v32
    v_xor_b32 v54, s91, v54
    v_lshl_add_u32 v53, v35, 7, s90
    v_lshl_add_u32 v8, v54, 4, v53
    v_xor_b32_e64 v9, 64, v8
    v_add_u32 v12, 81920, v8
    v_add_u32 v13, 81920, v9
    v_and_b32 v53, 3, v1
    v_cmp_eq_u32 vcc, 3, v53
    v_mov_b32 v33, 0x3f803f80
    s_nop 0
    v_cndmask_b32 v24, 0, v33, vcc
    v_mov_b32 v25, v24
    v_mov_b32 v26, v24
    v_mov_b32 v27, v24
    s_lshl_b32 s88, s69, 12
    s_lshl_b32 s89, s70, 6
    s_add_u32 s89, s89, s88
    v_lshl_add_u32 v56, v1, 2, s88
    v_lshl_add_u32 v57, v32, 10, s89
    v_lshl_add_u32 v57, v35, 2, v57
    v_lshlrev_b32 v59, 4, v35
    s_lshr_b32 s62, s71, 1
    s_lshl_b32 s62, s62, 3
    s_lshr_b32 s90, s72, 2
    s_add_u32 s62, s62, s90
    s_and_b32 s0, s71, 1
    s_lshl_b32 s0, s0, 2
    s_and_b32 s89, s72, 3
    s_add_u32 s0, s0, s89
    s_xor_b32 s62, s62, 16
    s_mul_i32 s97, s62, 94
    s_add_u32 s97, s97, s68
    s_lshl_b32 s97, s97, 12
    s_mul_i32 s98, s0, 94
    s_add_u32 s98, s98, s68
    s_mul_i32 s98, s98, 5120
    s_add_u32 s98, s98, 12320768
    s_mul_i32 s59, s62, 81920
    s_mul_i32 s60, s0, 160
    s_add_u32 s59, s59, s60
    s_lshl_b32 s61, s62, 10
    s_add_u32 s61, s61, 16171008
    s_mul_i32 s88, s62, 52
    s_lshr_b32 s88, s88, 8
    s_lshl_b32 s88, s88, 12
    s_add_u32 s88, s88, 16221184
    v_mov_b32_e64 v58, s88
    s_lshr_b32 s89, s62, 1
    s_lshl_b32 s89, s89, 12
    s_add_u32 s89, s89, 16249856
    v_mov_b32 v6, s89
    v_cmp_gt_u32 vcc, 32, v1
    s_nop 1
    v_cndmask_b32 v6, v6, v58, vcc
    v_lshl_add_u32 v6, v1, 7, v6
    s_cmp_eq_u32 s68, 0
    s_cselect_b32 vcc_lo, 0x7ffffff, 0
    s_cselect_b32 vcc_hi, 0x1f, 0
    v_mov_b32 v58, 1073741824
    v_cndmask_b32_e64 v6, v58, v6, vcc
    s_lshl1_add_u32 s0, s73, s69
    s_lshl_b32 s0, s0, 12
    s_lshl2_add_u32 s1, s74, s70
    s_mul_i32 s1, s1, 5
    s_lshl_b32 s47, s1, 8
    s_add_u32 s47, s47, 16171008
    s_lshr_b32 s88, s1, 2
    s_mul_i32 s88, s88, 380928
    s_lshl_b32 s89, s1, 10
    s_add_u32 s88, s88, s89
    s_add_u32 s54, s88, s0
    s_add_u32 s1, s1, 1
    s_lshr_b32 s88, s1, 2
    s_mul_i32 s88, s88, 380928
    s_lshl_b32 s89, s1, 10
    s_add_u32 s88, s88, s89
    s_add_u32 s55, s88, s0
    s_add_u32 s1, s1, 1
    s_lshr_b32 s88, s1, 2
    s_mul_i32 s88, s88, 380928
    s_lshl_b32 s89, s1, 10
    s_add_u32 s88, s88, s89
    s_add_u32 s56, s88, s0
    s_add_u32 s1, s1, 1
    s_lshr_b32 s88, s1, 2
    s_mul_i32 s88, s88, 380928
    s_lshl_b32 s89, s1, 10
    s_add_u32 s88, s88, s89
    s_add_u32 s57, s88, s0
    s_add_u32 s1, s1, 1
    s_lshr_b32 s88, s1, 2
    s_mul_i32 s88, s88, 380928
    s_lshl_b32 s89, s1, 10
    s_add_u32 s88, s88, s89
    s_add_u32 s58, s88, s0
    s_cmp_lg_u32 s92, 1
    s_cbranch_scc1 L_jc8
    v_lshrrev_b32_e64 v64, 5, v1
    v_mul_u32_u24 v64, 2176, v64
    v_bfe_u32 v65, v1, 2, 3
    v_lshl_add_u32 v64, v65, 7, v64
    v_and_b32_e64 v65, 3, v1
    v_lshl_add_u32 v64, v65, 3, v64
    v_add_u32 v111, s93, v64
    s_waitcnt vmcnt(4)
    ds_read_b64_tr_b16 v[112:113], v111 offset:0
    ds_read_b64_tr_b16 v[114:115], v111 offset:1088
    ds_read_b64_tr_b16 v[116:117], v111 offset:32
    ds_read_b64_tr_b16 v[118:119], v111 offset:1120
    ds_read_b64_tr_b16 v[120:121], v111 offset:64
    ds_read_b64_tr_b16 v[122:123], v111 offset:1152
    ds_read_b64_tr_b16 v[124:125], v111 offset:96
    ds_read_b64_tr_b16 v[126:127], v111 offset:1184
    s_branch L_js9
L_jc8:
    v_bfe_u32 v64, v1, 2, 2
    v_mul_u32_u24 v64, 1088, v64
    v_and_b32 v65, 3, v1
    v_lshl_add_u32 v64, v65, 8, v64
    v_and_b32_e64 v65, 48, v1
    v_add3_u32 v111, s93, v64, v65
    s_waitcnt vmcnt(4)
    ds_read_b128 v[112:115], v111 offset:0
    ds_read_b128 v[116:119], v111 offset:64
    ds_read_b128 v[120:123], v111 offset:128
    ds_read_b128 v[124:127], v111 offset:192
L_js9:
    s_cmp_ge_u32 s68, 6
    s_cbranch_scc1 L_wb6
    s_add_u32 m0, s83, 40960
    s_nop 0
    buffer_load_dwordx4 v22, s[12:15], s76 offen lds
    v_lshlrev_b32_e64 v78, 16, v68
    v_and_b32 v79, 0xffff0000, v68
    v_lshlrev_b32_e64 v80, 16, v69
    v_and_b32 v81, 0xffff0000, v69
    v_lshlrev_b32_e64 v82, 16, v70
    v_and_b32 v83, 0xffff0000, v70
    v_lshlrev_b32_e64 v84, 16, v71
    v_and_b32 v85, 0xffff0000, v71
    v_lshlrev_b32_e64 v86, 16, v72
    v_and_b32 v87, 0xffff0000, v72
    v_lshlrev_b32_e64 v88, 16, v73
    s_add_u32 m0, s83, 49152
    s_nop 0
    buffer_load_dwordx4 v22, s[12:15], s77 offen lds
    v_and_b32 v89, 0xffff0000, v73
    v_lshlrev_b32 v90, 16, v74
    v_and_b32 v91, 0xffff0000, v74
    v_lshlrev_b32_e64 v92, 16, v75
    v_and_b32 v93, 0xffff0000, v75
    v_lshlrev_b32_e64 v94, 16, v76
    v_and_b32 v95, 0xffff0000, v76
    v_lshlrev_b32_e64 v96, 16, v77
    v_and_b32 v97, 0xffff0000, v77
    v_add_f32 v98, v78, v79
    v_add_f32 v99, v80, v81
    s_add_u32 m0, s83, 57344
    s_nop 0
    buffer_load_dwordx4 v22, s[12:15], s78 offen lds
    v_add_f32 v100, v82, v83
    v_add_f32 v101, v84, v85
    v_add_f32 v98, v98, v86
    v_add_f32 v99, v99, v87
    v_add_f32 v100, v100, v88
    v_add_f32 v101, v101, v89
    v_add_f32 v98, v98, v90
    v_add_f32 v99, v99, v91
    v_add_f32 v100, v100, v92
    v_add_f32 v101, v101, v93
    v_add_f32 v98, v98, v94
    s_add_u32 m0, s83, 65536
    s_nop 0
    buffer_load_dwordx4 v22, s[12:15], s79 offen lds
    v_add_f32 v99, v99, v95
    v_add_f32 v100, v100, v96
    v_add_f32 v101, v101, v97
    v_add_f32 v98, v98, v99
    v_add_f32 v100, v100, v101
    v_add_f32 v98, v98, v100
    s_nop 1
    v_add_f32_dpp v98, v98, v98 row_ror:8 row_mask:0xf bank_mask:0xf
    s_nop 1
    v_add_f32_dpp v98, v98, v98 row_ror:4 row_mask:0xf bank_mask:0xf
    s_nop 1
    v_add_f32_dpp v98, v98, v98 row_ror:2 row_mask:0xf bank_mask:0xf
    s_nop 1
    v_add_f32_dpp v98, v98, v98 row_ror:1 row_mask:0xf bank_mask:0xf
    v_mov_b32 v102, v98
    s_add_u32 m0, s83, 73728
    s_nop 0
    buffer_load_dwordx4 v22, s[12:15], s80 offen lds
    v_permlane16_swap_b32 v98, v102
    v_add_f32_e64 v98, v98, v102
    v_mul_f32 v98, 0x3acccccd, v98
    v_sub_f32 v78, v78, v98
    v_sub_f32 v79, v79, v98
    v_sub_f32 v80, v80, v98
    v_sub_f32 v81, v81, v98
    v_sub_f32 v82, v82, v98
    v_sub_f32 v83, v83, v98
    v_sub_f32 v84, v84, v98
    v_sub_f32 v85, v85, v98
    s_add_u32 m0, s83, 24576
    s_nop 0
    buffer_load_dwordx4 v20, s[4:7], s81 offen lds
    v_sub_f32 v86, v86, v98
    v_sub_f32 v87, v87, v98
    v_sub_f32 v88, v88, v98
    v_sub_f32 v89, v89, v98
    v_sub_f32 v90, v90, v98
    v_sub_f32 v91, v91, v98
    v_sub_f32 v92, v92, v98
    v_sub_f32 v93, v93, v98
    v_sub_f32 v94, v94, v98
    v_sub_f32 v95, v95, v98
    v_sub_f32 v96, v96, v98
    s_add_u32 m0, s83, 32768
    s_nop 0
    buffer_load_dwordx4 v20, s[8:11], s81 offen lds
    v_sub_f32 v97, v97, v98
    v_mul_f32 v100, v78, v78
    v_mul_f32 v101, v79, v79
    v_fmac_f32 v100, v80, v80
    v_fmac_f32 v101, v81, v81
    v_fmac_f32 v100, v82, v82
    v_fmac_f32 v101, v83, v83
    v_fmac_f32 v100, v84, v84
    v_fmac_f32 v101, v85, v85
    v_fmac_f32 v100, v86, v86
    v_fmac_f32 v101, v87, v87
    s_add_u32 s81, s81, 221184
    v_fmac_f32 v100, v88, v88
    v_fmac_f32 v101, v89, v89
    v_fmac_f32 v100, v90, v90
    v_fmac_f32 v101, v91, v91
    v_fmac_f32 v100, v92, v92
    v_fmac_f32 v101, v93, v93
    v_fmac_f32 v100, v94, v94
    v_fmac_f32 v101, v95, v95
    v_fmac_f32 v100, v96, v96
    v_fmac_f32 v101, v97, v97
    v_add_f32_e64 v100, v100, v101
    s_add_u32 m0, s83, 81792
    s_nop 0
    buffer_load_dwordx4 v22, s[12:15], s76 offen offset:128 lds
    v_cvt_pk_bf16_f32 v71, -v98, -v98
    v_add_f32_dpp v100, v100, v100 row_ror:8 row_mask:0xf bank_mask:0xf
    s_nop 1
    v_add_f32_dpp v100, v100, v100 row_ror:4 row_mask:0xf bank_mask:0xf
    s_nop 1
    v_add_f32_dpp v100, v100, v100 row_ror:2 row_mask:0xf bank_mask:0xf
    s_nop 1
    v_add_f32_dpp v100, v100, v100 row_ror:1 row_mask:0xf bank_mask:0xf
    v_mov_b32 v102, v100
    s_nop 1
    v_permlane16_swap_b32 v100, v102
    v_add_f32 v100, v100, v102
    v_mul_f32 v100, 0x3acccccd, v100
    v_cvt_pk_bf16_f32 v102, v100, v100
    v_lshlrev_b32_e64 v100, 16, v102
    v_add_f32 v100, 0x3727c5ac, v100
    v_cvt_pk_bf16_f32 v102, v100, v100
    v_lshlrev_b32 v100, 16, v102
    v_sqrt_f32_e64 v100, v100
    s_nop 0
    v_cvt_pk_bf16_f32 v102, v100, v100
    v_lshlrev_b32 v100, 16, v102
    v_rcp_f32 v103, v100
    v_mul_f32_e64 v70, v100, v100
    v_mul_f32 v68, 0xc0135761, v103
    v_mul_f32 v102, v103, v103
    v_mul_f32 v102, v102, v103
    v_mul_f32 v69, 0xbdd2d3e8, v102
    v_and_b32 v68, 0xffffff7f, v68
    v_and_b32 v69, 0xffffff7f, v69
    v_and_b32 v70, 0xffffff7f, v70
    s_branch L_wd7
L_wb6:
    s_add_u32 m0, s83, 40960
    s_nop 0
    buffer_load_dwordx4 v22, s[12:15], s76 offen lds
    v_lshlrev_b32_e64 v98, 16, v68
    v_and_b32 v99, 0xffff0000, v68
    v_lshlrev_b32_e64 v100, 16, v69
    v_and_b32 v101, 0xffff0000, v69
    v_lshlrev_b32_e64 v88, 16, v70
    v_and_b32 v89, 0xffff0000, v70
    v_add_f32 v98, v98, v88
    v_add_f32 v99, v99, v89
    s_add_u32 m0, s83, 49152
    s_nop 0
    buffer_load_dwordx4 v22, s[12:15], s77 offen lds
    v_lshlrev_b32 v90, 16, v71
    v_and_b32 v91, 0xffff0000, v71
    v_add_f32 v100, v100, v90
    v_add_f32 v101, v101, v91
    v_lshlrev_b32_e64 v88, 16, v72
    v_and_b32 v89, 0xffff0000, v72
    v_add_f32 v98, v98, v88
    v_add_f32 v99, v99, v89
    s_add_u32 m0, s83, 57344
    s_nop 0
    buffer_load_dwordx4 v22, s[12:15], s78 offen lds
    v_lshlrev_b32 v90, 16, v73
    v_and_b32 v91, 0xffff0000, v73
    v_add_f32 v100, v100, v90
    v_add_f32 v101, v101, v91
    v_lshlrev_b32_e64 v88, 16, v74
    v_and_b32 v89, 0xffff0000, v74
    v_add_f32 v98, v98, v88
    v_add_f32 v99, v99, v89
    s_add_u32 m0, s83, 65536
    s_nop 0
    buffer_load_dwordx4 v22, s[12:15], s79 offen lds
    v_lshlrev_b32 v90, 16, v75
    v_and_b32 v91, 0xffff0000, v75
    v_add_f32 v100, v100, v90
    v_add_f32 v101, v101, v91
    v_lshlrev_b32_e64 v88, 16, v76
    v_and_b32 v89, 0xffff0000, v76
    v_add_f32 v98, v98, v88
    v_add_f32 v99, v99, v89
    s_add_u32 m0, s83, 73728
    s_nop 0
    buffer_load_dwordx4 v22, s[12:15], s80 offen lds
    v_lshlrev_b32 v90, 16, v77
    v_and_b32 v91, 0xffff0000, v77
    v_add_f32 v100, v100, v90
    v_add_f32 v101, v101, v91
    v_lshlrev_b32_e64 v88, 16, v78
    v_and_b32 v89, 0xffff0000, v78
    v_add_f32 v98, v98, v88
    v_add_f32 v99, v99, v89
    s_add_u32 m0, s83, 24576
    s_nop 0
    buffer_load_dwordx4 v20, s[4:7], s81 offen lds
    v_lshlrev_b32 v90, 16, v79
    v_and_b32 v91, 0xffff0000, v79
    v_add_f32 v100, v100, v90
    v_add_f32 v101, v101, v91
    v_lshlrev_b32_e64 v88, 16, v80
    v_and_b32 v89, 0xffff0000, v80
    v_add_f32 v98, v98, v88
    v_add_f32 v99, v99, v89
    s_add_u32 m0, s83, 32768
    s_nop 0
    buffer_load_dwordx4 v20, s[8:11], s81 offen lds
    v_lshlrev_b32 v90, 16, v81
    v_and_b32 v91, 0xffff0000, v81
    v_add_f32 v100, v100, v90
    v_add_f32 v101, v101, v91
    v_lshlrev_b32_e64 v88, 16, v82
    v_and_b32 v89, 0xffff0000, v82
    v_add_f32 v98, v98, v88
    v_add_f32 v99, v99, v89
    s_add_u32 s81, s81, 221184
    v_lshlrev_b32_e64 v90, 16, v83
    v_and_b32 v91, 0xffff0000, v83
    v_add_f32 v100, v100, v90
    v_add_f32 v101, v101, v91
    v_lshlrev_b32_e64 v88, 16, v84
    v_and_b32 v89, 0xffff0000, v84
    v_add_f32 v98, v98, v88
    v_add_f32 v99, v99, v89
    s_add_u32 m0, s83, 81792
    s_nop 0
    buffer_load_dwordx4 v22, s[12:15], s76 offen offset:128 lds
    v_lshlrev_b32 v90, 16, v85
    v_and_b32 v91, 0xffff0000, v85
    v_add_f32 v100, v100, v90
    v_add_f32 v101, v101, v91
    v_lshlrev_b32_e64 v88, 16, v86
    v_and_b32 v89, 0xffff0000, v86
    v_add_f32 v98, v98, v88
    v_add_f32 v99, v99, v89
    v_lshlrev_b32_e64 v90, 16, v87
    v_and_b32 v91, 0xffff0000, v87
    v_add_f32 v100, v100, v90
    v_add_f32 v101, v101, v91
    v_add_f32 v98, v98, v99
    v_add_f32 v100, v100, v101
    v_add_f32 v98, v98, v100
    s_nop 1
    v_add_f32_dpp v98, v98, v98 row_ror:8 row_mask:0xf bank_mask:0xf
    s_nop 1
    v_add_f32_dpp v98, v98, v98 row_ror:4 row_mask:0xf bank_mask:0xf
    s_nop 1
    v_add_f32_dpp v98, v98, v98 row_ror:2 row_mask:0xf bank_mask:0xf
    s_nop 1
    v_add_f32_dpp v98, v98, v98 row_ror:1 row_mask:0xf bank_mask:0xf
    v_cvt_pk_bf16_f32 v88, v98, v98
    v_lshlrev_b32 v88, 16, v88
    v_sub_f32_e64 v88, v98, v88
    v_cvt_pk_bf16_f32 v103, v98, v88
L_wd7:
    s_waitcnt lgkmcnt(0)
    buffer_store_dwordx4 v[68:71], v106, s[16:19], 0 offen sc1
    buffer_store_dword v103, v107, s[16:19], 0 offen sc1
    s_cmp_lt_u32 s68, 4
    s_cbranch_scc1 L_pr10
    s_setprio 1
L_pr10:
    s_waitcnt vmcnt(5)
    s_barrier
    ds_read_b64_tr_b16 v[128:129], v16 offset:0
    ds_read_b64_tr_b16 v[130:131], v16 offset:512
    ds_read_b64_tr_b16 v[132:133], v17 offset:0
    ds_read_b64_tr_b16 v[134:135], v17 offset:512
    ds_read_b128 v[144:147], v8 offset:0
    ds_read_b128 v[148:151], v8 offset:2048
    ds_read_b128 v[152:155], v8 offset:4096
    ds_read_b128 v[156:159], v8 offset:6144
    ds_read_b128 v[160:163], v8 offset:8192
    s_waitcnt lgkmcnt(4)
    v_mfma_f32_16x16x32_bf16 v[176:179], v[128:131], v[144:147], 0
    ds_read_b64_tr_b16 v[136:137], v16 offset:8192
    s_add_u32 m0, s83, 89984
    v_mfma_f32_16x16x32_bf16 v[180:183], v[132:135], v[144:147], 0
    ds_read_b64_tr_b16 v[138:139], v16 offset:8704
    buffer_load_dwordx4 v22, s[12:15], s77 offen offset:128 lds
    s_and_b32 s88, s72, 3
    s_mul_i32 s88, s88, 0
    s_lshr_b32 s86, s72, 2
    s_mul_i32 s86, s86, 1
    s_add_u32 s86, s86, s88
    s_waitcnt lgkmcnt(5)
    v_mfma_f32_16x16x32_bf16 v[192:195], v[128:131], v[148:151], 0
    ds_read_b64_tr_b16 v[140:141], v17 offset:8192
    s_add_u32 m0, s83, 98176
    v_mfma_f32_16x16x32_bf16 v[196:199], v[132:135], v[148:151], 0
    ds_read_b64_tr_b16 v[142:143], v17 offset:8704
    buffer_load_dwordx4 v22, s[12:15], s78 offen offset:128 lds
    s_mul_i32 s88, s86, 205
    s_lshr_b32 s88, s88, 10
    s_mul_i32 s88, s88, 5
    s_sub_u32 s86, s86, s88
    s_lshl_b32 s86, s86, 13
    s_waitcnt lgkmcnt(6)
    s_add_u32 m0, s83, 106368
    v_mfma_f32_16x16x32_bf16 v[208:211], v[128:131], v[152:155], 0
    v_mfma_f32_16x16x32_bf16 v[212:215], v[132:135], v[152:155], 0
    buffer_load_dwordx4 v22, s[12:15], s79 offen offset:128 lds
    s_add_u32 s36, s86, 55296
    s_add_u32 s86, s86, 0x2000
    s_cmp_eq_u32 s86, 40960
    s_cselect_b32 s86, 0, s86
    s_waitcnt lgkmcnt(5)
    s_add_u32 m0, s83, 114560
    v_mfma_f32_16x16x32_bf16 v[224:227], v[128:131], v[156:159], 0
    v_mfma_f32_16x16x32_bf16 v[228:231], v[132:135], v[156:159], 0
    buffer_load_dwordx4 v22, s[12:15], s80 offen offset:128 lds
    s_add_u32 s37, s86, 55296
    s_add_u32 s86, s86, 0x2000
    s_cmp_eq_u32 s86, 40960
    s_cselect_b32 s86, 0, s86
    s_waitcnt lgkmcnt(4)
    v_mfma_f32_16x16x32_bf16 v[240:243], v[128:131], v[160:163], 0
    v_mfma_f32_16x16x32_bf16 v[244:247], v[132:135], v[160:163], 0
    buffer_store_dwordx4 v[112:115], v4, s[16:19], s38 offen sc1
    s_add_u32 s42, s86, 55296
    s_add_u32 s86, s86, 0x2000
    s_cmp_eq_u32 s86, 40960
    s_cselect_b32 s86, 0, s86
    s_waitcnt lgkmcnt(0)
    s_bitcmp1_b32 s68, 2
    s_cbranch_scc1 L_cs11
    v_mfma_f32_16x16x32_bf16 v[52:55], v[24:27], v[128:131], 0
    v_mfma_f32_16x16x32_bf16 v[164:167], v[24:27], v[132:135], 0
    v_mfma_f32_16x16x32_bf16 v[168:171], v[24:27], v[136:139], 0
    v_mfma_f32_16x16x32_bf16 v[172:175], v[24:27], v[140:143], 0
L_cs11:
    v_mfma_f32_16x16x32_bf16 v[184:187], v[136:139], v[144:147], 0
    ds_read_b64_tr_b16 v[128:129], v18 offset:4096
    ds_read_b64_tr_b16 v[130:131], v18 offset:4608
    v_mfma_f32_16x16x32_bf16 v[188:191], v[140:143], v[144:147], 0
    ds_read_b64_tr_b16 v[132:133], v19 offset:4096
    ds_read_b64_tr_b16 v[134:135], v19 offset:4608
    ds_read_b128 v[144:147], v9 offset:0
    buffer_store_dwordx4 v[116:119], v4, s[16:19], s39 offen sc1
    s_add_u32 s43, s86, 55296
    s_add_u32 s86, s86, 0x2000
    s_cmp_eq_u32 s86, 40960
    s_cselect_b32 s86, 0, s86
    v_mfma_f32_16x16x32_bf16 v[200:203], v[136:139], v[148:151], 0
    v_mfma_f32_16x16x32_bf16 v[204:207], v[140:143], v[148:151], 0
    ds_read_b128 v[148:151], v9 offset:2048
    buffer_store_dwordx4 v[120:123], v4, s[16:19], s40 offen sc1
    s_add_u32 s44, s86, 55296
    s_and_b32 s88, s72, 3
    s_mul_i32 s88, s88, 0
    s_lshr_b32 s86, s72, 2
    s_mul_i32 s86, s86, 2
    s_add_u32 s86, s86, s88
    v_mfma_f32_16x16x32_bf16 v[216:219], v[136:139], v[152:155], 0
    v_mfma_f32_16x16x32_bf16 v[220:223], v[140:143], v[152:155], 0
    ds_read_b128 v[152:155], v9 offset:4096
    buffer_store_dwordx4 v[124:127], v4, s[16:19], s41 offen sc1
    s_mul_i32 s88, s86, 147
    s_lshr_b32 s88, s88, 10
    s_mul_i32 s88, s88, 7
    s_sub_u32 s86, s86, s88
    s_lshl_b32 s86, s86, 13
    v_mfma_f32_16x16x32_bf16 v[232:235], v[136:139], v[156:159], 0
    v_mfma_f32_16x16x32_bf16 v[236:239], v[140:143], v[156:159], 0
    ds_read_b128 v[156:159], v9 offset:6144
    s_and_b32 s88, s2, 1
    s_lshl_b32 s88, s88, 7
    v_mov_b32_e64 v64, 1
    buffer_atomic_add v64, v2, s[24:27], s88 offen sc1
    s_add_u32 s88, s86, s83
    s_cmp_ge_u32 s88, 55296
    s_cselect_b32 s45, 0x8000000, s86
    v_mfma_f32_16x16x32_bf16 v[248:251], v[136:139], v[160:163], 0
    s_add_u32 m0, s83, 122624
    v_mfma_f32_16x16x32_bf16 v[252:255], v[140:143], v[160:163], 0
    ds_read_b128 v[160:163], v9 offset:8192
    buffer_load_dwordx4 v22, s[12:15], s76 offen offset:256 lds
    s_add_u32 s86, s86, 0x2000
    s_cmp_eq_u32 s86, 57344
    s_cselect_b32 s86, 0, s86
    s_waitcnt lgkmcnt(4)
    v_mfma_f32_16x16x32_bf16 v[176:179], v[128:131], v[144:147], v[176:179]
    ds_read_b64_tr_b16 v[136:137], v18 offset:12288
    s_add_u32 m0, s83, 130816
    v_mfma_f32_16x16x32_bf16 v[180:183], v[132:135], v[144:147], v[180:183]
    ds_read_b64_tr_b16 v[138:139], v18 offset:12800
    buffer_load_dwordx4 v22, s[12:15], s77 offen offset:256 lds
    s_add_u32 s88, s86, s83
    s_cmp_ge_u32 s88, 55296
    s_cselect_b32 s46, 0x8000000, s86
    s_waitcnt lgkmcnt(5)
    v_mfma_f32_16x16x32_bf16 v[192:195], v[128:131], v[148:151], v[192:195]
    ds_read_b64_tr_b16 v[140:141], v19 offset:12288
    s_add_u32 m0, s83, 139008
    v_mfma_f32_16x16x32_bf16 v[196:199], v[132:135], v[148:151], v[196:199]
    ds_read_b64_tr_b16 v[142:143], v19 offset:12800
    buffer_load_dwordx4 v22, s[12:15], s78 offen offset:256 lds
    s_add_u32 s86, s86, 0x2000
    s_cmp_eq_u32 s86, 57344
    s_cselect_b32 s86, 0, s86
    s_waitcnt lgkmcnt(6)
    s_add_u32 m0, s83, 147200
    v_mfma_f32_16x16x32_bf16 v[208:211], v[128:131], v[152:155], v[208:211]
    v_mfma_f32_16x16x32_bf16 v[212:215], v[132:135], v[152:155], v[212:215]
    buffer_load_dwordx4 v22, s[12:15], s79 offen offset:256 lds
    s_add_u32 s88, s86, s83
    s_cmp_ge_u32 s88, 55296
    s_cselect_b32 s50, 0x8000000, s86
    s_waitcnt lgkmcnt(5)
    s_add_u32 m0, s83, 155392
    v_mfma_f32_16x16x32_bf16 v[224:227], v[128:131], v[156:159], v[224:227]
    v_mfma_f32_16x16x32_bf16 v[228:231], v[132:135], v[156:159], v[228:231]
    buffer_load_dwordx4 v22, s[12:15], s80 offen offset:256 lds
    s_add_u32 s86, s86, 0x2000
    s_cmp_eq_u32 s86, 57344
    s_cselect_b32 s86, 0, s86
    s_waitcnt lgkmcnt(4)
    v_mfma_f32_16x16x32_bf16 v[240:243], v[128:131], v[160:163], v[240:243]
    v_mfma_f32_16x16x32_bf16 v[244:247], v[132:135], v[160:163], v[244:247]
    s_add_u32 s88, s86, s83
    s_cmp_ge_u32 s88, 55296
    s_cselect_b32 s51, 0x8000000, s86
    s_waitcnt vmcnt(6) lgkmcnt(0)
    s_barrier
    v_mfma_f32_16x16x32_bf16 v[184:187], v[136:139], v[144:147], v[184:187]
    ds_read_b64_tr_b16 v[128:129], v16 offset:16384
    ds_read_b64_tr_b16 v[130:131], v16 offset:16896
    v_mfma_f32_16x16x32_bf16 v[188:191], v[140:143], v[144:147], v[188:191]
    ds_read_b64_tr_b16 v[132:133], v17 offset:16384
    s_add_u32 m0, s83, 8192
    ds_read_b64_tr_b16 v[134:135], v17 offset:16896
    ds_read_b128 v[144:147], v8 offset:40960
    buffer_load_dwordx4 v20, s[4:7], s81 offen lds
    s_add_u32 s86, s86, 0x2000
    s_cmp_eq_u32 s86, 57344
    s_cselect_b32 s86, 0, s86
    v_mfma_f32_16x16x32_bf16 v[200:203], v[136:139], v[148:151], v[200:203]
    v_mfma_f32_16x16x32_bf16 v[204:207], v[140:143], v[148:151], v[204:207]
    ds_read_b128 v[148:151], v8 offset:43008
    s_add_u32 s88, s86, s83
    s_cmp_ge_u32 s88, 55296
    s_cselect_b32 s63, 0x8000000, s86
    v_mfma_f32_16x16x32_bf16 v[216:219], v[136:139], v[152:155], v[216:219]
    s_add_u32 m0, s83, 16384
    v_mfma_f32_16x16x32_bf16 v[220:223], v[140:143], v[152:155], v[220:223]
    ds_read_b128 v[152:155], v8 offset:45056
    buffer_load_dwordx4 v20, s[8:11], s81 offen lds
    s_add_u32 s81, s81, 221184
    s_add_u32 s86, s86, 0x2000
    s_cmp_eq_u32 s86, 57344
    s_cselect_b32 s86, 0, s86
    v_mfma_f32_16x16x32_bf16 v[232:235], v[136:139], v[156:159], v[232:235]
    v_mfma_f32_16x16x32_bf16 v[236:239], v[140:143], v[156:159], v[236:239]
    ds_read_b128 v[156:159], v8 offset:47104
    s_add_u32 s88, s86, s83
    s_cmp_ge_u32 s88, 55296
    s_cselect_b32 s84, 0x8000000, s86
    v_mfma_f32_16x16x32_bf16 v[248:251], v[136:139], v[160:163], v[248:251]
    v_mfma_f32_16x16x32_bf16 v[252:255], v[140:143], v[160:163], v[252:255]
    ds_read_b128 v[160:163], v8 offset:49152
    v_mov_b32_e64 v64, 1
    buffer_store_dword v64, v2, s[16:19], s95 offen sc1
    s_add_u32 s86, s86, 0x2000
    s_cmp_eq_u32 s86, 57344
    s_cselect_b32 s86, 0, s86
    s_waitcnt lgkmcnt(4)
    v_mfma_f32_16x16x32_bf16 v[176:179], v[128:131], v[144:147], v[176:179]
    ds_read_b64_tr_b16 v[136:137], v16 offset:24576
    v_mfma_f32_16x16x32_bf16 v[180:183], v[132:135], v[144:147], v[180:183]
    ds_read_b64_tr_b16 v[138:139], v16 offset:25088
    s_add_u32 s88, s86, s83
    s_cmp_ge_u32 s88, 55296
    s_cselect_b32 s85, 0x8000000, s86
    s_waitcnt lgkmcnt(5)
    v_mfma_f32_16x16x32_bf16 v[192:195], v[128:131], v[148:151], v[192:195]
    ds_read_b64_tr_b16 v[140:141], v17 offset:24576
    s_add_u32 m0, s83, 40576
    v_mfma_f32_16x16x32_bf16 v[196:199], v[132:135], v[148:151], v[196:199]
    ds_read_b64_tr_b16 v[142:143], v17 offset:25088
    buffer_load_dwordx4 v22, s[12:15], s76 offen offset:384 lds
    s_waitcnt lgkmcnt(6)
    v_mfma_f32_16x16x32_bf16 v[208:211], v[128:131], v[152:155], v[208:211]
    v_mfma_f32_16x16x32_bf16 v[212:215], v[132:135], v[152:155], v[212:215]
    s_waitcnt lgkmcnt(5)
    s_add_u32 m0, s83, 48768
    v_mfma_f32_16x16x32_bf16 v[224:227], v[128:131], v[156:159], v[224:227]
    v_mfma_f32_16x16x32_bf16 v[228:231], v[132:135], v[156:159], v[228:231]
    buffer_load_dwordx4 v22, s[12:15], s77 offen offset:384 lds
    s_waitcnt lgkmcnt(4)
    v_mfma_f32_16x16x32_bf16 v[240:243], v[128:131], v[160:163], v[240:243]
    v_mfma_f32_16x16x32_bf16 v[244:247], v[132:135], v[160:163], v[244:247]
    s_waitcnt lgkmcnt(0)
    s_bitcmp1_b32 s68, 2
    s_cbranch_scc0 L_cs12
    v_mfma_f32_16x16x32_bf16 v[52:55], v[24:27], v[128:131], 0
    v_mfma_f32_16x16x32_bf16 v[164:167], v[24:27], v[132:135], 0
    v_mfma_f32_16x16x32_bf16 v[168:171], v[24:27], v[136:139], 0
    v_mfma_f32_16x16x32_bf16 v[172:175], v[24:27], v[140:143], 0
L_cs12:
    v_mfma_f32_16x16x32_bf16 v[184:187], v[136:139], v[144:147], v[184:187]
    ds_read_b64_tr_b16 v[128:129], v18 offset:20480
    ds_read_b64_tr_b16 v[130:131], v18 offset:20992
    v_mfma_f32_16x16x32_bf16 v[188:191], v[140:143], v[144:147], v[188:191]
    ds_read_b64_tr_b16 v[132:133], v19 offset:20480
    s_add_u32 m0, s83, 56960
    ds_read_b64_tr_b16 v[134:135], v19 offset:20992
    ds_read_b128 v[144:147], v9 offset:40960
    buffer_load_dwordx4 v22, s[12:15], s78 offen offset:384 lds
    v_mfma_f32_16x16x32_bf16 v[200:203], v[136:139], v[148:151], v[200:203]
    v_mfma_f32_16x16x32_bf16 v[204:207], v[140:143], v[148:151], v[204:207]
    ds_read_b128 v[148:151], v9 offset:43008
    v_mfma_f32_16x16x32_bf16 v[216:219], v[136:139], v[152:155], v[216:219]
    s_add_u32 m0, s83, 65152
    v_mfma_f32_16x16x32_bf16 v[220:223], v[140:143], v[152:155], v[220:223]
    ds_read_b128 v[152:155], v9 offset:45056
    buffer_load_dwordx4 v22, s[12:15], s79 offen offset:384 lds
    v_mfma_f32_16x16x32_bf16 v[232:235], v[136:139], v[156:159], v[232:235]
    v_mfma_f32_16x16x32_bf16 v[236:239], v[140:143], v[156:159], v[236:239]
    ds_read_b128 v[156:159], v9 offset:47104
    v_mfma_f32_16x16x32_bf16 v[248:251], v[136:139], v[160:163], v[248:251]
    s_add_u32 m0, s83, 73344
    v_mfma_f32_16x16x32_bf16 v[252:255], v[140:143], v[160:163], v[252:255]
    ds_read_b128 v[160:163], v9 offset:49152
    buffer_load_dwordx4 v22, s[12:15], s80 offen offset:384 lds
    s_waitcnt lgkmcnt(4)
    v_mfma_f32_16x16x32_bf16 v[176:179], v[128:131], v[144:147], v[176:179]
    ds_read_b64_tr_b16 v[136:137], v18 offset:28672
    v_mfma_f32_16x16x32_bf16 v[180:183], v[132:135], v[144:147], v[180:183]
    ds_read_b64_tr_b16 v[138:139], v18 offset:29184
    s_waitcnt lgkmcnt(5)
    v_mfma_f32_16x16x32_bf16 v[192:195], v[128:131], v[148:151], v[192:195]
    ds_read_b64_tr_b16 v[140:141], v19 offset:28672
    v_mfma_f32_16x16x32_bf16 v[196:199], v[132:135], v[148:151], v[196:199]
    ds_read_b64_tr_b16 v[142:143], v19 offset:29184
    s_waitcnt lgkmcnt(6)
    v_mfma_f32_16x16x32_bf16 v[208:211], v[128:131], v[152:155], v[208:211]
    v_mfma_f32_16x16x32_bf16 v[212:215], v[132:135], v[152:155], v[212:215]
    s_waitcnt lgkmcnt(5)
    v_mfma_f32_16x16x32_bf16 v[224:227], v[128:131], v[156:159], v[224:227]
    v_mfma_f32_16x16x32_bf16 v[228:231], v[132:135], v[156:159], v[228:231]
    s_waitcnt lgkmcnt(4)
    v_mfma_f32_16x16x32_bf16 v[240:243], v[128:131], v[160:163], v[240:243]
    v_mfma_f32_16x16x32_bf16 v[244:247], v[132:135], v[160:163], v[244:247]
    s_waitcnt vmcnt(6) lgkmcnt(0)
    s_barrier
    v_mfma_f32_16x16x32_bf16 v[184:187], v[136:139], v[144:147], v[184:187]
    ds_read_b64_tr_b16 v[128:129], v16 offset:0
    ds_read_b64_tr_b16 v[130:131], v16 offset:512
    v_mfma_f32_16x16x32_bf16 v[188:191], v[140:143], v[144:147], v[188:191]
    ds_read_b64_tr_b16 v[132:133], v17 offset:0
    s_add_u32 m0, s83, 24576
    ds_read_b64_tr_b16 v[134:135], v17 offset:512
    ds_read_b128 v[144:147], v12 offset:0
    buffer_load_dwordx4 v20, s[4:7], s81 offen lds
    v_mfma_f32_16x16x32_bf16 v[200:203], v[136:139], v[148:151], v[200:203]
    v_mfma_f32_16x16x32_bf16 v[204:207], v[140:143], v[148:151], v[204:207]
    ds_read_b128 v[148:151], v12 offset:2048
    v_mfma_f32_16x16x32_bf16 v[216:219], v[136:139], v[152:155], v[216:219]
    s_add_u32 m0, s83, 32768
    v_mfma_f32_16x16x32_bf16 v[220:223], v[140:143], v[152:155], v[220:223]
    ds_read_b128 v[152:155], v12 offset:4096
    buffer_load_dwordx4 v20, s[8:11], s81 offen lds
    s_add_u32 s81, s81, 221184
    v_mfma_f32_16x16x32_bf16 v[232:235], v[136:139], v[156:159], v[232:235]
    v_mfma_f32_16x16x32_bf16 v[236:239], v[140:143], v[156:159], v[236:239]
    ds_read_b128 v[156:159], v12 offset:6144
    v_mfma_f32_16x16x32_bf16 v[248:251], v[136:139], v[160:163], v[248:251]
    v_mfma_f32_16x16x32_bf16 v[252:255], v[140:143], v[160:163], v[252:255]
    ds_read_b128 v[160:163], v12 offset:8192
    v_lshlrev_b32 v64, 7, v0
    buffer_load_dword v23, v64, s[24:27], 0 offen sc1
    s_waitcnt lgkmcnt(4)
    v_mfma_f32_16x16x32_bf16 v[176:179], v[128:131], v[144:147], v[176:179]
    ds_read_b64_tr_b16 v[136:137], v16 offset:8192
    v_mfma_f32_16x16x32_bf16 v[180:183], v[132:135], v[144:147], v[180:183]
    ds_read_b64_tr_b16 v[138:139], v16 offset:8704
    s_waitcnt lgkmcnt(5)
    v_mfma_f32_16x16x32_bf16 v[192:195], v[128:131], v[148:151], v[192:195]
    ds_read_b64_tr_b16 v[140:141], v17 offset:8192
    v_mfma_f32_16x16x32_bf16 v[196:199], v[132:135], v[148:151], v[196:199]
    ds_read_b64_tr_b16 v[142:143], v17 offset:8704
    s_lshr_b32 s89, s68, 1
    s_lshl2_add_u32 s88, s74, s89
    s_mul_i32 s88, s88, 55296
    s_lshl_b32 s89, s73, 7
    s_add_u32 s88, s88, s89
    s_add_u32 s88, s88, 884736
    v_mul_u32_u24 v21, 0xd80, v1
    s_bfm_b64 exec, 16, 0
    s_bitcmp1_b32 s68, 0
    s_cbranch_scc1 L_wt13
    buffer_load_dword v10, v21, s[4:7], s88 offen
    s_branch L_wu14
L_wt13:
    buffer_load_dword v10, v21, s[8:11], s88 offen
L_wu14:
    s_mov_b64 exec, -1
    s_waitcnt lgkmcnt(6)
    v_mfma_f32_16x16x32_bf16 v[208:211], v[128:131], v[152:155], v[208:211]
    v_mfma_f32_16x16x32_bf16 v[212:215], v[132:135], v[152:155], v[212:215]
    s_waitcnt lgkmcnt(5)
    s_add_u32 m0, s83, 81408
    v_mfma_f32_16x16x32_bf16 v[224:227], v[128:131], v[156:159], v[224:227]
    v_mfma_f32_16x16x32_bf16 v[228:231], v[132:135], v[156:159], v[228:231]
    buffer_load_dwordx4 v22, s[12:15], s76 offen offset:512 lds
    s_waitcnt lgkmcnt(4)
    v_mfma_f32_16x16x32_bf16 v[240:243], v[128:131], v[160:163], v[240:243]
    v_mfma_f32_16x16x32_bf16 v[244:247], v[132:135], v[160:163], v[244:247]
    s_waitcnt lgkmcnt(0)
    s_bitcmp1_b32 s68, 2
    s_cbranch_scc1 L_cs15
    v_mfma_f32_16x16x32_bf16 v[52:55], v[24:27], v[128:131], v[52:55]
    v_mfma_f32_16x16x32_bf16 v[164:167], v[24:27], v[132:135], v[164:167]
    v_mfma_f32_16x16x32_bf16 v[168:171], v[24:27], v[136:139], v[168:171]
    v_mfma_f32_16x16x32_bf16 v[172:175], v[24:27], v[140:143], v[172:175]
L_cs15:
    v_mfma_f32_16x16x32_bf16 v[184:187], v[136:139], v[144:147], v[184:187]
    ds_read_b64_tr_b16 v[128:129], v18 offset:4096
    ds_read_b64_tr_b16 v[130:131], v18 offset:4608
    v_mfma_f32_16x16x32_bf16 v[188:191], v[140:143], v[144:147], v[188:191]
    ds_read_b64_tr_b16 v[132:133], v19 offset:4096
    s_add_u32 m0, s83, 89600
    ds_read_b64_tr_b16 v[134:135], v19 offset:4608
    ds_read_b128 v[144:147], v13 offset:0
    buffer_load_dwordx4 v22, s[12:15], s77 offen offset:512 lds
    v_mfma_f32_16x16x32_bf16 v[200:203], v[136:139], v[148:151], v[200:203]
    v_mfma_f32_16x16x32_bf16 v[204:207], v[140:143], v[148:151], v[204:207]
    ds_read_b128 v[148:151], v13 offset:2048
    v_mfma_f32_16x16x32_bf16 v[216:219], v[136:139], v[152:155], v[216:219]
    s_add_u32 m0, s83, 97792
    v_mfma_f32_16x16x32_bf16 v[220:223], v[140:143], v[152:155], v[220:223]
    ds_read_b128 v[152:155], v13 offset:4096
    buffer_load_dwordx4 v22, s[12:15], s78 offen offset:512 lds
    v_mfma_f32_16x16x32_bf16 v[232:235], v[136:139], v[156:159], v[232:235]
    v_mfma_f32_16x16x32_bf16 v[236:239], v[140:143], v[156:159], v[236:239]
    ds_read_b128 v[156:159], v13 offset:6144
    v_mfma_f32_16x16x32_bf16 v[248:251], v[136:139], v[160:163], v[248:251]
    s_add_u32 m0, s83, 105984
    v_mfma_f32_16x16x32_bf16 v[252:255], v[140:143], v[160:163], v[252:255]
    ds_read_b128 v[160:163], v13 offset:8192
    buffer_load_dwordx4 v22, s[12:15], s79 offen offset:512 lds
    s_waitcnt lgkmcnt(4)
    v_mfma_f32_16x16x32_bf16 v[176:179], v[128:131], v[144:147], v[176:179]
    ds_read_b64_tr_b16 v[136:137], v18 offset:12288
    v_mfma_f32_16x16x32_bf16 v[180:183], v[132:135], v[144:147], v[180:183]
    ds_read_b64_tr_b16 v[138:139], v18 offset:12800
    s_waitcnt lgkmcnt(5)
    v_mfma_f32_16x16x32_bf16 v[192:195], v[128:131], v[148:151], v[192:195]
    ds_read_b64_tr_b16 v[140:141], v19 offset:12288
    s_add_u32 m0, s83, 114176
    v_mfma_f32_16x16x32_bf16 v[196:199], v[132:135], v[148:151], v[196:199]
    ds_read_b64_tr_b16 v[142:143], v19 offset:12800
    buffer_load_dwordx4 v22, s[12:15], s80 offen offset:512 lds
    s_waitcnt lgkmcnt(6)
    v_mfma_f32_16x16x32_bf16 v[208:211], v[128:131], v[152:155], v[208:211]
    v_mfma_f32_16x16x32_bf16 v[212:215], v[132:135], v[152:155], v[212:215]
    s_waitcnt lgkmcnt(5)
    v_mfma_f32_16x16x32_bf16 v[224:227], v[128:131], v[156:159], v[224:227]
    v_mfma_f32_16x16x32_bf16 v[228:231], v[132:135], v[156:159], v[228:231]
    s_waitcnt lgkmcnt(4)
    v_mfma_f32_16x16x32_bf16 v[240:243], v[128:131], v[160:163], v[240:243]
    v_mfma_f32_16x16x32_bf16 v[244:247], v[132:135], v[160:163], v[244:247]
    s_cmp_lg_u32 s68, 0
    s_cbranch_scc1 L_cd17
    s_waitcnt vmcnt(6)
L_cp16:
    v_cmp_gt_u32 vcc, 0x80, v23
    s_nop 0
    s_and_b32 s88, vcc_lo, 3
    s_cbranch_scc0 L_cd17
    v_lshlrev_b32_e64 v64, 7, v0
    buffer_load_dword v23, v64, s[24:27], 0 offen sc1
    s_waitcnt vmcnt(0)
    s_sub_u32 s99, s99, 1
    s_cmp_gt_i32 s99, 0
    s_cbranch_scc1 L_cp16
L_cd17:
    s_waitcnt vmcnt(7) lgkmcnt(0)
    s_barrier
    v_mfma_f32_16x16x32_bf16 v[184:187], v[136:139], v[144:147], v[184:187]
    ds_read_b64_tr_b16 v[128:129], v16 offset:16384
    ds_read_b64_tr_b16 v[130:131], v16 offset:16896
    v_mfma_f32_16x16x32_bf16 v[188:191], v[140:143], v[144:147], v[188:191]
    ds_read_b64_tr_b16 v[132:133], v17 offset:16384
    s_add_u32 m0, s83, 8192
    ds_read_b64_tr_b16 v[134:135], v17 offset:16896
    ds_read_b128 v[144:147], v8 offset:0
    buffer_load_dwordx4 v20, s[4:7], s81 offen lds
    v_mfma_f32_16x16x32_bf16 v[200:203], v[136:139], v[148:151], v[200:203]
    v_mfma_f32_16x16x32_bf16 v[204:207], v[140:143], v[148:151], v[204:207]
    ds_read_b128 v[148:151], v8 offset:2048
    v_mfma_f32_16x16x32_bf16 v[216:219], v[136:139], v[152:155], v[216:219]
    s_add_u32 m0, s83, 16384
    v_mfma_f32_16x16x32_bf16 v[220:223], v[140:143], v[152:155], v[220:223]
    ds_read_b128 v[152:155], v8 offset:4096
    buffer_load_dwordx4 v20, s[8:11], s81 offen lds
    s_add_u32 s81, s81, 221184
    v_mfma_f32_16x16x32_bf16 v[232:235], v[136:139], v[156:159], v[232:235]
    v_mfma_f32_16x16x32_bf16 v[236:239], v[140:143], v[156:159], v[236:239]
    ds_read_b128 v[156:159], v8 offset:6144
    v_mfma_f32_16x16x32_bf16 v[248:251], v[136:139], v[160:163], v[248:251]
    v_mfma_f32_16x16x32_bf16 v[252:255], v[140:143], v[160:163], v[252:255]
    ds_read_b128 v[160:163], v8 offset:8192
    buffer_load_dwordx4 v[60:63], v67, s[16:19], 0 offen sc1
    s_waitcnt lgkmcnt(4)
    v_mfma_f32_16x16x32_bf16 v[176:179], v[128:131], v[144:147], v[176:179]
    ds_read_b64_tr_b16 v[136:137], v16 offset:24576
    v_mfma_f32_16x16x32_bf16 v[180:183], v[132:135], v[144:147], v[180:183]
    ds_read_b64_tr_b16 v[138:139], v16 offset:25088
    s_waitcnt lgkmcnt(5)
    v_mfma_f32_16x16x32_bf16 v[192:195], v[128:131], v[148:151], v[192:195]
    ds_read_b64_tr_b16 v[140:141], v17 offset:24576
    s_add_u32 m0, s83, 122240
    v_mfma_f32_16x16x32_bf16 v[196:199], v[132:135], v[148:151], v[196:199]
    ds_read_b64_tr_b16 v[142:143], v17 offset:25088
    buffer_load_dwordx4 v22, s[12:15], s76 offen offset:640 lds
    s_waitcnt lgkmcnt(6)
    v_mfma_f32_16x16x32_bf16 v[208:211], v[128:131], v[152:155], v[208:211]
    v_mfma_f32_16x16x32_bf16 v[212:215], v[132:135], v[152:155], v[212:215]
    s_waitcnt lgkmcnt(5)
    s_add_u32 m0, s83, 130432
    v_mfma_f32_16x16x32_bf16 v[224:227], v[128:131], v[156:159], v[224:227]
    v_mfma_f32_16x16x32_bf16 v[228:231], v[132:135], v[156:159], v[228:231]
    buffer_load_dwordx4 v22, s[12:15], s77 offen offset:640 lds
    s_waitcnt lgkmcnt(4)
    v_mfma_f32_16x16x32_bf16 v[240:243], v[128:131], v[160:163], v[240:243]
    v_mfma_f32_16x16x32_bf16 v[244:247], v[132:135], v[160:163], v[244:247]
    s_waitcnt lgkmcnt(0)
    s_bitcmp1_b32 s68, 2
    s_cbranch_scc0 L_cs18
    v_mfma_f32_16x16x32_bf16 v[52:55], v[24:27], v[128:131], v[52:55]
    v_mfma_f32_16x16x32_bf16 v[164:167], v[24:27], v[132:135], v[164:167]
    v_mfma_f32_16x16x32_bf16 v[168:171], v[24:27], v[136:139], v[168:171]
    v_mfma_f32_16x16x32_bf16 v[172:175], v[24:27], v[140:143], v[172:175]
L_cs18:
    v_mfma_f32_16x16x32_bf16 v[184:187], v[136:139], v[144:147], v[184:187]
    ds_read_b64_tr_b16 v[128:129], v18 offset:20480
    ds_read_b64_tr_b16 v[130:131], v18 offset:20992
    v_mfma_f32_16x16x32_bf16 v[188:191], v[140:143], v[144:147], v[188:191]
    ds_read_b64_tr_b16 v[132:133], v19 offset:20480
    s_add_u32 m0, s83, 138624
    ds_read_b64_tr_b16 v[134:135], v19 offset:20992
    ds_read_b128 v[144:147], v9 offset:0
    buffer_load_dwordx4 v22, s[12:15], s78 offen offset:640 lds
    v_mfma_f32_16x16x32_bf16 v[200:203], v[136:139], v[148:151], v[200:203]
    v_mfma_f32_16x16x32_bf16 v[204:207], v[140:143], v[148:151], v[204:207]
    ds_read_b128 v[148:151], v9 offset:2048
    v_mfma_f32_16x16x32_bf16 v[216:219], v[136:139], v[152:155], v[216:219]
    s_add_u32 m0, s83, 146816
    v_mfma_f32_16x16x32_bf16 v[220:223], v[140:143], v[152:155], v[220:223]
    ds_read_b128 v[152:155], v9 offset:4096
    buffer_load_dwordx4 v22, s[12:15], s79 offen offset:640 lds
    v_mfma_f32_16x16x32_bf16 v[232:235], v[136:139], v[156:159], v[232:235]
    v_mfma_f32_16x16x32_bf16 v[236:239], v[140:143], v[156:159], v[236:239]
    ds_read_b128 v[156:159], v9 offset:6144
    v_mfma_f32_16x16x32_bf16 v[248:251], v[136:139], v[160:163], v[248:251]
    s_add_u32 m0, s83, 155008
    v_mfma_f32_16x16x32_bf16 v[252:255], v[140:143], v[160:163], v[252:255]
    ds_read_b128 v[160:163], v9 offset:8192
    buffer_load_dwordx4 v22, s[12:15], s80 offen offset:640 lds
    s_waitcnt lgkmcnt(4)
    v_mfma_f32_16x16x32_bf16 v[176:179], v[128:131], v[144:147], v[176:179]
    ds_read_b64_tr_b16 v[136:137], v18 offset:28672
    v_mfma_f32_16x16x32_bf16 v[180:183], v[132:135], v[144:147], v[180:183]
    ds_read_b64_tr_b16 v[138:139], v18 offset:29184
    s_waitcnt lgkmcnt(5)
    v_mfma_f32_16x16x32_bf16 v[192:195], v[128:131], v[148:151], v[192:195]
    ds_read_b64_tr_b16 v[140:141], v19 offset:28672
    v_mfma_f32_16x16x32_bf16 v[196:199], v[132:135], v[148:151], v[196:199]
    ds_read_b64_tr_b16 v[142:143], v19 offset:29184
    s_waitcnt lgkmcnt(6)
    v_mfma_f32_16x16x32_bf16 v[208:211], v[128:131], v[152:155], v[208:211]
    v_mfma_f32_16x16x32_bf16 v[212:215], v[132:135], v[152:155], v[212:215]
    s_waitcnt lgkmcnt(5)
    v_mfma_f32_16x16x32_bf16 v[224:227], v[128:131], v[156:159], v[224:227]
    v_mfma_f32_16x16x32_bf16 v[228:231], v[132:135], v[156:159], v[228:231]
    s_waitcnt lgkmcnt(4)
    v_mfma_f32_16x16x32_bf16 v[240:243], v[128:131], v[160:163], v[240:243]
    v_mfma_f32_16x16x32_bf16 v[244:247], v[132:135], v[160:163], v[244:247]
    s_cmp_lg_u32 s68, 0
    s_cbranch_scc1 L_cd20
    s_waitcnt vmcnt(5)
L_cp19:
    v_and_b32 v60, v60, v61
    v_and_b32 v62, v62, v63
    v_and_b32 v60, 1, v60
    v_and_b32 v60, v60, v62
    v_cmp_ne_u32 vcc, 1, v60
    s_nop 0
    s_and_b32 vcc_hi, vcc_hi, 0xfff
    s_cmp_lg_u64 vcc, 0
    s_cbranch_scc0 L_cd20
    buffer_load_dwordx4 v[60:63], v67, s[16:19], 0 offen sc1
    s_waitcnt vmcnt(0)
    s_sub_u32 s99, s99, 1
    s_cmp_gt_i32 s99, 0
    s_cbranch_scc1 L_cp19
L_cd20:
    s_waitcnt vmcnt(6) lgkmcnt(0)
    s_barrier
    v_mfma_f32_16x16x32_bf16 v[184:187], v[136:139], v[144:147], v[184:187]
    ds_read_b64_tr_b16 v[128:129], v16 offset:0
    ds_read_b64_tr_b16 v[130:131], v16 offset:512
    v_mfma_f32_16x16x32_bf16 v[188:191], v[140:143], v[144:147], v[188:191]
    ds_read_b64_tr_b16 v[132:133], v17 offset:0
    s_add_u32 m0, s83, 24576
    ds_read_b64_tr_b16 v[134:135], v17 offset:512
    ds_read_b128 v[144:147], v8 offset:40960
    buffer_load_dwordx4 v20, s[4:7], s81 offen lds
    v_mfma_f32_16x16x32_bf16 v[200:203], v[136:139], v[148:151], v[200:203]
    v_mfma_f32_16x16x32_bf16 v[204:207], v[140:143], v[148:151], v[204:207]
    ds_read_b128 v[148:151], v8 offset:43008
    v_mfma_f32_16x16x32_bf16 v[216:219], v[136:139], v[152:155], v[216:219]
    s_add_u32 m0, s83, 32768
    v_mfma_f32_16x16x32_bf16 v[220:223], v[140:143], v[152:155], v[220:223]
    ds_read_b128 v[152:155], v8 offset:45056
    buffer_load_dwordx4 v20, s[8:11], s81 offen lds
    s_add_u32 s81, s81, 221184
    v_mfma_f32_16x16x32_bf16 v[232:235], v[136:139], v[156:159], v[232:235]
    v_mfma_f32_16x16x32_bf16 v[236:239], v[140:143], v[156:159], v[236:239]
    ds_read_b128 v[156:159], v8 offset:47104
    v_mfma_f32_16x16x32_bf16 v[248:251], v[136:139], v[160:163], v[248:251]
    s_add_u32 m0, s83, 40192
    v_mfma_f32_16x16x32_bf16 v[252:255], v[140:143], v[160:163], v[252:255]
    ds_read_b128 v[160:163], v8 offset:49152
    buffer_load_dwordx4 v22, s[12:15], s76 offen offset:768 lds
    s_waitcnt lgkmcnt(4)
    v_mfma_f32_16x16x32_bf16 v[176:179], v[128:131], v[144:147], v[176:179]
    ds_read_b64_tr_b16 v[136:137], v16 offset:8192
    v_mfma_f32_16x16x32_bf16 v[180:183], v[132:135], v[144:147], v[180:183]
    ds_read_b64_tr_b16 v[138:139], v16 offset:8704
    s_waitcnt lgkmcnt(5)
    v_mfma_f32_16x16x32_bf16 v[192:195], v[128:131], v[148:151], v[192:195]
    ds_read_b64_tr_b16 v[140:141], v17 offset:8192
    s_add_u32 m0, s83, 48384
    v_mfma_f32_16x16x32_bf16 v[196:199], v[132:135], v[148:151], v[196:199]
    ds_read_b64_tr_b16 v[142:143], v17 offset:8704
    buffer_load_dwordx4 v22, s[12:15], s77 offen offset:768 lds
    s_waitcnt lgkmcnt(6)
    v_mfma_f32_16x16x32_bf16 v[208:211], v[128:131], v[152:155], v[208:211]
    v_mfma_f32_16x16x32_bf16 v[212:215], v[132:135], v[152:155], v[212:215]
    s_waitcnt lgkmcnt(5)
    s_add_u32 m0, s83, 56576
    v_mfma_f32_16x16x32_bf16 v[224:227], v[128:131], v[156:159], v[224:227]
    v_mfma_f32_16x16x32_bf16 v[228:231], v[132:135], v[156:159], v[228:231]
    buffer_load_dwordx4 v22, s[12:15], s78 offen offset:768 lds
    s_waitcnt lgkmcnt(4)
    v_mfma_f32_16x16x32_bf16 v[240:243], v[128:131], v[160:163], v[240:243]
    v_mfma_f32_16x16x32_bf16 v[244:247], v[132:135], v[160:163], v[244:247]
    s_waitcnt lgkmcnt(0)
    s_bitcmp1_b32 s68, 2
    s_cbranch_scc1 L_cs21
    v_mfma_f32_16x16x32_bf16 v[52:55], v[24:27], v[128:131], v[52:55]
    v_mfma_f32_16x16x32_bf16 v[164:167], v[24:27], v[132:135], v[164:167]
    v_mfma_f32_16x16x32_bf16 v[168:171], v[24:27], v[136:139], v[168:171]
    v_mfma_f32_16x16x32_bf16 v[172:175], v[24:27], v[140:143], v[172:175]
L_cs21:
    v_mfma_f32_16x16x32_bf16 v[184:187], v[136:139], v[144:147], v[184:187]
    ds_read_b64_tr_b16 v[128:129], v18 offset:4096
    ds_read_b64_tr_b16 v[130:131], v18 offset:4608
    v_mfma_f32_16x16x32_bf16 v[188:191], v[140:143], v[144:147], v[188:191]
    ds_read_b64_tr_b16 v[132:133], v19 offset:4096
    s_add_u32 m0, s83, 64768
    ds_read_b64_tr_b16 v[134:135], v19 offset:4608
    ds_read_b128 v[144:147], v9 offset:40960
    buffer_load_dwordx4 v22, s[12:15], s79 offen offset:768 lds
    v_mfma_f32_16x16x32_bf16 v[200:203], v[136:139], v[148:151], v[200:203]
    v_mfma_f32_16x16x32_bf16 v[204:207], v[140:143], v[148:151], v[204:207]
    ds_read_b128 v[148:151], v9 offset:43008
    v_mfma_f32_16x16x32_bf16 v[216:219], v[136:139], v[152:155], v[216:219]
    s_add_u32 m0, s83, 72960
    v_mfma_f32_16x16x32_bf16 v[220:223], v[140:143], v[152:155], v[220:223]
    ds_read_b128 v[152:155], v9 offset:45056
    buffer_load_dwordx4 v22, s[12:15], s80 offen offset:768 lds
    v_mfma_f32_16x16x32_bf16 v[232:235], v[136:139], v[156:159], v[232:235]
    v_mfma_f32_16x16x32_bf16 v[236:239], v[140:143], v[156:159], v[236:239]
    ds_read_b128 v[156:159], v9 offset:47104
    v_mfma_f32_16x16x32_bf16 v[248:251], v[136:139], v[160:163], v[248:251]
    v_mfma_f32_16x16x32_bf16 v[252:255], v[140:143], v[160:163], v[252:255]
    ds_read_b128 v[160:163], v9 offset:49152
    s_lshl2_add_u32 s3, s36, s98
    s_add_u32 s3, s3, s36
    buffer_load_dwordx4 v[68:71], v4, s[16:19], s3 offen sc1
    s_waitcnt lgkmcnt(4)
    v_mfma_f32_16x16x32_bf16 v[176:179], v[128:131], v[144:147], v[176:179]
    ds_read_b64_tr_b16 v[136:137], v18 offset:12288
    v_mfma_f32_16x16x32_bf16 v[180:183], v[132:135], v[144:147], v[180:183]
    ds_read_b64_tr_b16 v[138:139], v18 offset:12800
    s_waitcnt lgkmcnt(5)
    v_mfma_f32_16x16x32_bf16 v[192:195], v[128:131], v[148:151], v[192:195]
    ds_read_b64_tr_b16 v[140:141], v19 offset:12288
    v_mfma_f32_16x16x32_bf16 v[196:199], v[132:135], v[148:151], v[196:199]
    ds_read_b64_tr_b16 v[142:143], v19 offset:12800
    buffer_load_dwordx4 v[72:75], v4, s[16:19], s3 offen offset:1024 sc1
    s_waitcnt lgkmcnt(6)
    v_mfma_f32_16x16x32_bf16 v[208:211], v[128:131], v[152:155], v[208:211]
    v_mfma_f32_16x16x32_bf16 v[212:215], v[132:135], v[152:155], v[212:215]
    s_waitcnt lgkmcnt(5)
    v_mfma_f32_16x16x32_bf16 v[224:227], v[128:131], v[156:159], v[224:227]
    v_mfma_f32_16x16x32_bf16 v[228:231], v[132:135], v[156:159], v[228:231]
    buffer_load_dwordx4 v[76:79], v4, s[16:19], s3 offen offset:2048 sc1
    s_waitcnt lgkmcnt(4)
    v_mfma_f32_16x16x32_bf16 v[240:243], v[128:131], v[160:163], v[240:243]
    v_mfma_f32_16x16x32_bf16 v[244:247], v[132:135], v[160:163], v[244:247]
    s_waitcnt vmcnt(8) lgkmcnt(0)
    s_barrier
    v_mfma_f32_16x16x32_bf16 v[184:187], v[136:139], v[144:147], v[184:187]
    ds_read_b64_tr_b16 v[128:129], v16 offset:16384
    ds_read_b64_tr_b16 v[130:131], v16 offset:16896
    v_mfma_f32_16x16x32_bf16 v[188:191], v[140:143], v[144:147], v[188:191]
    ds_read_b64_tr_b16 v[132:133], v17 offset:16384
    s_add_u32 m0, s83, 8192
    ds_read_b64_tr_b16 v[134:135], v17 offset:16896
    ds_read_b128 v[144:147], v12 offset:0
    buffer_load_dwordx4 v20, s[4:7], s81 offen lds
    v_mfma_f32_16x16x32_bf16 v[200:203], v[136:139], v[148:151], v[200:203]
    v_mfma_f32_16x16x32_bf16 v[204:207], v[140:143], v[148:151], v[204:207]
    ds_read_b128 v[148:151], v12 offset:2048
    v_mfma_f32_16x16x32_bf16 v[216:219], v[136:139], v[152:155], v[216:219]
    s_add_u32 m0, s83, 16384
    v_mfma_f32_16x16x32_bf16 v[220:223], v[140:143], v[152:155], v[220:223]
    ds_read_b128 v[152:155], v12 offset:4096
    buffer_load_dwordx4 v20, s[8:11], s81 offen lds
    s_add_u32 s81, s81, 221184
    v_mfma_f32_16x16x32_bf16 v[232:235], v[136:139], v[156:159], v[232:235]
    v_mfma_f32_16x16x32_bf16 v[236:239], v[140:143], v[156:159], v[236:239]
    ds_read_b128 v[156:159], v12 offset:6144
    v_mfma_f32_16x16x32_bf16 v[248:251], v[136:139], v[160:163], v[248:251]
    s_add_u32 m0, s83, 81024
    v_mfma_f32_16x16x32_bf16 v[252:255], v[140:143], v[160:163], v[252:255]
    ds_read_b128 v[160:163], v12 offset:8192
    buffer_load_dwordx4 v22, s[12:15], s76 offen offset:896 lds
    s_waitcnt lgkmcnt(4)
    v_mfma_f32_16x16x32_bf16 v[176:179], v[128:131], v[144:147], v[176:179]
    ds_read_b64_tr_b16 v[136:137], v16 offset:24576
    v_mfma_f32_16x16x32_bf16 v[180:183], v[132:135], v[144:147], v[180:183]
    ds_read_b64_tr_b16 v[138:139], v16 offset:25088
    s_waitcnt lgkmcnt(5)
    v_mfma_f32_16x16x32_bf16 v[192:195], v[128:131], v[148:151], v[192:195]
    ds_read_b64_tr_b16 v[140:141], v17 offset:24576
    s_add_u32 m0, s83, 89216
    v_mfma_f32_16x16x32_bf16 v[196:199], v[132:135], v[148:151], v[196:199]
    ds_read_b64_tr_b16 v[142:143], v17 offset:25088
    buffer_load_dwordx4 v22, s[12:15], s77 offen offset:896 lds
    s_waitcnt lgkmcnt(6)
    v_mfma_f32_16x16x32_bf16 v[208:211], v[128:131], v[152:155], v[208:211]
    v_mfma_f32_16x16x32_bf16 v[212:215], v[132:135], v[152:155], v[212:215]
    s_waitcnt lgkmcnt(5)
    s_add_u32 m0, s83, 97408
    v_mfma_f32_16x16x32_bf16 v[224:227], v[128:131], v[156:159], v[224:227]
    v_mfma_f32_16x16x32_bf16 v[228:231], v[132:135], v[156:159], v[228:231]
    buffer_load_dwordx4 v22, s[12:15], s78 offen offset:896 lds
    s_waitcnt lgkmcnt(4)
    v_mfma_f32_16x16x32_bf16 v[240:243], v[128:131], v[160:163], v[240:243]
    v_mfma_f32_16x16x32_bf16 v[244:247], v[132:135], v[160:163], v[244:247]
    s_waitcnt lgkmcnt(0)
    s_bitcmp1_b32 s68, 2
    s_cbranch_scc0 L_cs22
    v_mfma_f32_16x16x32_bf16 v[52:55], v[24:27], v[128:131], v[52:55]
    v_mfma_f32_16x16x32_bf16 v[164:167], v[24:27], v[132:135], v[164:167]
    v_mfma_f32_16x16x32_bf16 v[168:171], v[24:27], v[136:139], v[168:171]
    v_mfma_f32_16x16x32_bf16 v[172:175], v[24:27], v[140:143], v[172:175]
L_cs22:
    v_mfma_f32_16x16x32_bf16 v[184:187], v[136:139], v[144:147], v[184:187]
    ds_read_b64_tr_b16 v[128:129], v18 offset:20480
    ds_read_b64_tr_b16 v[130:131], v18 offset:20992
    v_mfma_f32_16x16x32_bf16 v[188:191], v[140:143], v[144:147], v[188:191]
    ds_read_b64_tr_b16 v[132:133], v19 offset:20480
    s_add_u32 m0, s83, 105600
    ds_read_b64_tr_b16 v[134:135], v19 offset:20992
    ds_read_b128 v[144:147], v13 offset:0
    buffer_load_dwordx4 v22, s[12:15], s79 offen offset:896 lds
    v_mfma_f32_16x16x32_bf16 v[200:203], v[136:139], v[148:151], v[200:203]
    v_mfma_f32_16x16x32_bf16 v[204:207], v[140:143], v[148:151], v[204:207]
    ds_read_b128 v[148:151], v13 offset:2048
    v_mfma_f32_16x16x32_bf16 v[216:219], v[136:139], v[152:155], v[216:219]
    s_add_u32 m0, s83, 113792
    v_mfma_f32_16x16x32_bf16 v[220:223], v[140:143], v[152:155], v[220:223]
    ds_read_b128 v[152:155], v13 offset:4096
    buffer_load_dwordx4 v22, s[12:15], s80 offen offset:896 lds
    v_mfma_f32_16x16x32_bf16 v[232:235], v[136:139], v[156:159], v[232:235]
    v_mfma_f32_16x16x32_bf16 v[236:239], v[140:143], v[156:159], v[236:239]
    ds_read_b128 v[156:159], v13 offset:6144
    v_mfma_f32_16x16x32_bf16 v[248:251], v[136:139], v[160:163], v[248:251]
    v_mfma_f32_16x16x32_bf16 v[252:255], v[140:143], v[160:163], v[252:255]
    ds_read_b128 v[160:163], v13 offset:8192
    buffer_load_dwordx4 v[80:83], v4, s[16:19], s3 offen offset:3072 sc1
    s_waitcnt lgkmcnt(4)
    v_mfma_f32_16x16x32_bf16 v[176:179], v[128:131], v[144:147], v[176:179]
    ds_read_b64_tr_b16 v[136:137], v18 offset:28672
    v_mfma_f32_16x16x32_bf16 v[180:183], v[132:135], v[144:147], v[180:183]
    ds_read_b64_tr_b16 v[138:139], v18 offset:29184
    s_waitcnt lgkmcnt(5)
    v_mfma_f32_16x16x32_bf16 v[192:195], v[128:131], v[148:151], v[192:195]
    ds_read_b64_tr_b16 v[140:141], v19 offset:28672
    v_mfma_f32_16x16x32_bf16 v[196:199], v[132:135], v[148:151], v[196:199]
    ds_read_b64_tr_b16 v[142:143], v19 offset:29184
    buffer_load_dwordx4 v[84:87], v5, s[16:19], s3 offen sc1
    s_waitcnt lgkmcnt(6)
    v_mfma_f32_16x16x32_bf16 v[208:211], v[128:131], v[152:155], v[208:211]
    v_mfma_f32_16x16x32_bf16 v[212:215], v[132:135], v[152:155], v[212:215]
    s_waitcnt lgkmcnt(5)
    v_mfma_f32_16x16x32_bf16 v[224:227], v[128:131], v[156:159], v[224:227]
    v_mfma_f32_16x16x32_bf16 v[228:231], v[132:135], v[156:159], v[228:231]
    s_lshl2_add_u32 s3, s37, s98
    s_add_u32 s3, s3, s37
    buffer_load_dwordx4 v[88:91], v4, s[16:19], s3 offen sc1
    s_waitcnt lgkmcnt(4)
    v_mfma_f32_16x16x32_bf16 v[240:243], v[128:131], v[160:163], v[240:243]
    v_mfma_f32_16x16x32_bf16 v[244:247], v[132:135], v[160:163], v[244:247]
    s_waitcnt vmcnt(8) lgkmcnt(0)
    s_barrier
    v_mfma_f32_16x16x32_bf16 v[184:187], v[136:139], v[144:147], v[184:187]
    ds_read_b64_tr_b16 v[128:129], v16 offset:0
    ds_read_b64_tr_b16 v[130:131], v16 offset:512
    v_mfma_f32_16x16x32_bf16 v[188:191], v[140:143], v[144:147], v[188:191]
    ds_read_b64_tr_b16 v[132:133], v17 offset:0
    s_add_u32 m0, s83, 24576
    ds_read_b64_tr_b16 v[134:135], v17 offset:512
    ds_read_b128 v[144:147], v8 offset:0
    buffer_load_dwordx4 v20, s[4:7], s81 offen lds
    v_mfma_f32_16x16x32_bf16 v[200:203], v[136:139], v[148:151], v[200:203]
    v_mfma_f32_16x16x32_bf16 v[204:207], v[140:143], v[148:151], v[204:207]
    ds_read_b128 v[148:151], v8 offset:2048
    v_mfma_f32_16x16x32_bf16 v[216:219], v[136:139], v[152:155], v[216:219]
    s_add_u32 m0, s83, 32768
    v_mfma_f32_16x16x32_bf16 v[220:223], v[140:143], v[152:155], v[220:223]
    ds_read_b128 v[152:155], v8 offset:4096
    buffer_load_dwordx4 v20, s[8:11], s81 offen lds
    s_add_u32 s81, s81, 221184
    v_mfma_f32_16x16x32_bf16 v[232:235], v[136:139], v[156:159], v[232:235]
    v_mfma_f32_16x16x32_bf16 v[236:239], v[140:143], v[156:159], v[236:239]
    ds_read_b128 v[156:159], v8 offset:6144
    v_mfma_f32_16x16x32_bf16 v[248:251], v[136:139], v[160:163], v[248:251]
    s_add_u32 m0, s83, 121856
    v_mfma_f32_16x16x32_bf16 v[252:255], v[140:143], v[160:163], v[252:255]
    ds_read_b128 v[160:163], v8 offset:8192
    buffer_load_dwordx4 v22, s[12:15], s76 offen offset:1024 lds
    s_waitcnt lgkmcnt(4)
    v_mfma_f32_16x16x32_bf16 v[176:179], v[128:131], v[144:147], v[176:179]
    ds_read_b64_tr_b16 v[136:137], v16 offset:8192
    v_mfma_f32_16x16x32_bf16 v[180:183], v[132:135], v[144:147], v[180:183]
    ds_read_b64_tr_b16 v[138:139], v16 offset:8704
    s_waitcnt lgkmcnt(5)
    v_mfma_f32_16x16x32_bf16 v[192:195], v[128:131], v[148:151], v[192:195]
    ds_read_b64_tr_b16 v[140:141], v17 offset:8192
    s_add_u32 m0, s83, 130048
    v_mfma_f32_16x16x32_bf16 v[196:199], v[132:135], v[148:151], v[196:199]
    ds_read_b64_tr_b16 v[142:143], v17 offset:8704
    buffer_load_dwordx4 v22, s[12:15], s77 offen offset:1024 lds
    s_waitcnt lgkmcnt(6)
    v_mfma_f32_16x16x32_bf16 v[208:211], v[128:131], v[152:155], v[208:211]
    v_mfma_f32_16x16x32_bf16 v[212:215], v[132:135], v[152:155], v[212:215]
    s_waitcnt lgkmcnt(5)
    s_add_u32 m0, s83, 138240
    v_mfma_f32_16x16x32_bf16 v[224:227], v[128:131], v[156:159], v[224:227]
    v_mfma_f32_16x16x32_bf16 v[228:231], v[132:135], v[156:159], v[228:231]
    buffer_load_dwordx4 v22, s[12:15], s78 offen offset:1024 lds
    s_waitcnt lgkmcnt(4)
    v_mfma_f32_16x16x32_bf16 v[240:243], v[128:131], v[160:163], v[240:243]
    v_mfma_f32_16x16x32_bf16 v[244:247], v[132:135], v[160:163], v[244:247]
    s_waitcnt lgkmcnt(0)
    s_bitcmp1_b32 s68, 2
    s_cbranch_scc1 L_cs23
    v_mfma_f32_16x16x32_bf16 v[52:55], v[24:27], v[128:131], v[52:55]
    v_mfma_f32_16x16x32_bf16 v[164:167], v[24:27], v[132:135], v[164:167]
    v_mfma_f32_16x16x32_bf16 v[168:171], v[24:27], v[136:139], v[168:171]
    v_mfma_f32_16x16x32_bf16 v[172:175], v[24:27], v[140:143], v[172:175]
L_cs23:
    v_mfma_f32_16x16x32_bf16 v[184:187], v[136:139], v[144:147], v[184:187]
    ds_read_b64_tr_b16 v[128:129], v18 offset:4096
    ds_read_b64_tr_b16 v[130:131], v18 offset:4608
    v_mfma_f32_16x16x32_bf16 v[188:191], v[140:143], v[144:147], v[188:191]
    ds_read_b64_tr_b16 v[132:133], v19 offset:4096
    s_add_u32 m0, s83, 146432
    ds_read_b64_tr_b16 v[134:135], v19 offset:4608
    ds_read_b128 v[144:147], v9 offset:0
    buffer_load_dwordx4 v22, s[12:15], s79 offen offset:1024 lds
    v_mfma_f32_16x16x32_bf16 v[200:203], v[136:139], v[148:151], v[200:203]
    v_mfma_f32_16x16x32_bf16 v[204:207], v[140:143], v[148:151], v[204:207]
    ds_read_b128 v[148:151], v9 offset:2048
    v_mfma_f32_16x16x32_bf16 v[216:219], v[136:139], v[152:155], v[216:219]
    s_add_u32 m0, s83, 154624
    v_mfma_f32_16x16x32_bf16 v[220:223], v[140:143], v[152:155], v[220:223]
    ds_read_b128 v[152:155], v9 offset:4096
    buffer_load_dwordx4 v22, s[12:15], s80 offen offset:1024 lds
    v_mfma_f32_16x16x32_bf16 v[232:235], v[136:139], v[156:159], v[232:235]
    v_mfma_f32_16x16x32_bf16 v[236:239], v[140:143], v[156:159], v[236:239]
    ds_read_b128 v[156:159], v9 offset:6144
    v_mfma_f32_16x16x32_bf16 v[248:251], v[136:139], v[160:163], v[248:251]
    v_mfma_f32_16x16x32_bf16 v[252:255], v[140:143], v[160:163], v[252:255]
    ds_read_b128 v[160:163], v9 offset:8192
    buffer_load_dwordx4 v[92:95], v4, s[16:19], s3 offen offset:1024 sc1
    s_waitcnt lgkmcnt(4)
    v_mfma_f32_16x16x32_bf16 v[176:179], v[128:131], v[144:147], v[176:179]
    ds_read_b64_tr_b16 v[136:137], v18 offset:12288
    v_mfma_f32_16x16x32_bf16 v[180:183], v[132:135], v[144:147], v[180:183]
    ds_read_b64_tr_b16 v[138:139], v18 offset:12800
    s_waitcnt lgkmcnt(5)
    v_mfma_f32_16x16x32_bf16 v[192:195], v[128:131], v[148:151], v[192:195]
    ds_read_b64_tr_b16 v[140:141], v19 offset:12288
    v_mfma_f32_16x16x32_bf16 v[196:199], v[132:135], v[148:151], v[196:199]
    ds_read_b64_tr_b16 v[142:143], v19 offset:12800
    buffer_load_dwordx4 v[96:99], v4, s[16:19], s3 offen offset:2048 sc1
    s_waitcnt lgkmcnt(6)
    v_mfma_f32_16x16x32_bf16 v[208:211], v[128:131], v[152:155], v[208:211]
    v_mfma_f32_16x16x32_bf16 v[212:215], v[132:135], v[152:155], v[212:215]
    s_waitcnt lgkmcnt(5)
    v_mfma_f32_16x16x32_bf16 v[224:227], v[128:131], v[156:159], v[224:227]
    v_mfma_f32_16x16x32_bf16 v[228:231], v[132:135], v[156:159], v[228:231]
    buffer_load_dwordx4 v[100:103], v4, s[16:19], s3 offen offset:3072 sc1
    s_waitcnt lgkmcnt(4)
    v_mfma_f32_16x16x32_bf16 v[240:243], v[128:131], v[160:163], v[240:243]
    v_mfma_f32_16x16x32_bf16 v[244:247], v[132:135], v[160:163], v[244:247]
    s_waitcnt vmcnt(8) lgkmcnt(0)
    s_barrier
    v_mfma_f32_16x16x32_bf16 v[184:187], v[136:139], v[144:147], v[184:187]
    ds_read_b64_tr_b16 v[128:129], v16 offset:16384
    ds_read_b64_tr_b16 v[130:131], v16 offset:16896
    v_mfma_f32_16x16x32_bf16 v[188:191], v[140:143], v[144:147], v[188:191]
    ds_read_b64_tr_b16 v[132:133], v17 offset:16384
    s_add_u32 m0, s83, 8192
    ds_read_b64_tr_b16 v[134:135], v17 offset:16896
    ds_read_b128 v[144:147], v8 offset:40960
    buffer_load_dwordx4 v20, s[4:7], s81 offen lds
    v_mfma_f32_16x16x32_bf16 v[200:203], v[136:139], v[148:151], v[200:203]
    v_mfma_f32_16x16x32_bf16 v[204:207], v[140:143], v[148:151], v[204:207]
    ds_read_b128 v[148:151], v8 offset:43008
    v_mfma_f32_16x16x32_bf16 v[216:219], v[136:139], v[152:155], v[216:219]
    s_add_u32 m0, s83, 16384
    v_mfma_f32_16x16x32_bf16 v[220:223], v[140:143], v[152:155], v[220:223]
    ds_read_b128 v[152:155], v8 offset:45056
    buffer_load_dwordx4 v20, s[8:11], s81 offen lds
    s_add_u32 s81, s81, 221184
    v_mfma_f32_16x16x32_bf16 v[232:235], v[136:139], v[156:159], v[232:235]
    v_mfma_f32_16x16x32_bf16 v[236:239], v[140:143], v[156:159], v[236:239]
    ds_read_b128 v[156:159], v8 offset:47104
    v_mfma_f32_16x16x32_bf16 v[248:251], v[136:139], v[160:163], v[248:251]
    s_add_u32 m0, s83, 39808
    v_mfma_f32_16x16x32_bf16 v[252:255], v[140:143], v[160:163], v[252:255]
    ds_read_b128 v[160:163], v8 offset:49152
    buffer_load_dwordx4 v22, s[12:15], s76 offen offset:1152 lds
    s_waitcnt lgkmcnt(4)
    v_mfma_f32_16x16x32_bf16 v[176:179], v[128:131], v[144:147], v[176:179]
    ds_read_b64_tr_b16 v[136:137], v16 offset:24576
    v_mfma_f32_16x16x32_bf16 v[180:183], v[132:135], v[144:147], v[180:183]
    ds_read_b64_tr_b16 v[138:139], v16 offset:25088
    s_waitcnt lgkmcnt(5)
    v_mfma_f32_16x16x32_bf16 v[192:195], v[128:131], v[148:151], v[192:195]
    ds_read_b64_tr_b16 v[140:141], v17 offset:24576
    s_add_u32 m0, s83, 48000
    v_mfma_f32_16x16x32_bf16 v[196:199], v[132:135], v[148:151], v[196:199]
    ds_read_b64_tr_b16 v[142:143], v17 offset:25088
    buffer_load_dwordx4 v22, s[12:15], s77 offen offset:1152 lds
    s_waitcnt lgkmcnt(6)
    v_mfma_f32_16x16x32_bf16 v[208:211], v[128:131], v[152:155], v[208:211]
    v_mfma_f32_16x16x32_bf16 v[212:215], v[132:135], v[152:155], v[212:215]
    s_waitcnt lgkmcnt(5)
    s_add_u32 m0, s83, 56192
    v_mfma_f32_16x16x32_bf16 v[224:227], v[128:131], v[156:159], v[224:227]
    v_mfma_f32_16x16x32_bf16 v[228:231], v[132:135], v[156:159], v[228:231]
    buffer_load_dwordx4 v22, s[12:15], s78 offen offset:1152 lds
    s_waitcnt lgkmcnt(4)
    v_mfma_f32_16x16x32_bf16 v[240:243], v[128:131], v[160:163], v[240:243]
    v_mfma_f32_16x16x32_bf16 v[244:247], v[132:135], v[160:163], v[244:247]
    s_waitcnt lgkmcnt(0)
    s_bitcmp1_b32 s68, 2
    s_cbranch_scc0 L_cs24
    v_mfma_f32_16x16x32_bf16 v[52:55], v[24:27], v[128:131], v[52:55]
    v_mfma_f32_16x16x32_bf16 v[164:167], v[24:27], v[132:135], v[164:167]
    v_mfma_f32_16x16x32_bf16 v[168:171], v[24:27], v[136:139], v[168:171]
    v_mfma_f32_16x16x32_bf16 v[172:175], v[24:27], v[140:143], v[172:175]
L_cs24:
    v_mfma_f32_16x16x32_bf16 v[184:187], v[136:139], v[144:147], v[184:187]
    ds_read_b64_tr_b16 v[128:129], v18 offset:20480
    ds_read_b64_tr_b16 v[130:131], v18 offset:20992
    v_mfma_f32_16x16x32_bf16 v[188:191], v[140:143], v[144:147], v[188:191]
    ds_read_b64_tr_b16 v[132:133], v19 offset:20480
    s_add_u32 m0, s83, 64384
    ds_read_b64_tr_b16 v[134:135], v19 offset:20992
    ds_read_b128 v[144:147], v9 offset:40960
    buffer_load_dwordx4 v22, s[12:15], s79 offen offset:1152 lds
    v_mfma_f32_16x16x32_bf16 v[200:203], v[136:139], v[148:151], v[200:203]
    v_mfma_f32_16x16x32_bf16 v[204:207], v[140:143], v[148:151], v[204:207]
    ds_read_b128 v[148:151], v9 offset:43008
    v_mfma_f32_16x16x32_bf16 v[216:219], v[136:139], v[152:155], v[216:219]
    s_add_u32 m0, s83, 72576
    v_mfma_f32_16x16x32_bf16 v[220:223], v[140:143], v[152:155], v[220:223]
    ds_read_b128 v[152:155], v9 offset:45056
    buffer_load_dwordx4 v22, s[12:15], s80 offen offset:1152 lds
    v_mfma_f32_16x16x32_bf16 v[232:235], v[136:139], v[156:159], v[232:235]
    v_mfma_f32_16x16x32_bf16 v[236:239], v[140:143], v[156:159], v[236:239]
    ds_read_b128 v[156:159], v9 offset:47104
    v_mfma_f32_16x16x32_bf16 v[248:251], v[136:139], v[160:163], v[248:251]
    v_mfma_f32_16x16x32_bf16 v[252:255], v[140:143], v[160:163], v[252:255]
    ds_read_b128 v[160:163], v9 offset:49152
    buffer_load_dwordx4 v[104:107], v5, s[16:19], s3 offen sc1
    s_waitcnt lgkmcnt(4)
    v_mfma_f32_16x16x32_bf16 v[176:179], v[128:131], v[144:147], v[176:179]
    ds_read_b64_tr_b16 v[136:137], v18 offset:28672
    v_mfma_f32_16x16x32_bf16 v[180:183], v[132:135], v[144:147], v[180:183]
    ds_read_b64_tr_b16 v[138:139], v18 offset:29184
    s_waitcnt lgkmcnt(5)
    v_mfma_f32_16x16x32_bf16 v[192:195], v[128:131], v[148:151], v[192:195]
    ds_read_b64_tr_b16 v[140:141], v19 offset:28672
    v_mfma_f32_16x16x32_bf16 v[196:199], v[132:135], v[148:151], v[196:199]
    ds_read_b64_tr_b16 v[142:143], v19 offset:29184
    s_lshl2_add_u32 s3, s42, s98
    s_add_u32 s3, s3, s42
    buffer_load_dwordx4 v[108:111], v4, s[16:19], s3 offen sc1
    s_waitcnt lgkmcnt(6)
    v_mfma_f32_16x16x32_bf16 v[208:211], v[128:131], v[152:155], v[208:211]
    v_mfma_f32_16x16x32_bf16 v[212:215], v[132:135], v[152:155], v[212:215]
    s_waitcnt lgkmcnt(5)
    v_mfma_f32_16x16x32_bf16 v[224:227], v[128:131], v[156:159], v[224:227]
    v_mfma_f32_16x16x32_bf16 v[228:231], v[132:135], v[156:159], v[228:231]
    buffer_load_dwordx4 v[112:115], v4, s[16:19], s3 offen offset:1024 sc1
    s_waitcnt lgkmcnt(4)
    v_mfma_f32_16x16x32_bf16 v[240:243], v[128:131], v[160:163], v[240:243]
    v_mfma_f32_16x16x32_bf16 v[244:247], v[132:135], v[160:163], v[244:247]
    s_waitcnt vmcnt(8) lgkmcnt(0)
    s_barrier
    v_mfma_f32_16x16x32_bf16 v[184:187], v[136:139], v[144:147], v[184:187]
    ds_read_b64_tr_b16 v[128:129], v16 offset:0
    ds_read_b64_tr_b16 v[130:131], v16 offset:512
    v_mfma_f32_16x16x32_bf16 v[188:191], v[140:143], v[144:147], v[188:191]
    ds_read_b64_tr_b16 v[132:133], v17 offset:0
    s_add_u32 m0, s83, 24576
    ds_read_b64_tr_b16 v[134:135], v17 offset:512
    ds_read_b128 v[144:147], v12 offset:0
    buffer_load_dwordx4 v20, s[4:7], s81 offen lds
    v_mfma_f32_16x16x32_bf16 v[200:203], v[136:139], v[148:151], v[200:203]
    v_mfma_f32_16x16x32_bf16 v[204:207], v[140:143], v[148:151], v[204:207]
    ds_read_b128 v[148:151], v12 offset:2048
    v_mfma_f32_16x16x32_bf16 v[216:219], v[136:139], v[152:155], v[216:219]
    s_add_u32 m0, s83, 32768
    v_mfma_f32_16x16x32_bf16 v[220:223], v[140:143], v[152:155], v[220:223]
    ds_read_b128 v[152:155], v12 offset:4096
    buffer_load_dwordx4 v20, s[8:11], s81 offen lds
    v_mfma_f32_16x16x32_bf16 v[232:235], v[136:139], v[156:159], v[232:235]
    v_mfma_f32_16x16x32_bf16 v[236:239], v[140:143], v[156:159], v[236:239]
    ds_read_b128 v[156:159], v12 offset:6144
    v_mfma_f32_16x16x32_bf16 v[248:251], v[136:139], v[160:163], v[248:251]
    v_mfma_f32_16x16x32_bf16 v[252:255], v[140:143], v[160:163], v[252:255]
    ds_read_b128 v[160:163], v12 offset:8192
    buffer_load_dwordx4 v[32:35], v4, s[16:19], s47 offen sc1
    s_waitcnt lgkmcnt(4)
    v_mfma_f32_16x16x32_bf16 v[176:179], v[128:131], v[144:147], v[176:179]
    ds_read_b64_tr_b16 v[136:137], v16 offset:8192
    v_mfma_f32_16x16x32_bf16 v[180:183], v[132:135], v[144:147], v[180:183]
    ds_read_b64_tr_b16 v[138:139], v16 offset:8704
    s_waitcnt lgkmcnt(5)
    v_mfma_f32_16x16x32_bf16 v[192:195], v[128:131], v[148:151], v[192:195]
    ds_read_b64_tr_b16 v[140:141], v17 offset:8192
    v_mfma_f32_16x16x32_bf16 v[196:199], v[132:135], v[148:151], v[196:199]
    ds_read_b64_tr_b16 v[142:143], v17 offset:8704
    buffer_load_dwordx4 v[48:51], v59, s[16:19], s47 offen offset:1024 sc1
    s_waitcnt lgkmcnt(6)
    v_mfma_f32_16x16x32_bf16 v[208:211], v[128:131], v[152:155], v[208:211]
    v_mfma_f32_16x16x32_bf16 v[212:215], v[132:135], v[152:155], v[212:215]
    s_waitcnt lgkmcnt(5)
    v_mfma_f32_16x16x32_bf16 v[224:227], v[128:131], v[156:159], v[224:227]
    v_mfma_f32_16x16x32_bf16 v[228:231], v[132:135], v[156:159], v[228:231]
    buffer_load_dwordx4 v[116:119], v4, s[16:19], s3 offen offset:2048 sc1
    s_waitcnt lgkmcnt(4)
    v_mfma_f32_16x16x32_bf16 v[240:243], v[128:131], v[160:163], v[240:243]
    v_mfma_f32_16x16x32_bf16 v[244:247], v[132:135], v[160:163], v[244:247]
    s_waitcnt lgkmcnt(0)
    s_bitcmp1_b32 s68, 2
    s_cbranch_scc1 L_cs25
    v_mfma_f32_16x16x32_bf16 v[52:55], v[24:27], v[128:131], v[52:55]
    v_mfma_f32_16x16x32_bf16 v[164:167], v[24:27], v[132:135], v[164:167]
    v_mfma_f32_16x16x32_bf16 v[168:171], v[24:27], v[136:139], v[168:171]
    v_mfma_f32_16x16x32_bf16 v[172:175], v[24:27], v[140:143], v[172:175]
L_cs25:
    v_mfma_f32_16x16x32_bf16 v[184:187], v[136:139], v[144:147], v[184:187]
    ds_read_b64_tr_b16 v[128:129], v18 offset:4096
    ds_read_b64_tr_b16 v[130:131], v18 offset:4608
    v_mfma_f32_16x16x32_bf16 v[188:191], v[140:143], v[144:147], v[188:191]
    ds_read_b64_tr_b16 v[132:133], v19 offset:4096
    ds_read_b64_tr_b16 v[134:135], v19 offset:4608
    ds_read_b128 v[144:147], v13 offset:0
    buffer_load_dwordx4 v[120:123], v4, s[16:19], s3 offen offset:3072 sc1
    v_mfma_f32_16x16x32_bf16 v[200:203], v[136:139], v[148:151], v[200:203]
    v_mfma_f32_16x16x32_bf16 v[204:207], v[140:143], v[148:151], v[204:207]
    ds_read_b128 v[148:151], v13 offset:2048
    v_mfma_f32_16x16x32_bf16 v[216:219], v[136:139], v[152:155], v[216:219]
    v_mfma_f32_16x16x32_bf16 v[220:223], v[140:143], v[152:155], v[220:223]
    ds_read_b128 v[152:155], v13 offset:4096
    buffer_load_dwordx4 v[124:127], v5, s[16:19], s3 offen sc1
    v_mfma_f32_16x16x32_bf16 v[232:235], v[136:139], v[156:159], v[232:235]
    v_mfma_f32_16x16x32_bf16 v[236:239], v[140:143], v[156:159], v[236:239]
    ds_read_b128 v[156:159], v13 offset:6144
    v_mfma_f32_16x16x32_bf16 v[248:251], v[136:139], v[160:163], v[248:251]
    v_mfma_f32_16x16x32_bf16 v[252:255], v[140:143], v[160:163], v[252:255]
    ds_read_b128 v[160:163], v13 offset:8192
    s_lshl2_add_u32 s3, s43, s98
    s_add_u32 s3, s3, s43
    s_add_u32 m0, s83, 81920
    s_nop 0
    buffer_load_dwordx4 v4, s[16:19], s3 offen sc1 lds
    s_waitcnt lgkmcnt(4)
    v_mfma_f32_16x16x32_bf16 v[176:179], v[128:131], v[144:147], v[176:179]
    ds_read_b64_tr_b16 v[136:137], v18 offset:12288
    v_mfma_f32_16x16x32_bf16 v[180:183], v[132:135], v[144:147], v[180:183]
    ds_read_b64_tr_b16 v[138:139], v18 offset:12800
    s_waitcnt lgkmcnt(5)
    v_mfma_f32_16x16x32_bf16 v[192:195], v[128:131], v[148:151], v[192:195]
    ds_read_b64_tr_b16 v[140:141], v19 offset:12288
    s_add_u32 m0, s83, 89088
    v_mfma_f32_16x16x32_bf16 v[196:199], v[132:135], v[148:151], v[196:199]
    ds_read_b64_tr_b16 v[142:143], v19 offset:12800
    buffer_load_dwordx4 v4, s[16:19], s3 offen offset:1024 sc1 lds
    s_waitcnt lgkmcnt(6)
    v_mfma_f32_16x16x32_bf16 v[208:211], v[128:131], v[152:155], v[208:211]
    v_mfma_f32_16x16x32_bf16 v[212:215], v[132:135], v[152:155], v[212:215]
    s_waitcnt lgkmcnt(5)
    s_add_u32 m0, s83, 96256
    v_mfma_f32_16x16x32_bf16 v[224:227], v[128:131], v[156:159], v[224:227]
    v_mfma_f32_16x16x32_bf16 v[228:231], v[132:135], v[156:159], v[228:231]
    buffer_load_dwordx4 v4, s[16:19], s3 offen offset:2048 sc1 lds
    s_waitcnt lgkmcnt(4)
    v_mfma_f32_16x16x32_bf16 v[240:243], v[128:131], v[160:163], v[240:243]
    v_mfma_f32_16x16x32_bf16 v[244:247], v[132:135], v[160:163], v[244:247]
    s_cmp_lg_u32 s68, 4
    s_cbranch_scc1 L_si26
    v_and_b32 v64, 7, v1
    v_lshlrev_b32 v64, 10, v64
    v_mov_b32_e64 v65, 0
    ds_write_b32 v64, v65 offset:512
    v_mov_b32_e64 v64, 0
    ds_write_b32 v65, v64 offset:4612
L_si26:
    s_waitcnt vmcnt(8) lgkmcnt(0)
    s_barrier
    v_mfma_f32_16x16x32_bf16 v[184:187], v[136:139], v[144:147], v[184:187]
    ds_read_b64_tr_b16 v[128:129], v16 offset:16384
    ds_read_b64_tr_b16 v[130:131], v16 offset:16896
    v_mfma_f32_16x16x32_bf16 v[188:191], v[140:143], v[144:147], v[188:191]
    ds_read_b64_tr_b16 v[132:133], v17 offset:16384
    s_add_u32 m0, s83, 103424
    ds_read_b64_tr_b16 v[134:135], v17 offset:16896
    ds_read_b128 v[144:147], v8 offset:0
    buffer_load_dwordx4 v4, s[16:19], s3 offen offset:3072 sc1 lds
    s_waitcnt vmcnt(7)
    v_mfma_f32_16x16x32_bf16 v[200:203], v[136:139], v[148:151], v[200:203]
    v_mfma_f32_16x16x32_bf16 v[204:207], v[140:143], v[148:151], v[204:207]
    ds_read_b128 v[148:151], v8 offset:2048
    v_mov_b32 v40, v32
    v_mov_b32 v41, v33
    v_mov_b32 v42, v34
    v_mfma_f32_16x16x32_bf16 v[216:219], v[136:139], v[152:155], v[216:219]
    s_add_u32 m0, s83, 114688
    v_mfma_f32_16x16x32_bf16 v[220:223], v[140:143], v[152:155], v[220:223]
    ds_read_b128 v[152:155], v8 offset:4096
    buffer_load_dwordx4 v5, s[16:19], s3 offen sc1 lds
    v_mov_b32 v43, v35
    v_permlane32_swap_b32 v32, v40
    v_mfma_f32_16x16x32_bf16 v[232:235], v[136:139], v[156:159], v[232:235]
    v_mfma_f32_16x16x32_bf16 v[236:239], v[140:143], v[156:159], v[236:239]
    ds_read_b128 v[156:159], v8 offset:6144
    v_permlane32_swap_b32 v33, v41
    v_permlane32_swap_b32 v34, v42
    v_permlane32_swap_b32 v35, v43
    v_mfma_f32_16x16x32_bf16 v[248:251], v[136:139], v[160:163], v[248:251]
    v_mfma_f32_16x16x32_bf16 v[252:255], v[140:143], v[160:163], v[252:255]
    ds_read_b128 v[160:163], v8 offset:8192
    s_lshl2_add_u32 s3, s44, s98
    s_add_u32 s3, s3, s44
    s_add_u32 m0, s83, 122880
    s_nop 0
    buffer_load_dwordx4 v4, s[16:19], s3 offen sc1 lds
    v_mov_b32 v36, v32
    v_mov_b32_e64 v37, v33
    s_waitcnt lgkmcnt(4)
    v_mfma_f32_16x16x32_bf16 v[176:179], v[128:131], v[144:147], v[176:179]
    ds_read_b64_tr_b16 v[136:137], v16 offset:24576
    v_mfma_f32_16x16x32_bf16 v[180:183], v[132:135], v[144:147], v[180:183]
    ds_read_b64_tr_b16 v[138:139], v16 offset:25088
    v_mov_b32 v38, v34
    v_mov_b32 v39, v35
    v_mov_b32 v44, v40
    s_waitcnt lgkmcnt(5)
    v_mfma_f32_16x16x32_bf16 v[192:195], v[128:131], v[148:151], v[192:195]
    ds_read_b64_tr_b16 v[140:141], v17 offset:24576
    s_add_u32 m0, s83, 130048
    v_mfma_f32_16x16x32_bf16 v[196:199], v[132:135], v[148:151], v[196:199]
    ds_read_b64_tr_b16 v[142:143], v17 offset:25088
    buffer_load_dwordx4 v4, s[16:19], s3 offen offset:1024 sc1 lds
    v_mov_b32 v45, v41
    v_mov_b32_e64 v46, v42
    s_waitcnt lgkmcnt(6)
    v_mfma_f32_16x16x32_bf16 v[208:211], v[128:131], v[152:155], v[208:211]
    v_mfma_f32_16x16x32_bf16 v[212:215], v[132:135], v[152:155], v[212:215]
    v_mov_b32 v47, v43
    v_permlane16_swap_b32 v32, v36
    v_permlane16_swap_b32 v33, v37
    s_waitcnt lgkmcnt(5)
    s_add_u32 m0, s83, 137216
    v_mfma_f32_16x16x32_bf16 v[224:227], v[128:131], v[156:159], v[224:227]
    v_mfma_f32_16x16x32_bf16 v[228:231], v[132:135], v[156:159], v[228:231]
    buffer_load_dwordx4 v4, s[16:19], s3 offen offset:2048 sc1 lds
    v_permlane16_swap_b32 v34, v38
    v_permlane16_swap_b32 v35, v39
    s_waitcnt lgkmcnt(4)
    v_mfma_f32_16x16x32_bf16 v[240:243], v[128:131], v[160:163], v[240:243]
    v_mfma_f32_16x16x32_bf16 v[244:247], v[132:135], v[160:163], v[244:247]
    v_permlane16_swap_b32 v40, v44
    v_permlane16_swap_b32 v41, v45
    v_permlane16_swap_b32 v42, v46
    s_waitcnt lgkmcnt(0)
    s_bitcmp1_b32 s68, 2
    s_cbranch_scc0 L_cs27
    v_mfma_f32_16x16x32_bf16 v[52:55], v[24:27], v[128:131], v[52:55]
    v_mfma_f32_16x16x32_bf16 v[164:167], v[24:27], v[132:135], v[164:167]
    v_mfma_f32_16x16x32_bf16 v[168:171], v[24:27], v[136:139], v[168:171]
    v_mfma_f32_16x16x32_bf16 v[172:175], v[24:27], v[140:143], v[172:175]
L_cs27:
    v_mfma_f32_16x16x32_bf16 v[184:187], v[136:139], v[144:147], v[184:187]
    ds_read_b64_tr_b16 v[128:129], v18 offset:20480
    ds_read_b64_tr_b16 v[130:131], v18 offset:20992
    v_mfma_f32_16x16x32_bf16 v[188:191], v[140:143], v[144:147], v[188:191]
    ds_read_b64_tr_b16 v[132:133], v19 offset:20480
    s_add_u32 m0, s83, 144384
    ds_read_b64_tr_b16 v[134:135], v19 offset:20992
    ds_read_b128 v[144:147], v9 offset:0
    buffer_load_dwordx4 v4, s[16:19], s3 offen offset:3072 sc1 lds
    v_permlane16_swap_b32 v43, v47
    v_mov_b32 v58, 1073741824
    v_lshlrev_b32 v2, 7, v1
    v_cmp_gt_u32 vcc, 1, v1
    s_nop 1
    v_cndmask_b32_e64 v2, v58, v2, vcc
    v_mfma_f32_16x16x32_bf16 v[200:203], v[136:139], v[148:151], v[200:203]
    v_mfma_f32_16x16x32_bf16 v[204:207], v[140:143], v[148:151], v[204:207]
    ds_read_b128 v[148:151], v9 offset:2048
    v_mfma_f32_16x16x32_bf16 v[216:219], v[136:139], v[152:155], v[216:219]
    s_add_u32 m0, s83, 155648
    v_mfma_f32_16x16x32_bf16 v[220:223], v[140:143], v[152:155], v[220:223]
    ds_read_b128 v[152:155], v9 offset:4096
    buffer_load_dwordx4 v5, s[16:19], s3 offen sc1 lds
    v_mfma_f32_16x16x32_bf16 v[232:235], v[136:139], v[156:159], v[232:235]
    v_mfma_f32_16x16x32_bf16 v[236:239], v[140:143], v[156:159], v[236:239]
    ds_read_b128 v[156:159], v9 offset:6144
    v_mfma_f32_16x16x32_bf16 v[248:251], v[136:139], v[160:163], v[248:251]
    v_mfma_f32_16x16x32_bf16 v[252:255], v[140:143], v[160:163], v[252:255]
    ds_read_b128 v[160:163], v9 offset:8192
    s_lshl2_add_u32 s3, s51, s98
    s_add_u32 s3, s3, s51
    s_add_u32 m0, s83, 7168
    s_nop 0
    buffer_load_dwordx4 v4, s[16:19], s3 offen offset:1024 sc1 lds
    s_waitcnt lgkmcnt(4)
    v_mfma_f32_16x16x32_bf16 v[176:179], v[128:131], v[144:147], v[176:179]
    ds_read_b64_tr_b16 v[136:137], v18 offset:28672
    v_mfma_f32_16x16x32_bf16 v[180:183], v[132:135], v[144:147], v[180:183]
    ds_read_b64_tr_b16 v[138:139], v18 offset:29184
    s_waitcnt lgkmcnt(5)
    v_mfma_f32_16x16x32_bf16 v[192:195], v[128:131], v[148:151], v[192:195]
    ds_read_b64_tr_b16 v[140:141], v19 offset:28672
    s_add_u32 m0, s83, 14336
    v_mfma_f32_16x16x32_bf16 v[196:199], v[132:135], v[148:151], v[196:199]
    ds_read_b64_tr_b16 v[142:143], v19 offset:29184
    buffer_load_dwordx4 v4, s[16:19], s3 offen offset:2048 sc1 lds
    s_waitcnt lgkmcnt(6)
    v_mfma_f32_16x16x32_bf16 v[208:211], v[128:131], v[152:155], v[208:211]
    v_mfma_f32_16x16x32_bf16 v[212:215], v[132:135], v[152:155], v[212:215]
    s_waitcnt lgkmcnt(5)
    v_mfma_f32_16x16x32_bf16 v[224:227], v[128:131], v[156:159], v[224:227]
    v_mfma_f32_16x16x32_bf16 v[228:231], v[132:135], v[156:159], v[228:231]
    s_waitcnt lgkmcnt(4)
    v_mfma_f32_16x16x32_bf16 v[240:243], v[128:131], v[160:163], v[240:243]
    v_mfma_f32_16x16x32_bf16 v[244:247], v[132:135], v[160:163], v[244:247]
    s_mov_b32 vcc_lo, 0xffff0000
    s_mov_b32 vcc_hi, 0xffff0000
    v_cndmask_b32 v28, v55, v167, vcc
    v_cndmask_b32 v29, v171, v175, vcc
    s_mov_b32 vcc_lo, 0
    s_mov_b32 vcc_hi, -1
    v_cndmask_b32_e64 v28, v28, v29, vcc
    v_cvt_pk_bf16_f32 v30, v28, v28
    v_lshlrev_b32 v30, 16, v30
    v_sub_f32 v30, v28, v30
    v_cvt_pk_bf16_f32 v29, v28, v30
    ds_write_b32 v57, v29
    s_waitcnt lgkmcnt(0)
    s_barrier
    ds_read_b32 v55, v56 offset:0
    ds_read_b32 v167, v56 offset:1024
    ds_read_b32 v171, v56 offset:2048
    ds_read_b32 v175, v56 offset:3072
    v_mfma_f32_16x16x32_bf16 v[184:187], v[136:139], v[144:147], v[184:187]
    v_mfma_f32_16x16x32_bf16 v[188:191], v[140:143], v[144:147], v[188:191]
    s_lshl2_add_u32 s3, s45, s98
    s_add_u32 s3, s3, s45
    s_add_u32 m0, s83, 40960
    s_nop 0
    buffer_load_dwordx4 v4, s[16:19], s3 offen sc1 lds
    s_add_u32 m0, s83, 48128
    v_mfma_f32_16x16x32_bf16 v[200:203], v[136:139], v[148:151], v[200:203]
    v_mfma_f32_16x16x32_bf16 v[204:207], v[140:143], v[148:151], v[204:207]
    buffer_load_dwordx4 v4, s[16:19], s3 offen offset:1024 sc1 lds
    s_add_u32 m0, s83, 55296
    v_mfma_f32_16x16x32_bf16 v[216:219], v[136:139], v[152:155], v[216:219]
    v_mfma_f32_16x16x32_bf16 v[220:223], v[140:143], v[152:155], v[220:223]
    buffer_load_dwordx4 v4, s[16:19], s3 offen offset:2048 sc1 lds
    s_add_u32 m0, s83, 62464
    v_mfma_f32_16x16x32_bf16 v[232:235], v[136:139], v[156:159], v[232:235]
    v_mfma_f32_16x16x32_bf16 v[236:239], v[140:143], v[156:159], v[236:239]
    buffer_load_dwordx4 v4, s[16:19], s3 offen offset:3072 sc1 lds
    s_add_u32 m0, s83, 73728
    v_mfma_f32_16x16x32_bf16 v[248:251], v[136:139], v[160:163], v[248:251]
    v_mfma_f32_16x16x32_bf16 v[252:255], v[140:143], v[160:163], v[252:255]
    buffer_load_dwordx4 v5, s[16:19], s3 offen sc1 lds
    s_setprio 3
    s_waitcnt lgkmcnt(0)
    v_mfma_f32_16x16x32_bf16 v[176:179], v[52:55], v[32:35], v[176:179]
    v_mfma_f32_16x16x32_bf16 v[180:183], v[164:167], v[32:35], v[180:183]
    v_mfma_f32_16x16x32_bf16 v[184:187], v[168:171], v[32:35], v[184:187]
    v_mfma_f32_16x16x32_bf16 v[188:191], v[172:175], v[32:35], v[188:191]
    v_mfma_f32_16x16x32_bf16 v[192:195], v[52:55], v[36:39], v[192:195]
    v_mfma_f32_16x16x32_bf16 v[196:199], v[164:167], v[36:39], v[196:199]
    v_mfma_f32_16x16x32_bf16 v[200:203], v[168:171], v[36:39], v[200:203]
    v_mfma_f32_16x16x32_bf16 v[204:207], v[172:175], v[36:39], v[204:207]
    s_lshl2_add_u32 s3, s46, s98
    s_add_u32 s3, s3, s46
    s_nop 0
    buffer_load_dwordx4 v[128:131], v4, s[16:19], s3 offen sc1
    buffer_load_dwordx4 v[132:135], v4, s[16:19], s3 offen offset:1024 sc1
    v_pk_mul_f32 v[8:9], v[176:177], v[176:177]
    v_pk_mul_f32 v[10:11], v[178:179], v[178:179]
    v_pk_mul_f32 v[12:13], v[180:181], v[180:181]
    v_pk_mul_f32 v[14:15], v[182:183], v[182:183]
    v_pk_fma_f32 v[8:9], v[32:33], v[8:9], v[32:33] op_sel:[1,0,0] op_sel_hi:[1,1,0]
    v_pk_fma_f32 v[10:11], v[32:33], v[10:11], v[32:33] op_sel:[1,0,0] op_sel_hi:[1,1,0]
    v_pk_fma_f32 v[12:13], v[32:33], v[12:13], v[32:33] op_sel:[1,0,0] op_sel_hi:[1,1,0]
    v_pk_fma_f32 v[14:15], v[32:33], v[14:15], v[32:33] op_sel:[1,0,0] op_sel_hi:[1,1,0]
    v_pk_mul_f32 v[8:9], v[8:9], v[176:177]
    v_pk_mul_f32 v[10:11], v[10:11], v[178:179]
    v_pk_mul_f32 v[12:13], v[12:13], v[180:181]
    v_pk_mul_f32 v[14:15], v[14:15], v[182:183]
    v_exp_f32_e64 v8, v8
    v_mfma_f32_16x16x32_bf16 v[208:211], v[52:55], v[40:43], v[208:211]
    v_exp_f32 v9, v9
    v_exp_f32 v10, v10
    v_mfma_f32_16x16x32_bf16 v[212:215], v[164:167], v[40:43], v[212:215]
    v_exp_f32 v11, v11
    v_exp_f32 v12, v12
    v_mfma_f32_16x16x32_bf16 v[216:219], v[168:171], v[40:43], v[216:219]
    v_exp_f32 v13, v13
    v_exp_f32 v14, v14
    v_mfma_f32_16x16x32_bf16 v[220:223], v[172:175], v[40:43], v[220:223]
    v_exp_f32_e64 v15, v15
    v_pk_mul_f32 v[16:17], v[176:177], v[184:185]
    v_pk_mul_f32 v[18:19], v[178:179], v[186:187]
    buffer_load_dwordx4 v[136:139], v4, s[16:19], s3 offen offset:2048 sc1
    v_pk_mul_f32 v[20:21], v[180:181], v[188:189]
    v_pk_mul_f32 v[22:23], v[182:183], v[190:191]
    v_pk_fma_f32 v[8:9], v[8:9], v[34:35], v[34:35] op_sel_hi:[1,0,0]
    v_pk_fma_f32 v[10:11], v[10:11], v[34:35], v[34:35] op_sel_hi:[1,0,0]
    v_pk_fma_f32 v[12:13], v[12:13], v[34:35], v[34:35] op_sel_hi:[1,0,0]
    v_pk_fma_f32 v[14:15], v[14:15], v[34:35], v[34:35] op_sel_hi:[1,0,0]
    v_rcp_f32_e64 v8, v8
    v_mfma_f32_16x16x32_bf16 v[224:227], v[52:55], v[44:47], v[224:227]
    v_rcp_f32 v9, v9
    v_rcp_f32 v10, v10
    v_mfma_f32_16x16x32_bf16 v[228:231], v[164:167], v[44:47], v[228:231]
    v_rcp_f32 v11, v11
    v_rcp_f32 v12, v12
    v_mfma_f32_16x16x32_bf16 v[232:235], v[168:171], v[44:47], v[232:235]
    v_rcp_f32 v13, v13
    v_rcp_f32 v14, v14
    v_mfma_f32_16x16x32_bf16 v[236:239], v[172:175], v[44:47], v[236:239]
    v_rcp_f32_e64 v15, v15
    v_pk_mul_f32 v[8:9], v[8:9], v[16:17]
    v_pk_mul_f32 v[10:11], v[10:11], v[18:19]
    v_pk_mul_f32 v[12:13], v[12:13], v[20:21]
    v_pk_mul_f32 v[14:15], v[14:15], v[22:23]
    v_cvt_pk_bf16_f32 v24, v8, v9
    v_mfma_f32_16x16x32_bf16 v[240:243], v[52:55], v[48:51], v[240:243]
    v_cvt_pk_bf16_f32 v25, v10, v11
    v_cvt_pk_bf16_f32 v26, v12, v13
    v_mfma_f32_16x16x32_bf16 v[244:247], v[164:167], v[48:51], v[244:247]
    v_cvt_pk_bf16_f32 v27, v14, v15
    buffer_load_dwordx4 v[140:143], v4, s[16:19], s3 offen offset:3072 sc1
    buffer_store_dwordx4 v[24:27], v4, s[16:19], s54 offen sc1
    v_pk_mul_f32 v[8:9], v[192:193], v[192:193]
    v_pk_mul_f32 v[10:11], v[194:195], v[194:195]
    v_pk_mul_f32 v[12:13], v[196:197], v[196:197]
    v_pk_mul_f32 v[14:15], v[198:199], v[198:199]
    v_pk_fma_f32 v[8:9], v[36:37], v[8:9], v[36:37] op_sel:[1,0,0] op_sel_hi:[1,1,0]
    v_pk_fma_f32 v[10:11], v[36:37], v[10:11], v[36:37] op_sel:[1,0,0] op_sel_hi:[1,1,0]
    v_pk_fma_f32 v[12:13], v[36:37], v[12:13], v[36:37] op_sel:[1,0,0] op_sel_hi:[1,1,0]
    v_pk_fma_f32 v[14:15], v[36:37], v[14:15], v[36:37] op_sel:[1,0,0] op_sel_hi:[1,1,0]
    v_pk_mul_f32 v[8:9], v[8:9], v[192:193]
    v_pk_mul_f32 v[10:11], v[10:11], v[194:195]
    v_pk_mul_f32 v[12:13], v[12:13], v[196:197]
    v_pk_mul_f32 v[14:15], v[14:15], v[198:199]
    v_exp_f32_e64 v8, v8
    v_mfma_f32_16x16x32_bf16 v[248:251], v[168:171], v[48:51], v[248:251]
    v_exp_f32 v9, v9
    v_exp_f32 v10, v10
    v_mfma_f32_16x16x32_bf16 v[252:255], v[172:175], v[48:51], v[252:255]
    v_exp_f32 v11, v11
    v_exp_f32 v12, v12
    v_exp_f32 v13, v13
    v_exp_f32 v14, v14
    v_exp_f32_e64 v15, v15
    v_pk_mul_f32 v[16:17], v[192:193], v[200:201]
    v_pk_mul_f32 v[18:19], v[194:195], v[202:203]
    buffer_load_dwordx4 v[144:147], v5, s[16:19], s3 offen sc1
    v_pk_mul_f32 v[20:21], v[196:197], v[204:205]
    v_pk_mul_f32 v[22:23], v[198:199], v[206:207]
    v_pk_fma_f32 v[8:9], v[8:9], v[38:39], v[38:39] op_sel_hi:[1,0,0]
    v_pk_fma_f32 v[10:11], v[10:11], v[38:39], v[38:39] op_sel_hi:[1,0,0]
    v_pk_fma_f32 v[12:13], v[12:13], v[38:39], v[38:39] op_sel_hi:[1,0,0]
    v_pk_fma_f32 v[14:15], v[14:15], v[38:39], v[38:39] op_sel_hi:[1,0,0]
    v_rcp_f32 v8, v8
    v_rcp_f32 v9, v9
    v_rcp_f32 v10, v10
    v_rcp_f32 v11, v11
    v_rcp_f32 v12, v12
    v_rcp_f32 v13, v13
    v_rcp_f32 v14, v14
    v_rcp_f32 v15, v15
    v_pk_mul_f32 v[8:9], v[8:9], v[16:17]
    v_pk_mul_f32 v[10:11], v[10:11], v[18:19]
    v_pk_mul_f32 v[12:13], v[12:13], v[20:21]
    v_pk_mul_f32 v[14:15], v[14:15], v[22:23]
    v_cvt_pk_bf16_f32 v28, v8, v9
    v_cvt_pk_bf16_f32 v29, v10, v11
    v_cvt_pk_bf16_f32 v30, v12, v13
    v_cvt_pk_bf16_f32 v31, v14, v15
    s_lshl2_add_u32 s3, s50, s98
    s_add_u32 s3, s3, s50
    buffer_load_dwordx4 v[148:151], v4, s[16:19], s3 offen sc1
    buffer_store_dwordx4 v[28:31], v4, s[16:19], s55 offen sc1
    v_pk_mul_f32 v[8:9], v[208:209], v[208:209]
    v_pk_mul_f32 v[10:11], v[210:211], v[210:211]
    v_pk_mul_f32 v[12:13], v[212:213], v[212:213]
    v_pk_mul_f32 v[14:15], v[214:215], v[214:215]
    v_pk_fma_f32 v[8:9], v[40:41], v[8:9], v[40:41] op_sel:[1,0,0] op_sel_hi:[1,1,0]
    v_pk_fma_f32 v[10:11], v[40:41], v[10:11], v[40:41] op_sel:[1,0,0] op_sel_hi:[1,1,0]
    v_pk_fma_f32 v[12:13], v[40:41], v[12:13], v[40:41] op_sel:[1,0,0] op_sel_hi:[1,1,0]
    v_pk_fma_f32 v[14:15], v[40:41], v[14:15], v[40:41] op_sel:[1,0,0] op_sel_hi:[1,1,0]
    v_pk_mul_f32 v[8:9], v[8:9], v[208:209]
    v_pk_mul_f32 v[10:11], v[10:11], v[210:211]
    v_pk_mul_f32 v[12:13], v[12:13], v[212:213]
    v_pk_mul_f32 v[14:15], v[14:15], v[214:215]
    v_exp_f32 v8, v8
    v_exp_f32 v9, v9
    v_exp_f32 v10, v10
    v_exp_f32 v11, v11
    v_exp_f32 v12, v12
    v_exp_f32 v13, v13
    v_exp_f32 v14, v14
    v_exp_f32 v15, v15
    v_pk_mul_f32 v[16:17], v[208:209], v[216:217]
    v_pk_mul_f32 v[18:19], v[210:211], v[218:219]
    buffer_load_dwordx4 v[152:155], v4, s[16:19], s3 offen offset:1024 sc1
    v_pk_mul_f32 v[20:21], v[212:213], v[220:221]
    v_pk_mul_f32 v[22:23], v[214:215], v[222:223]
    v_pk_fma_f32 v[8:9], v[8:9], v[42:43], v[42:43] op_sel_hi:[1,0,0]
    v_pk_fma_f32 v[10:11], v[10:11], v[42:43], v[42:43] op_sel_hi:[1,0,0]
    v_pk_fma_f32 v[12:13], v[12:13], v[42:43], v[42:43] op_sel_hi:[1,0,0]
    v_pk_fma_f32 v[14:15], v[14:15], v[42:43], v[42:43] op_sel_hi:[1,0,0]
    v_rcp_f32 v8, v8
    v_rcp_f32 v9, v9
    v_rcp_f32 v10, v10
    v_rcp_f32 v11, v11
    v_rcp_f32 v12, v12
    v_rcp_f32 v13, v13
    v_rcp_f32 v14, v14
    v_rcp_f32 v15, v15
    v_pk_mul_f32 v[8:9], v[8:9], v[16:17]
    v_pk_mul_f32 v[10:11], v[10:11], v[18:19]
    v_pk_mul_f32 v[12:13], v[12:13], v[20:21]
    v_pk_mul_f32 v[14:15], v[14:15], v[22:23]
    v_cvt_pk_bf16_f32 v24, v8, v9
    v_cvt_pk_bf16_f32 v25, v10, v11
    v_cvt_pk_bf16_f32 v26, v12, v13
    v_cvt_pk_bf16_f32 v27, v14, v15
    buffer_load_dwordx4 v[156:159], v4, s[16:19], s3 offen offset:2048 sc1
    buffer_store_dwordx4 v[24:27], v4, s[16:19], s56 offen sc1
    v_pk_mul_f32 v[8:9], v[224:225], v[224:225]
    v_pk_mul_f32 v[10:11], v[226:227], v[226:227]
    v_pk_mul_f32 v[12:13], v[228:229], v[228:229]
    v_pk_mul_f32 v[14:15], v[230:231], v[230:231]
    v_pk_fma_f32 v[8:9], v[44:45], v[8:9], v[44:45] op_sel:[1,0,0] op_sel_hi:[1,1,0]
    v_pk_fma_f32 v[10:11], v[44:45], v[10:11], v[44:45] op_sel:[1,0,0] op_sel_hi:[1,1,0]
    v_pk_fma_f32 v[12:13], v[44:45], v[12:13], v[44:45] op_sel:[1,0,0] op_sel_hi:[1,1,0]
    v_pk_fma_f32 v[14:15], v[44:45], v[14:15], v[44:45] op_sel:[1,0,0] op_sel_hi:[1,1,0]
    v_pk_mul_f32 v[8:9], v[8:9], v[224:225]
    v_pk_mul_f32 v[10:11], v[10:11], v[226:227]
    v_pk_mul_f32 v[12:13], v[12:13], v[228:229]
    v_pk_mul_f32 v[14:15], v[14:15], v[230:231]
    v_exp_f32 v8, v8
    v_exp_f32 v9, v9
    v_exp_f32 v10, v10
    v_exp_f32 v11, v11
    v_exp_f32 v12, v12
    v_exp_f32 v13, v13
    v_exp_f32 v14, v14
    v_exp_f32 v15, v15
    v_pk_mul_f32 v[16:17], v[224:225], v[232:233]
    v_pk_mul_f32 v[18:19], v[226:227], v[234:235]
    buffer_load_dwordx4 v[160:163], v4, s[16:19], s3 offen offset:3072 sc1
    v_pk_mul_f32 v[20:21], v[228:229], v[236:237]
    v_pk_mul_f32 v[22:23], v[230:231], v[238:239]
    v_pk_fma_f32 v[8:9], v[8:9], v[46:47], v[46:47] op_sel_hi:[1,0,0]
    v_pk_fma_f32 v[10:11], v[10:11], v[46:47], v[46:47] op_sel_hi:[1,0,0]
    v_pk_fma_f32 v[12:13], v[12:13], v[46:47], v[46:47] op_sel_hi:[1,0,0]
    v_pk_fma_f32 v[14:15], v[14:15], v[46:47], v[46:47] op_sel_hi:[1,0,0]
    v_rcp_f32 v8, v8
    v_rcp_f32 v9, v9
    v_rcp_f32 v10, v10
    v_rcp_f32 v11, v11
    v_rcp_f32 v12, v12
    v_rcp_f32 v13, v13
    v_rcp_f32 v14, v14
    v_rcp_f32 v15, v15
    v_pk_mul_f32 v[8:9], v[8:9], v[16:17]
    v_pk_mul_f32 v[10:11], v[10:11], v[18:19]
    v_pk_mul_f32 v[12:13], v[12:13], v[20:21]
    v_pk_mul_f32 v[14:15], v[14:15], v[22:23]
    v_cvt_pk_bf16_f32 v28, v8, v9
    v_cvt_pk_bf16_f32 v29, v10, v11
    v_cvt_pk_bf16_f32 v30, v12, v13
    v_cvt_pk_bf16_f32 v31, v14, v15
    buffer_load_dwordx4 v[164:167], v5, s[16:19], s3 offen sc1
    buffer_store_dwordx4 v[28:31], v4, s[16:19], s57 offen sc1
    v_pk_mul_f32 v[8:9], v[240:241], v[240:241]
    v_pk_mul_f32 v[10:11], v[242:243], v[242:243]
    v_pk_mul_f32 v[12:13], v[244:245], v[244:245]
    v_pk_mul_f32 v[14:15], v[246:247], v[246:247]
    v_pk_fma_f32 v[8:9], v[48:49], v[8:9], v[48:49] op_sel:[1,0,0] op_sel_hi:[1,1,0]
    v_pk_fma_f32 v[10:11], v[48:49], v[10:11], v[48:49] op_sel:[1,0,0] op_sel_hi:[1,1,0]
    v_pk_fma_f32 v[12:13], v[48:49], v[12:13], v[48:49] op_sel:[1,0,0] op_sel_hi:[1,1,0]
    v_pk_fma_f32 v[14:15], v[48:49], v[14:15], v[48:49] op_sel:[1,0,0] op_sel_hi:[1,1,0]
    v_pk_mul_f32 v[8:9], v[8:9], v[240:241]
    v_pk_mul_f32 v[10:11], v[10:11], v[242:243]
    v_pk_mul_f32 v[12:13], v[12:13], v[244:245]
    v_pk_mul_f32 v[14:15], v[14:15], v[246:247]
    v_exp_f32 v8, v8
    v_exp_f32 v9, v9
    v_exp_f32 v10, v10
    v_exp_f32 v11, v11
    v_exp_f32 v12, v12
    v_exp_f32 v13, v13
    v_exp_f32 v14, v14
    v_exp_f32 v15, v15
    v_pk_mul_f32 v[16:17], v[240:241], v[248:249]
    v_pk_mul_f32 v[18:19], v[242:243], v[250:251]
    v_pk_mul_f32 v[20:21], v[244:245], v[252:253]
    v_pk_mul_f32 v[22:23], v[246:247], v[254:255]
    v_pk_fma_f32 v[8:9], v[8:9], v[50:51], v[50:51] op_sel_hi:[1,0,0]
    v_pk_fma_f32 v[10:11], v[10:11], v[50:51], v[50:51] op_sel_hi:[1,0,0]
    v_pk_fma_f32 v[12:13], v[12:13], v[50:51], v[50:51] op_sel_hi:[1,0,0]
    v_pk_fma_f32 v[14:15], v[14:15], v[50:51], v[50:51] op_sel_hi:[1,0,0]
    v_rcp_f32 v8, v8
    v_rcp_f32 v9, v9
    v_rcp_f32 v10, v10
    v_rcp_f32 v11, v11
    v_rcp_f32 v12, v12
    v_rcp_f32 v13, v13
    v_rcp_f32 v14, v14
    v_rcp_f32 v15, v15
    v_pk_mul_f32 v[8:9], v[8:9], v[16:17]
    v_pk_mul_f32 v[10:11], v[10:11], v[18:19]
    v_pk_mul_f32 v[12:13], v[12:13], v[20:21]
    v_pk_mul_f32 v[14:15], v[14:15], v[22:23]
    v_cvt_pk_bf16_f32 v24, v8, v9
    v_cvt_pk_bf16_f32 v25, v10, v11
    v_cvt_pk_bf16_f32 v26, v12, v13
    v_cvt_pk_bf16_f32 v27, v14, v15
    buffer_store_dwordx4 v[24:27], v4, s[16:19], s58 offen sc1
    s_setprio 0
    s_mov_b32 s92, 0
    s_cmp_lg_u32 s92, 0
    s_cbranch_scc1 L_pb33
    s_waitcnt vmcnt(0)
    s_mov_b32 s92, 1
    v_mov_b32 v253, 1
    s_mov_b64 exec, 1
    ds_add_rtn_u32 v253, v4, v253 offset:4612
    s_mov_b64 exec, -1
    s_waitcnt lgkmcnt(0)
    v_readfirstlane_b32 s88, v253
    v_mov_b32 v253, 1
    s_cmp_lg_u32 s88, 7
    s_cbranch_scc1 L_pb33
    buffer_store_dword v253, v2, s[16:19], s87 offen sc1
L_pb33:
    s_lshl2_add_u32 s3, s51, s98
    s_add_u32 s3, s3, s51
    s_add_u32 m0, s83, 21504
    s_nop 0
    buffer_load_dwordx4 v4, s[16:19], s3 offen offset:3072 sc1 lds
    s_add_u32 m0, s83, 32768
    s_nop 0
    buffer_load_dwordx4 v5, s[16:19], s3 offen sc1 lds
    s_mov_b32 exec_lo, 0
    buffer_load_dword v58, v6, s[16:19], 0 offen sc1
    s_mov_b64 exec, -1
    s_lshl2_add_u32 s3, s63, s98
    s_add_u32 s3, s3, s63
    buffer_load_dwordx4 v[8:11], v4, s[16:19], s3 offen sc1
    buffer_load_dwordx4 v[12:15], v4, s[16:19], s3 offen offset:1024 sc1
    buffer_load_dwordx4 v[16:19], v4, s[16:19], s3 offen offset:2048 sc1
    s_mov_b32 exec_lo, 0
    buffer_load_dword v3, v6, s[16:19], 0 offen sc1
    s_mov_b64 exec, -1
    buffer_load_dwordx4 v[20:23], v4, s[16:19], s3 offen offset:3072 sc1
    buffer_load_dwordx4 v[24:27], v5, s[16:19], s3 offen sc1
    s_cmp_lg_u32 s68, 0
    s_cbranch_scc1 L_fs29
    s_waitcnt vmcnt(6)
    v_cmp_eq_u32 vcc, 1, v58
    s_nop 0
    s_and_b32 s88, vcc_hi, 0x1f
    s_cmp_eq_u32 s88, 0x1f
    s_cbranch_scc1 L_fw31
    s_waitcnt vmcnt(2)
    v_cmp_eq_u32_e64 vcc, 1, v3
    s_nop 0
    s_and_b32 s88, vcc_hi, 31
    s_cmp_eq_u32 s88, 31
    s_cbranch_scc1 L_fw31
    s_mov_b32 exec_lo, 0
L_fp28:
    buffer_load_dword v3, v6, s[16:19], 0 offen sc1
    s_waitcnt vmcnt(0)
    v_cmp_eq_u32 vcc, 1, v3
    s_nop 0
    s_and_b32 s88, vcc_hi, 31
    s_cmp_eq_u32 s88, 31
    s_cbranch_scc1 L_fw31
    s_sub_u32 s99, s99, 1
    s_cmp_gt_i32 s99, 0
    s_cbranch_scc1 L_fp28
L_fw31:
    s_mov_b64 exec, -1
    v_and_b32 v255, 7, v1
    v_lshlrev_b32 v255, 10, v255
    v_mov_b32_e64 v254, 1
    ds_write_b32 v255, v254 offset:512
    s_waitcnt lgkmcnt(0)
    s_branch L_fq30
L_fs29:
    v_mov_b32_e64 v255, s83
L_ft32:
    ds_read_b32 v254, v255 offset:512
    s_waitcnt lgkmcnt(0)
    v_readfirstlane_b32 s88, v254
    s_nop 0
    s_cmp_ge_u32 s88, 1
    s_cbranch_scc1 L_fq30
    s_sub_u32 s99, s99, 1
    s_cmp_gt_i32 s99, 0
    s_cbranch_scc1 L_ft32
L_fq30:
    s_branch L_p2
L_ssm:
    s_and_b32 s88, s68, 4
    v_and_b32 v44, 31, v1
    v_lshrrev_b32 v45, 5, v1
    v_bfe_u32 v46, v44, 1, 3
    v_xor_b32 v45, v45, v46
    v_xor_b32 v45, s88, v45
    v_lshlrev_b32 v44, 7, v44
    v_xor_b32 v40, 0, v45
    v_lshl_add_u32 v40, v40, 4, v44
    v_xor_b32_e64 v41, 2, v45
    v_lshl_add_u32 v41, v41, 4, v44
    v_xor_b32_e64 v42, 4, v45
    v_lshl_add_u32 v42, v42, 4, v44
    v_xor_b32_e64 v43, 6, v45
    v_lshl_add_u32 v43, v43, 4, v44
    v_mov_b32 v46, 1073741824
    v_cmp_eq_u32_e64 vcc, 0, v0
    s_nop 1
    v_cndmask_b32 v2, v46, 0, vcc
    s_lshl_b32 s87, s74, 5
    s_add_u32 s87, s87, s73
    s_lshl_b32 s87, s87, 7
    s_add_u32 s87, s87, 16221184
    s_mov_b32 s16, s66
    s_mov_b32 s17, s67
    s_mov_b32 s18, 16647168
    s_mov_b32 s19, 0x20000
    s_mov_b32 s24, s64
    s_mov_b32 s25, s65
    s_mov_b32 s26, 256
    s_mov_b32 s27, 0x20000
    s_mov_b32 s32, s62
    s_mov_b32 s33, s63
    s_mov_b32 s34, 5242880
    s_mov_b32 s35, 0x20000
    v_lshlrev_b32 v4, 4, v1
    v_add_u32 v5, 0x1000, v4
    s_mov_b32 s99, 0x40000
    s_cmp_eq_u32 s68, 0
    s_cselect_b32 s88, 16217088, 1073741824
    v_lshl_add_u32 v67, v1, 6, s88
    s_add_u32 s87, s87, 32768
    s_lshl_b32 s88, s73, 7
    s_lshl_b32 s89, s70, 6
    s_add_u32 s75, s88, s89
    v_add_u32 v6, s75, v1
    s_sub_u32 s89, 15, s74
    s_lshr_b32 s88, s89, 1
    s_lshl2_add_u32 s88, s88, s69
    s_mul_i32 s88, s88, 1280
    s_and_b32 s89, s89, 1
    s_add_u32 s88, s88, s89
    s_lshl3_add_u32 s88, s88, 16319488
    v_lshl_add_u32 v6, v6, 4, s88
    v_and_b32 v52, 31, v1
    v_add_u32 v52, s75, v52
    v_lshlrev_b32_e64 v52, 1, v52
    global_load_ushort v32, v52, s[38:39] offset:0
    global_load_ushort v33, v52, s[40:41] offset:0
    global_load_ushort v34, v52, s[50:51] offset:0
    global_load_ushort v35, v52, s[38:39] offset:64
    global_load_ushort v36, v52, s[40:41] offset:64
    global_load_ushort v37, v52, s[50:51] offset:64
    v_mov_b32_e64 v64, 0
    buffer_store_dword v64, v2, s[16:19], s87 offen sc1
    v_mov_b32 v250, -1
    v_mov_b32 v251, -1
    buffer_store_dwordx2 v[250:251], v6, s[16:19], 0 offen sc1
    s_lshl_b32 s88, s69, 12
    s_add_u32 s88, s88, 8192
    s_lshl_b32 s89, s70, 14
    s_add_u32 s89, s89, 24576
    v_add_u32 v16, s88, v40
    v_add_u32 v8, s89, v40
    v_add_u32 v12, 98304, v8
    v_add_u32 v48, 98304, v16
    v_add_u32 v17, s88, v41
    v_add_u32 v9, s89, v41
    v_add_u32 v13, 98304, v9
    v_add_u32 v49, 98304, v17
    v_add_u32 v18, s88, v42
    v_add_u32 v10, s89, v42
    v_add_u32 v14, 98304, v10
    v_add_u32 v50, 98304, v18
    v_add_u32 v19, s88, v43
    v_add_u32 v11, s89, v43
    v_add_u32 v15, 98304, v11
    v_add_u32 v51, 98304, v19
    s_lshr_b32 s62, s71, 1
    s_lshl_b32 s62, s62, 3
    s_lshr_b32 s90, s72, 2
    s_add_u32 s62, s62, s90
    s_and_b32 s0, s71, 1
    s_lshl_b32 s0, s0, 2
    s_and_b32 s89, s72, 3
    s_add_u32 s0, s0, s89
    s_xor_b32 s62, s62, 16
    s_mul_i32 s97, s62, 94
    s_add_u32 s97, s97, s68
    s_lshl_b32 s97, s97, 12
    s_mul_i32 s98, s0, 94
    s_add_u32 s98, s98, s68
    s_mul_i32 s98, s98, 5120
    s_add_u32 s98, s98, 12320768
    s_mul_i32 s59, s62, 81920
    s_mul_i32 s60, s0, 160
    s_add_u32 s59, s59, s60
    s_lshl_b32 s61, s62, 10
    s_add_u32 s61, s61, 16171008
    v_mov_b32 v253, 0
    v_mov_b32 v254, 0
    v_mov_b32 v255, 0
    v_mov_b32 v241, 0
    v_mov_b32 v243, 0
    v_mov_b32 v245, 0
    v_mov_b32 v247, 0
    v_mov_b32 v248, 0
    v_mov_b32_e64 v249, 0
    s_mul_i32 s88, s70, 6144
    s_lshl_b32 s89, s69, 9
    s_add_u32 s88, s88, s89
    s_add_u32 s88, s88, 20480
    v_and_b32_e64 v53, 31, v1
    v_lshl_add_u32 v53, v53, 4, s88
    v_lshrrev_b32_e64 v250, 5, v1
    v_lshl_add_u32 v52, v250, 2, v53
    v_and_b32_e64 v54, 31, v1
    v_mul_u32_u24 v54, 0x50, v54
    v_lshl_add_u32 v54, v250, 5, v54
    v_lshrrev_b32 v55, 4, v1
    v_lshlrev_b32 v55, 3, v55
    v_bfe_u32 v251, v1, 2, 2
    v_add_u32_e64 v55, v55, v251
    v_mul_u32_u24 v55, 0x50, v55
    v_and_b32_e64 v251, 3, v1
    v_lshl_add_u32 v55, v251, 3, v55
    s_mul_i32 s88, s68, 2560
    v_add_u32 v54, s88, v54
    v_add_u32_e64 v55, s88, v55
    s_lshl_b32 s88, s74, 1
    s_lshr_b32 s89, s69, 1
    s_add_u32 s88, s88, s89
    s_mul_i32 s54, s88, 94
    s_lshr_b32 s89, s75, 5
    s_add_u32 s54, s54, s89
    s_add_u32 s54, s54, 54
    s_lshl_b32 s54, s54, 12
    s_and_b32 s89, s69, 1
    s_lshl_b32 s89, s89, 11
    s_add_u32 s54, s54, s89
    s_add_u32 s55, s54, 81920
    s_add_u32 s56, s54, 4096
    s_add_u32 s57, s54, 86016
    v_and_b32 v66, 31, v1
    v_bfe_u32 v252, v66, 1, 1
    v_bfe_u32 v251, v66, 3, 2
    v_lshl_add_u32 v252, v251, 1, v252
    v_and_b32_e64 v251, 1, v66
    v_lshl_add_u32 v252, v251, 3, v252
    v_bfe_u32 v251, v66, 2, 1
    v_lshl_add_u32 v252, v251, 4, v252
    v_lshlrev_b32 v252, 4, v252
    v_lshlrev_b32 v65, 6, v250
    v_lshlrev_b32_e64 v66, 2, v66
    v_lshl_add_u32 v66, v250, 30, v66
    s_lshl_b32 s88, s74, 2
    s_add_u32 s88, s88, s69
    s_lshl_b32 s89, s88, 9
    s_add_u32 s47, s89, 16171008
    s_lshl_b32 s89, s88, 7
    s_add_u32 s49, s89, 16203776
    s_lshl_b32 s88, s75, 2
    s_add_u32 s48, s88, 16211968
    s_add_u32 m0, s83, 122752
    s_nop 0
    buffer_load_dwordx4 v22, s[4:7], s76 offen offset:128 lds
    s_add_u32 m0, s83, 130944
    s_nop 0
    buffer_load_dwordx4 v22, s[4:7], s77 offen offset:128 lds
    s_add_u32 m0, s83, 139136
    s_nop 0
    buffer_load_dwordx4 v22, s[4:7], s78 offen offset:128 lds
    s_add_u32 m0, s83, 147328
    s_nop 0
    buffer_load_dwordx4 v22, s[4:7], s79 offen offset:128 lds
    s_cmp_lt_u32 s68, 4
    s_cbranch_scc1 L_pr34
    s_setprio 1
L_pr34:
    s_waitcnt vmcnt(14)
    s_barrier
    ds_read_b128 v[128:131], v16 offset:0
    ds_read_b128 v[132:135], v8 offset:0
    ds_read_b128 v[136:139], v8 offset:4096
    ds_read_b128 v[140:143], v8 offset:8192
    ds_read_b128 v[144:147], v8 offset:12288
    s_waitcnt lgkmcnt(0)
    v_mfma_f32_32x32x16_bf16 v[176:191], v[128:131], v[132:135], 0
    ds_read_b128 v[152:155], v17 offset:0
    s_add_u32 m0, s83, 73472
    ds_read_b128 v[156:159], v9 offset:0
    ds_read_b128 v[160:163], v9 offset:4096
    buffer_load_dwordx4 v22, s[4:7], s76 offen offset:256 lds
    s_and_b32 s88, s72, 3
    s_mul_i32 s88, s88, 0
    s_lshr_b32 s86, s72, 2
    s_mul_i32 s86, s86, 1
    s_add_u32 s86, s86, s88
    v_mfma_f32_32x32x16_bf16 v[192:207], v[128:131], v[136:139], 0
    ds_read_b128 v[164:167], v9 offset:8192
    ds_read_b128 v[168:171], v9 offset:12288
    s_mul_i32 s88, s86, 205
    s_lshr_b32 s88, s88, 10
    s_mul_i32 s88, s88, 5
    s_sub_u32 s86, s86, s88
    s_lshl_b32 s86, s86, 13
    s_add_u32 m0, s83, 81664
    v_mfma_f32_32x32x16_bf16 v[208:223], v[128:131], v[140:143], 0
    buffer_load_dwordx4 v22, s[4:7], s77 offen offset:256 lds
    s_add_u32 s36, s86, 55296
    s_add_u32 s86, s86, 0x2000
    s_cmp_eq_u32 s86, 40960
    s_cselect_b32 s86, 0, s86
    v_mfma_f32_32x32x16_bf16 v[224:239], v[128:131], v[144:147], 0
    s_add_u32 s37, s86, 55296
    s_add_u32 s86, s86, 0x2000
    s_cmp_eq_u32 s86, 40960
    s_cselect_b32 s86, 0, s86
    s_waitcnt lgkmcnt(0)
    v_mfma_f32_32x32x16_bf16 v[176:191], v[152:155], v[156:159], v[176:191]
    ds_read_b128 v[128:131], v18 offset:0
    s_add_u32 m0, s83, 89856
    ds_read_b128 v[132:135], v10 offset:0
    ds_read_b128 v[136:139], v10 offset:4096
    buffer_load_dwordx4 v22, s[4:7], s78 offen offset:256 lds
    s_add_u32 s42, s86, 55296
    s_add_u32 s86, s86, 0x2000
    s_cmp_eq_u32 s86, 40960
    s_cselect_b32 s86, 0, s86
    v_mfma_f32_32x32x16_bf16 v[192:207], v[152:155], v[160:163], v[192:207]
    ds_read_b128 v[140:143], v10 offset:8192
    ds_read_b128 v[144:147], v10 offset:12288
    s_add_u32 s43, s86, 55296
    s_add_u32 s86, s86, 0x2000
    s_cmp_eq_u32 s86, 40960
    s_cselect_b32 s86, 0, s86
    s_add_u32 m0, s83, 98048
    v_mfma_f32_32x32x16_bf16 v[208:223], v[152:155], v[164:167], v[208:223]
    buffer_load_dwordx4 v22, s[4:7], s79 offen offset:256 lds
    s_add_u32 s44, s86, 55296
    s_and_b32 s88, s72, 3
    s_mul_i32 s88, s88, 0
    s_lshr_b32 s86, s72, 2
    s_mul_i32 s86, s86, 2
    s_add_u32 s86, s86, s88
    v_mfma_f32_32x32x16_bf16 v[224:239], v[152:155], v[168:171], v[224:239]
    s_mul_i32 s88, s86, 147
    s_lshr_b32 s88, s88, 10
    s_mul_i32 s88, s88, 7
    s_sub_u32 s86, s86, s88
    s_lshl_b32 s86, s86, 13
    s_waitcnt lgkmcnt(0)
    v_mfma_f32_32x32x16_bf16 v[176:191], v[128:131], v[132:135], v[176:191]
    ds_read_b128 v[152:155], v19 offset:0
    s_add_u32 m0, s83, 57088
    ds_read_b128 v[156:159], v11 offset:0
    ds_read_b128 v[160:163], v11 offset:4096
    buffer_load_dwordx4 v20, s[12:15], s81 offen offset:256 lds
    s_add_u32 s88, s86, s83
    s_cmp_ge_u32 s88, 55296
    s_cselect_b32 s45, 0x8000000, s86
    v_mfma_f32_32x32x16_bf16 v[192:207], v[128:131], v[136:139], v[192:207]
    ds_read_b128 v[164:167], v11 offset:8192
    ds_read_b128 v[168:171], v11 offset:12288
    s_add_u32 s86, s86, 0x2000
    s_cmp_eq_u32 s86, 57344
    s_cselect_b32 s86, 0, s86
    s_add_u32 m0, s83, 65280
    v_mfma_f32_32x32x16_bf16 v[208:223], v[128:131], v[140:143], v[208:223]
    buffer_load_dwordx4 v20, s[12:15], s82 offen offset:256 lds
    s_add_u32 s88, s86, s83
    s_cmp_ge_u32 s88, 55296
    s_cselect_b32 s46, 0x8000000, s86
    v_mfma_f32_32x32x16_bf16 v[224:239], v[128:131], v[144:147], v[224:239]
    s_add_u32 s86, s86, 0x2000
    s_cmp_eq_u32 s86, 57344
    s_cselect_b32 s86, 0, s86
    s_waitcnt vmcnt(6) lgkmcnt(0)
    s_barrier
    v_mfma_f32_32x32x16_bf16 v[176:191], v[152:155], v[156:159], v[176:191]
    ds_read_b128 v[128:131], v48 offset:0
    s_add_u32 m0, s83, 7808
    ds_read_b128 v[132:135], v12 offset:0
    ds_read_b128 v[136:139], v12 offset:4096
    buffer_load_dwordx4 v20, s[12:15], s81 offen offset:384 lds
    s_add_u32 s88, s86, s83
    s_cmp_ge_u32 s88, 55296
    s_cselect_b32 s50, 0x8000000, s86
    v_mfma_f32_32x32x16_bf16 v[192:207], v[152:155], v[160:163], v[192:207]
    ds_read_b128 v[140:143], v12 offset:8192
    ds_read_b128 v[144:147], v12 offset:12288
    s_add_u32 s86, s86, 0x2000
    s_cmp_eq_u32 s86, 57344
    s_cselect_b32 s86, 0, s86
    s_add_u32 m0, s83, 16000
    v_mfma_f32_32x32x16_bf16 v[208:223], v[152:155], v[164:167], v[208:223]
    buffer_load_dwordx4 v20, s[12:15], s82 offen offset:384 lds
    s_add_u32 s88, s86, s83
    s_cmp_ge_u32 s88, 55296
    s_cselect_b32 s51, 0x8000000, s86
    v_mfma_f32_32x32x16_bf16 v[224:239], v[152:155], v[168:171], v[224:239]
    s_add_u32 s86, s86, 0x2000
    s_cmp_eq_u32 s86, 57344
    s_cselect_b32 s86, 0, s86
    s_waitcnt lgkmcnt(0)
    v_mfma_f32_32x32x16_bf16 v[176:191], v[128:131], v[132:135], v[176:191]
    ds_read_b128 v[152:155], v49 offset:0
    ds_read_b128 v[156:159], v13 offset:0
    ds_read_b128 v[160:163], v13 offset:4096
    s_and_b32 s88, s2, 1
    s_lshl_b32 s88, s88, 7
    v_mov_b32_e64 v64, 1
    buffer_atomic_add v64, v2, s[24:27], s88 offen sc1
    s_add_u32 s88, s86, s83
    s_cmp_ge_u32 s88, 55296
    s_cselect_b32 s63, 0x8000000, s86
    v_mfma_f32_32x32x16_bf16 v[192:207], v[128:131], v[136:139], v[192:207]
    ds_read_b128 v[164:167], v13 offset:8192
    ds_read_b128 v[168:171], v13 offset:12288
    s_add_u32 s86, s86, 0x2000
    s_cmp_eq_u32 s86, 57344
    s_cselect_b32 s86, 0, s86
    s_add_u32 m0, s83, 24192
    v_mfma_f32_32x32x16_bf16 v[208:223], v[128:131], v[140:143], v[208:223]
    buffer_load_dwordx4 v22, s[4:7], s76 offen offset:384 lds
    s_add_u32 s88, s86, s83
    s_cmp_ge_u32 s88, 55296
    s_cselect_b32 s84, 0x8000000, s86
    v_mfma_f32_32x32x16_bf16 v[224:239], v[128:131], v[144:147], v[224:239]
    s_add_u32 s86, s86, 0x2000
    s_cmp_eq_u32 s86, 57344
    s_cselect_b32 s86, 0, s86
    s_waitcnt lgkmcnt(0)
    v_mfma_f32_32x32x16_bf16 v[176:191], v[152:155], v[156:159], v[176:191]
    ds_read_b128 v[128:131], v50 offset:0
    s_add_u32 m0, s83, 32384
    ds_read_b128 v[132:135], v14 offset:0
    ds_read_b128 v[136:139], v14 offset:4096
    buffer_load_dwordx4 v22, s[4:7], s77 offen offset:384 lds
    s_add_u32 s88, s86, s83
    s_cmp_ge_u32 s88, 55296
    s_cselect_b32 s85, 0x8000000, s86
    v_mfma_f32_32x32x16_bf16 v[192:207], v[152:155], v[160:163], v[192:207]
    ds_read_b128 v[140:143], v14 offset:8192
    s_add_u32 m0, s83, 40576
    ds_read_b128 v[144:147], v14 offset:12288
    v_mfma_f32_32x32x16_bf16 v[208:223], v[152:155], v[164:167], v[208:223]
    buffer_load_dwordx4 v22, s[4:7], s78 offen offset:384 lds
    v_lshlrev_b32 v32, 16, v32
    v_lshlrev_b32 v33, 16, v33
    v_mfma_f32_32x32x16_bf16 v[224:239], v[152:155], v[168:171], v[224:239]
    v_lshlrev_b32_e64 v34, 16, v34
    v_mul_f32 v34, 0x3fb8aa3b, v34
    v_exp_f32 v34, v34
    s_waitcnt lgkmcnt(0)
    v_mfma_f32_32x32x16_bf16 v[176:191], v[128:131], v[132:135], v[176:191]
    ds_read_b128 v[152:155], v51 offset:0
    s_add_u32 m0, s83, 48768
    ds_read_b128 v[156:159], v15 offset:0
    ds_read_b128 v[160:163], v15 offset:4096
    buffer_load_dwordx4 v22, s[4:7], s79 offen offset:384 lds
    v_cvt_pk_bf16_f32 v38, v34, v34
    v_lshlrev_b32_e64 v34, 16, v38
    v_mfma_f32_32x32x16_bf16 v[192:207], v[128:131], v[136:139], v[192:207]
    ds_read_b128 v[164:167], v15 offset:8192
    ds_read_b128 v[168:171], v15 offset:12288
    v_mul_f32 v38, v34, v32
    v_mul_f32 v39, v34, v33
    v_mul_f32 v38, 0x3fb8aa3b, v38
    v_mfma_f32_32x32x16_bf16 v[208:223], v[128:131], v[140:143], v[208:223]
    v_exp_f32 v38, v38
    v_mul_f32 v39, 0.15915494, v39
    v_fract_f32_e64 v39, v39
    v_mfma_f32_32x32x16_bf16 v[224:239], v[128:131], v[144:147], v[224:239]
    v_cos_f32 v24, v39
    v_sin_f32 v25, v39
    v_mul_f32_e64 v40, v32, v32
    s_waitcnt vmcnt(7) lgkmcnt(0)
    s_barrier
    v_mfma_f32_32x32x16_bf16 v[176:191], v[152:155], v[156:159], v[176:191]
    ds_read_b128 v[128:131], v16 offset:49152
    s_add_u32 m0, s83, 105984
    ds_read_b128 v[132:135], v8 offset:49152
    ds_read_b128 v[136:139], v8 offset:53248
    buffer_load_dwordx4 v20, s[12:15], s81 offen offset:512 lds
    v_fmac_f32 v40, v33, v33
    v_rcp_f32 v40, v40
    v_mfma_f32_32x32x16_bf16 v[192:207], v[152:155], v[160:163], v[192:207]
    ds_read_b128 v[140:143], v8 offset:57344
    ds_read_b128 v[144:147], v8 offset:61440
    v_mul_f32 v24, v24, v38
    v_mul_f32 v25, v25, v38
    v_add_f32_e64 v40, v40, v40
    s_add_u32 m0, s83, 114176
    v_mfma_f32_32x32x16_bf16 v[208:223], v[152:155], v[164:167], v[208:223]
    buffer_load_dwordx4 v20, s[12:15], s82 offen offset:512 lds
    v_subrev_f32 v41, 1.0, v24
    v_mul_f32 v26, v41, v32
    v_mfma_f32_32x32x16_bf16 v[224:239], v[152:155], v[168:171], v[224:239]
    v_fmac_f32 v26, v25, v33
    v_mul_f32 v26, v26, v40
    v_mul_f32 v27, v25, v32
    s_waitcnt lgkmcnt(0)
    v_mfma_f32_32x32x16_bf16 v[176:191], v[128:131], v[132:135], v[176:191]
    ds_read_b128 v[152:155], v17 offset:49152
    s_add_u32 m0, s83, 122368
    ds_read_b128 v[156:159], v9 offset:49152
    ds_read_b128 v[160:163], v9 offset:53248
    buffer_load_dwordx4 v22, s[4:7], s76 offen offset:512 lds
    v_fma_f32 v27, -v41, v33, v27
    v_mul_f32_e64 v27, v27, v40
    v_mfma_f32_32x32x16_bf16 v[192:207], v[128:131], v[136:139], v[192:207]
    ds_read_b128 v[164:167], v9 offset:57344
    ds_read_b128 v[168:171], v9 offset:61440
    v_mov_b32 v60, v24
    v_mov_b32 v61, v25
    v_mul_f32_e64 v38, v61, v61
    s_add_u32 m0, s83, 130560
    v_mfma_f32_32x32x16_bf16 v[208:223], v[128:131], v[140:143], v[208:223]
    buffer_load_dwordx4 v22, s[4:7], s77 offen offset:512 lds
    v_mul_f32_e64 v61, v60, v61
    v_fma_f32 v60, v60, v60, -v38
    v_mfma_f32_32x32x16_bf16 v[224:239], v[128:131], v[144:147], v[224:239]
    v_add_f32 v61, v61, v61
    v_mul_f32 v38, v61, v61
    v_mul_f32 v61, v60, v61
    s_waitcnt lgkmcnt(0)
    v_mfma_f32_32x32x16_bf16 v[176:191], v[152:155], v[156:159], v[176:191]
    ds_read_b128 v[128:131], v18 offset:49152
    s_add_u32 m0, s83, 138752
    ds_read_b128 v[132:135], v10 offset:49152
    ds_read_b128 v[136:139], v10 offset:53248
    buffer_load_dwordx4 v22, s[4:7], s78 offen offset:512 lds
    v_fma_f32 v60, v60, v60, -v38
    v_add_f32_e64 v61, v61, v61
    v_mfma_f32_32x32x16_bf16 v[192:207], v[152:155], v[160:163], v[192:207]
    ds_read_b128 v[140:143], v10 offset:57344
    ds_read_b128 v[144:147], v10 offset:61440
    v_mul_f32 v38, v61, v61
    v_mul_f32 v61, v60, v61
    v_fma_f32 v60, v60, v60, -v38
    s_add_u32 m0, s83, 146944
    v_mfma_f32_32x32x16_bf16 v[208:223], v[152:155], v[164:167], v[208:223]
    buffer_load_dwordx4 v22, s[4:7], s79 offen offset:512 lds
    v_add_f32 v61, v61, v61
    v_lshlrev_b32 v35, 16, v35
    v_mfma_f32_32x32x16_bf16 v[224:239], v[152:155], v[168:171], v[224:239]
    v_lshlrev_b32 v36, 16, v36
    v_lshlrev_b32 v37, 16, v37
    v_mul_f32 v37, 0x3fb8aa3b, v37
    s_waitcnt lgkmcnt(0)
    v_mfma_f32_32x32x16_bf16 v[176:191], v[128:131], v[132:135], v[176:191]
    ds_read_b128 v[152:155], v19 offset:49152
    ds_read_b128 v[156:159], v11 offset:49152
    ds_read_b128 v[160:163], v11 offset:53248
    v_exp_f32_e64 v37, v37
    s_nop 0
    v_cvt_pk_bf16_f32 v38, v37, v37
    v_lshlrev_b32_e64 v37, 16, v38
    v_mfma_f32_32x32x16_bf16 v[192:207], v[128:131], v[136:139], v[192:207]
    ds_read_b128 v[164:167], v11 offset:57344
    ds_read_b128 v[168:171], v11 offset:61440
    v_mul_f32 v38, v37, v35
    v_mul_f32 v39, v37, v36
    v_mul_f32 v38, 0x3fb8aa3b, v38
    v_mfma_f32_32x32x16_bf16 v[208:223], v[128:131], v[140:143], v[208:223]
    v_exp_f32 v38, v38
    v_mul_f32 v39, 0.15915494, v39
    v_fract_f32_e64 v39, v39
    v_mfma_f32_32x32x16_bf16 v[224:239], v[128:131], v[144:147], v[224:239]
    v_cos_f32 v28, v39
    v_sin_f32 v29, v39
    v_mul_f32_e64 v40, v35, v35
    s_waitcnt vmcnt(6) lgkmcnt(0)
    s_barrier
    v_mfma_f32_32x32x16_bf16 v[176:191], v[152:155], v[156:159], v[176:191]
    ds_read_b128 v[128:131], v16 offset:0
    s_add_u32 m0, s83, 56704
    ds_read_b128 v[132:135], v8 offset:0
    ds_read_b128 v[136:139], v8 offset:4096
    buffer_load_dwordx4 v20, s[12:15], s81 offen offset:640 lds
    v_fmac_f32 v40, v36, v36
    v_rcp_f32 v40, v40
    v_mfma_f32_32x32x16_bf16 v[192:207], v[152:155], v[160:163], v[192:207]
    ds_read_b128 v[140:143], v8 offset:8192
    ds_read_b128 v[144:147], v8 offset:12288
    v_mul_f32 v28, v28, v38
    v_mul_f32 v29, v29, v38
    v_add_f32_e64 v40, v40, v40
    s_add_u32 m0, s83, 64896
    v_mfma_f32_32x32x16_bf16 v[208:223], v[152:155], v[164:167], v[208:223]
    buffer_load_dwordx4 v20, s[12:15], s82 offen offset:640 lds
    v_subrev_f32 v41, 1.0, v28
    v_mul_f32 v30, v41, v35
    v_mfma_f32_32x32x16_bf16 v[224:239], v[152:155], v[168:171], v[224:239]
    v_fmac_f32 v30, v29, v36
    v_mul_f32 v30, v30, v40
    v_mul_f32 v31, v29, v35
    s_waitcnt lgkmcnt(0)
    v_mfma_f32_32x32x16_bf16 v[176:191], v[128:131], v[132:135], v[176:191]
    ds_read_b128 v[152:155], v17 offset:0
    s_add_u32 m0, s83, 73088
    ds_read_b128 v[156:159], v9 offset:0
    ds_read_b128 v[160:163], v9 offset:4096
    buffer_load_dwordx4 v22, s[4:7], s76 offen offset:640 lds
    v_fma_f32 v31, -v41, v36, v31
    v_mul_f32_e64 v31, v31, v40
    v_mfma_f32_32x32x16_bf16 v[192:207], v[128:131], v[136:139], v[192:207]
    ds_read_b128 v[164:167], v9 offset:8192
    ds_read_b128 v[168:171], v9 offset:12288
    v_mov_b32 v62, v28
    v_mov_b32 v63, v29
    v_mul_f32_e64 v38, v63, v63
    s_add_u32 m0, s83, 81280
    v_mfma_f32_32x32x16_bf16 v[208:223], v[128:131], v[140:143], v[208:223]
    buffer_load_dwordx4 v22, s[4:7], s77 offen offset:640 lds
    v_mul_f32_e64 v63, v62, v63
    v_fma_f32 v62, v62, v62, -v38
    v_mfma_f32_32x32x16_bf16 v[224:239], v[128:131], v[144:147], v[224:239]
    v_add_f32 v63, v63, v63
    v_mul_f32 v38, v63, v63
    v_mul_f32 v63, v62, v63
    s_waitcnt lgkmcnt(0)
    v_mfma_f32_32x32x16_bf16 v[176:191], v[152:155], v[156:159], v[176:191]
    ds_read_b128 v[128:131], v18 offset:0
    s_add_u32 m0, s83, 89472
    ds_read_b128 v[132:135], v10 offset:0
    ds_read_b128 v[136:139], v10 offset:4096
    buffer_load_dwordx4 v22, s[4:7], s78 offen offset:640 lds
    v_fma_f32 v62, v62, v62, -v38
    v_add_f32_e64 v63, v63, v63
    v_mfma_f32_32x32x16_bf16 v[192:207], v[152:155], v[160:163], v[192:207]
    ds_read_b128 v[140:143], v10 offset:8192
    ds_read_b128 v[144:147], v10 offset:12288
    v_mul_f32 v38, v63, v63
    v_mul_f32 v63, v62, v63
    v_fma_f32 v62, v62, v62, -v38
    s_add_u32 m0, s83, 97664
    v_mfma_f32_32x32x16_bf16 v[208:223], v[152:155], v[164:167], v[208:223]
    buffer_load_dwordx4 v22, s[4:7], s79 offen offset:640 lds
    v_add_f32 v63, v63, v63
    v_cmp_gt_u32 vcc, 32, v1
    s_nop 1
    v_cndmask_b32 v56, v62, v60, vcc
    v_cndmask_b32_e64 v57, v63, v61, vcc
    v_mfma_f32_32x32x16_bf16 v[224:239], v[152:155], v[168:171], v[224:239]
    v_mul_f32 v38, v57, v57
    v_mul_f32 v57, v56, v57
    v_fma_f32 v56, v56, v56, -v38
    s_waitcnt lgkmcnt(0)
    v_mfma_f32_32x32x16_bf16 v[176:191], v[128:131], v[132:135], v[176:191]
    ds_read_b128 v[152:155], v19 offset:0
    ds_read_b128 v[156:159], v11 offset:0
    ds_read_b128 v[160:163], v11 offset:4096
    v_add_f32 v57, v57, v57
    v_mov_b32 v58, v56
    v_mov_b32 v59, v57
    v_mfma_f32_32x32x16_bf16 v[192:207], v[128:131], v[136:139], v[192:207]
    ds_read_b128 v[164:167], v11 offset:8192
    ds_read_b128 v[168:171], v11 offset:12288
    v_mul_f32 v38, v59, v59
    v_mul_f32 v59, v58, v59
    v_fma_f32 v58, v58, v58, -v38
    v_mfma_f32_32x32x16_bf16 v[208:223], v[128:131], v[140:143], v[208:223]
    v_add_f32 v59, v59, v59
    v_mul_f32 v38, v59, v59
    v_mul_f32_e64 v59, v58, v59
    v_mfma_f32_32x32x16_bf16 v[224:239], v[128:131], v[144:147], v[224:239]
    v_fma_f32 v58, v58, v58, -v38
    v_add_f32 v59, v59, v59
    v_mul_f32 v38, v59, v59
    s_waitcnt vmcnt(6) lgkmcnt(0)
    s_barrier
    v_mfma_f32_32x32x16_bf16 v[176:191], v[152:155], v[156:159], v[176:191]
    ds_read_b128 v[128:131], v48 offset:0
    s_add_u32 m0, s83, 7424
    ds_read_b128 v[132:135], v12 offset:0
    ds_read_b128 v[136:139], v12 offset:4096
    buffer_load_dwordx4 v20, s[12:15], s81 offen offset:768 lds
    v_mul_f32_e64 v59, v58, v59
    v_fma_f32 v58, v58, v58, -v38
    v_mfma_f32_32x32x16_bf16 v[192:207], v[152:155], v[160:163], v[192:207]
    ds_read_b128 v[140:143], v12 offset:8192
    ds_read_b128 v[144:147], v12 offset:12288
    v_add_f32_e64 v59, v59, v59
    s_add_u32 m0, s83, 15616
    v_mfma_f32_32x32x16_bf16 v[208:223], v[152:155], v[164:167], v[208:223]
    buffer_load_dwordx4 v20, s[12:15], s82 offen offset:768 lds
    v_mfma_f32_32x32x16_bf16 v[224:239], v[152:155], v[168:171], v[224:239]
    s_waitcnt lgkmcnt(0)
    v_mfma_f32_32x32x16_bf16 v[176:191], v[128:131], v[132:135], v[176:191]
    ds_read_b128 v[152:155], v49 offset:0
    ds_read_b128 v[156:159], v13 offset:0
    ds_read_b128 v[160:163], v13 offset:4096
    v_lshlrev_b32 v64, 7, v0
    buffer_load_dword v23, v64, s[24:27], 0 offen sc1
    v_mfma_f32_32x32x16_bf16 v[192:207], v[128:131], v[136:139], v[192:207]
    ds_read_b128 v[164:167], v13 offset:8192
    s_add_u32 m0, s83, 23808
    ds_read_b128 v[168:171], v13 offset:12288
    v_mfma_f32_32x32x16_bf16 v[208:223], v[128:131], v[140:143], v[208:223]
    buffer_load_dwordx4 v22, s[4:7], s76 offen offset:768 lds
    v_mfma_f32_32x32x16_bf16 v[224:239], v[128:131], v[144:147], v[224:239]
    s_waitcnt lgkmcnt(0)
    v_mfma_f32_32x32x16_bf16 v[176:191], v[152:155], v[156:159], v[176:191]
    ds_read_b128 v[128:131], v50 offset:0
    s_add_u32 m0, s83, 32000
    ds_read_b128 v[132:135], v14 offset:0
    ds_read_b128 v[136:139], v14 offset:4096
    buffer_load_dwordx4 v22, s[4:7], s77 offen offset:768 lds
    v_mfma_f32_32x32x16_bf16 v[192:207], v[152:155], v[160:163], v[192:207]
    ds_read_b128 v[140:143], v14 offset:8192
    s_add_u32 m0, s83, 40192
    ds_read_b128 v[144:147], v14 offset:12288
    v_mfma_f32_32x32x16_bf16 v[208:223], v[152:155], v[164:167], v[208:223]
    buffer_load_dwordx4 v22, s[4:7], s78 offen offset:768 lds
    v_mfma_f32_32x32x16_bf16 v[224:239], v[152:155], v[168:171], v[224:239]
    s_waitcnt lgkmcnt(0)
    v_mfma_f32_32x32x16_bf16 v[176:191], v[128:131], v[132:135], v[176:191]
    ds_read_b128 v[152:155], v51 offset:0
    s_add_u32 m0, s83, 48384
    ds_read_b128 v[156:159], v15 offset:0
    ds_read_b128 v[160:163], v15 offset:4096
    buffer_load_dwordx4 v22, s[4:7], s79 offen offset:768 lds
    v_mfma_f32_32x32x16_bf16 v[192:207], v[128:131], v[136:139], v[192:207]
    ds_read_b128 v[164:167], v15 offset:8192
    ds_read_b128 v[168:171], v15 offset:12288
    v_mfma_f32_32x32x16_bf16 v[208:223], v[128:131], v[140:143], v[208:223]
    v_mfma_f32_32x32x16_bf16 v[224:239], v[128:131], v[144:147], v[224:239]
    s_waitcnt vmcnt(7) lgkmcnt(0)
    s_barrier
    v_mfma_f32_32x32x16_bf16 v[176:191], v[152:155], v[156:159], v[176:191]
    ds_read_b128 v[128:131], v16 offset:49152
    s_add_u32 m0, s83, 105600
    ds_read_b128 v[132:135], v8 offset:49152
    ds_read_b128 v[136:139], v8 offset:53248
    buffer_load_dwordx4 v20, s[12:15], s81 offen offset:896 lds
    v_mfma_f32_32x32x16_bf16 v[192:207], v[152:155], v[160:163], v[192:207]
    ds_read_b128 v[140:143], v8 offset:57344
    s_add_u32 m0, s83, 113792
    ds_read_b128 v[144:147], v8 offset:61440
    v_mfma_f32_32x32x16_bf16 v[208:223], v[152:155], v[164:167], v[208:223]
    buffer_load_dwordx4 v20, s[12:15], s82 offen offset:896 lds
    v_mfma_f32_32x32x16_bf16 v[224:239], v[152:155], v[168:171], v[224:239]
    s_waitcnt lgkmcnt(0)
    v_mfma_f32_32x32x16_bf16 v[176:191], v[128:131], v[132:135], v[176:191]
    ds_read_b128 v[152:155], v17 offset:49152
    s_add_u32 m0, s83, 121984
    ds_read_b128 v[156:159], v9 offset:49152
    ds_read_b128 v[160:163], v9 offset:53248
    buffer_load_dwordx4 v22, s[4:7], s76 offen offset:896 lds
    v_mfma_f32_32x32x16_bf16 v[192:207], v[128:131], v[136:139], v[192:207]
    ds_read_b128 v[164:167], v9 offset:57344
    s_add_u32 m0, s83, 130176
    ds_read_b128 v[168:171], v9 offset:61440
    v_mfma_f32_32x32x16_bf16 v[208:223], v[128:131], v[140:143], v[208:223]
    buffer_load_dwordx4 v22, s[4:7], s77 offen offset:896 lds
    v_mfma_f32_32x32x16_bf16 v[224:239], v[128:131], v[144:147], v[224:239]
    s_waitcnt lgkmcnt(0)
    v_mfma_f32_32x32x16_bf16 v[176:191], v[152:155], v[156:159], v[176:191]
    ds_read_b128 v[128:131], v18 offset:49152
    s_add_u32 m0, s83, 138368
    ds_read_b128 v[132:135], v10 offset:49152
    ds_read_b128 v[136:139], v10 offset:53248
    buffer_load_dwordx4 v22, s[4:7], s78 offen offset:896 lds
    v_mfma_f32_32x32x16_bf16 v[192:207], v[152:155], v[160:163], v[192:207]
    ds_read_b128 v[140:143], v10 offset:57344
    s_add_u32 m0, s83, 146560
    ds_read_b128 v[144:147], v10 offset:61440
    v_mfma_f32_32x32x16_bf16 v[208:223], v[152:155], v[164:167], v[208:223]
    buffer_load_dwordx4 v22, s[4:7], s79 offen offset:896 lds
    v_mfma_f32_32x32x16_bf16 v[224:239], v[152:155], v[168:171], v[224:239]
    s_waitcnt lgkmcnt(0)
    v_mfma_f32_32x32x16_bf16 v[176:191], v[128:131], v[132:135], v[176:191]
    ds_read_b128 v[152:155], v19 offset:49152
    ds_read_b128 v[156:159], v11 offset:49152
    ds_read_b128 v[160:163], v11 offset:53248
    v_mfma_f32_32x32x16_bf16 v[192:207], v[128:131], v[136:139], v[192:207]
    ds_read_b128 v[164:167], v11 offset:57344
    ds_read_b128 v[168:171], v11 offset:61440
    v_mfma_f32_32x32x16_bf16 v[208:223], v[128:131], v[140:143], v[208:223]
    v_mfma_f32_32x32x16_bf16 v[224:239], v[128:131], v[144:147], v[224:239]
    s_cmp_lg_u32 s68, 0
    s_cbranch_scc1 L_cd36
    s_waitcnt vmcnt(10)
L_cp35:
    v_cmp_gt_u32 vcc, 0x80, v23
    s_nop 0
    s_and_b32 s88, vcc_lo, 3
    s_cbranch_scc0 L_cd36
    v_lshlrev_b32 v64, 7, v0
    buffer_load_dword v23, v64, s[24:27], 0 offen sc1
    s_waitcnt vmcnt(0)
    s_sub_u32 s99, s99, 1
    s_cmp_gt_i32 s99, 0
    s_cbranch_scc1 L_cp35
L_cd36:
    s_waitcnt vmcnt(6) lgkmcnt(0)
    s_barrier
    v_mfma_f32_32x32x16_bf16 v[176:191], v[152:155], v[156:159], v[176:191]
    ds_read_b128 v[128:131], v16 offset:0
    s_add_u32 m0, s83, 56320
    ds_read_b128 v[132:135], v8 offset:0
    ds_read_b128 v[136:139], v8 offset:4096
    buffer_load_dwordx4 v20, s[12:15], s81 offen offset:1024 lds
    v_mfma_f32_32x32x16_bf16 v[192:207], v[152:155], v[160:163], v[192:207]
    ds_read_b128 v[140:143], v8 offset:8192
    s_add_u32 m0, s83, 64512
    ds_read_b128 v[144:147], v8 offset:12288
    v_mfma_f32_32x32x16_bf16 v[208:223], v[152:155], v[164:167], v[208:223]
    buffer_load_dwordx4 v20, s[12:15], s82 offen offset:1024 lds
    v_mfma_f32_32x32x16_bf16 v[224:239], v[152:155], v[168:171], v[224:239]
    s_waitcnt lgkmcnt(0)
    v_mfma_f32_32x32x16_bf16 v[176:191], v[128:131], v[132:135], v[176:191]
    ds_read_b128 v[152:155], v17 offset:0
    ds_read_b128 v[156:159], v9 offset:0
    ds_read_b128 v[160:163], v9 offset:4096
    buffer_load_dwordx4 v[148:151], v67, s[16:19], 0 offen sc1
    v_mfma_f32_32x32x16_bf16 v[192:207], v[128:131], v[136:139], v[192:207]
    ds_read_b128 v[164:167], v9 offset:8192
    s_add_u32 m0, s83, 72704
    ds_read_b128 v[168:171], v9 offset:12288
    v_mfma_f32_32x32x16_bf16 v[208:223], v[128:131], v[140:143], v[208:223]
    buffer_load_dwordx4 v22, s[4:7], s76 offen offset:1024 lds
    v_mfma_f32_32x32x16_bf16 v[224:239], v[128:131], v[144:147], v[224:239]
    s_waitcnt lgkmcnt(0)
    v_mfma_f32_32x32x16_bf16 v[176:191], v[152:155], v[156:159], v[176:191]
    ds_read_b128 v[128:131], v18 offset:0
    s_add_u32 m0, s83, 80896
    ds_read_b128 v[132:135], v10 offset:0
    ds_read_b128 v[136:139], v10 offset:4096
    buffer_load_dwordx4 v22, s[4:7], s77 offen offset:1024 lds
    v_mfma_f32_32x32x16_bf16 v[192:207], v[152:155], v[160:163], v[192:207]
    ds_read_b128 v[140:143], v10 offset:8192
    s_add_u32 m0, s83, 89088
    ds_read_b128 v[144:147], v10 offset:12288
    v_mfma_f32_32x32x16_bf16 v[208:223], v[152:155], v[164:167], v[208:223]
    buffer_load_dwordx4 v22, s[4:7], s78 offen offset:1024 lds
    v_mfma_f32_32x32x16_bf16 v[224:239], v[152:155], v[168:171], v[224:239]
    s_waitcnt lgkmcnt(0)
    v_mfma_f32_32x32x16_bf16 v[176:191], v[128:131], v[132:135], v[176:191]
    ds_read_b128 v[152:155], v19 offset:0
    s_add_u32 m0, s83, 97280
    ds_read_b128 v[156:159], v11 offset:0
    ds_read_b128 v[160:163], v11 offset:4096
    buffer_load_dwordx4 v22, s[4:7], s79 offen offset:1024 lds
    v_mfma_f32_32x32x16_bf16 v[192:207], v[128:131], v[136:139], v[192:207]
    ds_read_b128 v[164:167], v11 offset:8192
    ds_read_b128 v[168:171], v11 offset:12288
    v_mfma_f32_32x32x16_bf16 v[208:223], v[128:131], v[140:143], v[208:223]
    v_mfma_f32_32x32x16_bf16 v[224:239], v[128:131], v[144:147], v[224:239]
    s_waitcnt vmcnt(7) lgkmcnt(0)
    s_barrier
    v_mfma_f32_32x32x16_bf16 v[176:191], v[152:155], v[156:159], v[176:191]
    ds_read_b128 v[128:131], v48 offset:0
    s_add_u32 m0, s83, 7040
    ds_read_b128 v[132:135], v12 offset:0
    ds_read_b128 v[136:139], v12 offset:4096
    buffer_load_dwordx4 v20, s[12:15], s81 offen offset:1152 lds
    v_mfma_f32_32x32x16_bf16 v[192:207], v[152:155], v[160:163], v[192:207]
    ds_read_b128 v[140:143], v12 offset:8192
    s_add_u32 m0, s83, 15232
    ds_read_b128 v[144:147], v12 offset:12288
    v_mfma_f32_32x32x16_bf16 v[208:223], v[152:155], v[164:167], v[208:223]
    buffer_load_dwordx4 v20, s[12:15], s82 offen offset:1152 lds
    v_mfma_f32_32x32x16_bf16 v[224:239], v[152:155], v[168:171], v[224:239]
    s_waitcnt lgkmcnt(0)
    v_mfma_f32_32x32x16_bf16 v[176:191], v[128:131], v[132:135], v[176:191]
    ds_read_b128 v[152:155], v49 offset:0
    s_add_u32 m0, s83, 23424
    ds_read_b128 v[156:159], v13 offset:0
    ds_read_b128 v[160:163], v13 offset:4096
    buffer_load_dwordx4 v22, s[4:7], s76 offen offset:1152 lds
    v_mfma_f32_32x32x16_bf16 v[192:207], v[128:131], v[136:139], v[192:207]
    ds_read_b128 v[164:167], v13 offset:8192
    s_add_u32 m0, s83, 31616
    ds_read_b128 v[168:171], v13 offset:12288
    v_mfma_f32_32x32x16_bf16 v[208:223], v[128:131], v[140:143], v[208:223]
    buffer_load_dwordx4 v22, s[4:7], s77 offen offset:1152 lds
    v_mfma_f32_32x32x16_bf16 v[224:239], v[128:131], v[144:147], v[224:239]
    s_waitcnt lgkmcnt(0)
    v_mfma_f32_32x32x16_bf16 v[176:191], v[152:155], v[156:159], v[176:191]
    ds_read_b128 v[128:131], v50 offset:0
    s_add_u32 m0, s83, 39808
    ds_read_b128 v[132:135], v14 offset:0
    ds_read_b128 v[136:139], v14 offset:4096
    buffer_load_dwordx4 v22, s[4:7], s78 offen offset:1152 lds
    v_mfma_f32_32x32x16_bf16 v[192:207], v[152:155], v[160:163], v[192:207]
    ds_read_b128 v[140:143], v14 offset:8192
    s_add_u32 m0, s83, 48000
    ds_read_b128 v[144:147], v14 offset:12288
    v_mfma_f32_32x32x16_bf16 v[208:223], v[152:155], v[164:167], v[208:223]
    buffer_load_dwordx4 v22, s[4:7], s79 offen offset:1152 lds
    v_mfma_f32_32x32x16_bf16 v[224:239], v[152:155], v[168:171], v[224:239]
    s_waitcnt lgkmcnt(0)
    v_mfma_f32_32x32x16_bf16 v[176:191], v[128:131], v[132:135], v[176:191]
    ds_read_b128 v[152:155], v51 offset:0
    ds_read_b128 v[156:159], v15 offset:0
    ds_read_b128 v[160:163], v15 offset:4096
    v_mfma_f32_32x32x16_bf16 v[192:207], v[128:131], v[136:139], v[192:207]
    ds_read_b128 v[164:167], v15 offset:8192
    ds_read_b128 v[168:171], v15 offset:12288
    v_mfma_f32_32x32x16_bf16 v[208:223], v[128:131], v[140:143], v[208:223]
    v_mfma_f32_32x32x16_bf16 v[224:239], v[128:131], v[144:147], v[224:239]
    s_cmp_lg_u32 s68, 0
    s_cbranch_scc1 L_cd38
    s_waitcnt vmcnt(10)
L_cp37:
    v_and_b32 v148, v148, v149
    v_and_b32 v150, v150, v151
    v_and_b32 v148, 1, v148
    v_and_b32 v148, v148, v150
    v_cmp_ne_u32_e64 vcc, 1, v148
    s_nop 0
    s_and_b32 vcc_hi, vcc_hi, 0xfff
    s_cmp_lg_u64 vcc, 0
    s_cbranch_scc0 L_cd38
    buffer_load_dwordx4 v[148:151], v67, s[16:19], 0 offen sc1
    s_waitcnt vmcnt(0)
    s_sub_u32 s99, s99, 1
    s_cmp_gt_i32 s99, 0
    s_cbranch_scc1 L_cp37
L_cd38:
    s_waitcnt vmcnt(6) lgkmcnt(0)
    s_barrier
    v_mfma_f32_32x32x16_bf16 v[176:191], v[152:155], v[156:159], v[176:191]
    ds_read_b128 v[128:131], v16 offset:49152
    ds_read_b128 v[132:135], v8 offset:49152
    ds_read_b128 v[136:139], v8 offset:53248
    buffer_load_dword v252, v252, s[16:19], s47 offen offset:12 sc1
    buffer_load_dword v240, v66, s[16:19], s48 offen offset:0 sc1
    buffer_load_dword v242, v66, s[16:19], s48 offen offset:2560 sc1
    buffer_load_dword v244, v66, s[16:19], s48 offen offset:128 sc1
    buffer_load_dword v246, v66, s[16:19], s48 offen offset:2688 sc1
    v_mfma_f32_32x32x16_bf16 v[192:207], v[152:155], v[160:163], v[192:207]
    ds_read_b128 v[140:143], v8 offset:57344
    ds_read_b128 v[144:147], v8 offset:61440
    v_mfma_f32_32x32x16_bf16 v[208:223], v[152:155], v[164:167], v[208:223]
    v_mfma_f32_32x32x16_bf16 v[224:239], v[152:155], v[168:171], v[224:239]
    buffer_load_dwordx4 v[32:35], v65, s[16:19], s49 offen offset:0 sc1
    buffer_load_dwordx4 v[36:39], v65, s[16:19], s49 offen offset:16 sc1
    buffer_load_dwordx4 v[40:43], v65, s[16:19], s49 offen offset:32 sc1
    buffer_load_dwordx4 v[44:47], v65, s[16:19], s49 offen offset:48 sc1
    s_waitcnt lgkmcnt(0)
    v_mfma_f32_32x32x16_bf16 v[176:191], v[128:131], v[132:135], v[176:191]
    ds_read_b128 v[152:155], v17 offset:49152
    ds_read_b128 v[156:159], v9 offset:49152
    ds_read_b128 v[160:163], v9 offset:53248
    v_mfma_f32_32x32x16_bf16 v[192:207], v[128:131], v[136:139], v[192:207]
    ds_read_b128 v[164:167], v9 offset:57344
    ds_read_b128 v[168:171], v9 offset:61440
    v_mfma_f32_32x32x16_bf16 v[208:223], v[128:131], v[140:143], v[208:223]
    s_lshl2_add_u32 s3, s36, s98
    s_add_u32 s3, s3, s36
    buffer_load_dwordx4 v[68:71], v4, s[16:19], s3 offen sc1
    v_mfma_f32_32x32x16_bf16 v[224:239], v[128:131], v[144:147], v[224:239]
    s_waitcnt lgkmcnt(0)
    v_mfma_f32_32x32x16_bf16 v[176:191], v[152:155], v[156:159], v[176:191]
    ds_read_b128 v[128:131], v18 offset:49152
    ds_read_b128 v[132:135], v10 offset:49152
    ds_read_b128 v[136:139], v10 offset:53248
    v_mfma_f32_32x32x16_bf16 v[192:207], v[152:155], v[160:163], v[192:207]
    ds_read_b128 v[140:143], v10 offset:57344
    ds_read_b128 v[144:147], v10 offset:61440
    buffer_load_dwordx4 v[72:75], v4, s[16:19], s3 offen offset:1024 sc1
    v_mfma_f32_32x32x16_bf16 v[208:223], v[152:155], v[164:167], v[208:223]
    v_mfma_f32_32x32x16_bf16 v[224:239], v[152:155], v[168:171], v[224:239]
    s_waitcnt lgkmcnt(0)
    v_mfma_f32_32x32x16_bf16 v[176:191], v[128:131], v[132:135], v[176:191]
    ds_read_b128 v[152:155], v19 offset:49152
    ds_read_b128 v[156:159], v11 offset:49152
    ds_read_b128 v[160:163], v11 offset:53248
    buffer_load_dwordx4 v[76:79], v4, s[16:19], s3 offen offset:2048 sc1
    v_mfma_f32_32x32x16_bf16 v[192:207], v[128:131], v[136:139], v[192:207]
    ds_read_b128 v[164:167], v11 offset:57344
    ds_read_b128 v[168:171], v11 offset:61440
    v_mfma_f32_32x32x16_bf16 v[208:223], v[128:131], v[140:143], v[208:223]
    v_mfma_f32_32x32x16_bf16 v[224:239], v[128:131], v[144:147], v[224:239]
    buffer_load_dwordx4 v[80:83], v4, s[16:19], s3 offen offset:3072 sc1
    s_waitcnt vmcnt(13) lgkmcnt(0)
    s_barrier
    v_mfma_f32_32x32x16_bf16 v[176:191], v[152:155], v[156:159], v[176:191]
    ds_read_b128 v[128:131], v16 offset:0
    ds_read_b128 v[132:135], v8 offset:0
    ds_read_b128 v[136:139], v8 offset:4096
    buffer_load_dwordx4 v[84:87], v5, s[16:19], s3 offen sc1
    v_mfma_f32_32x32x16_bf16 v[192:207], v[152:155], v[160:163], v[192:207]
    ds_read_b128 v[140:143], v8 offset:8192
    ds_read_b128 v[144:147], v8 offset:12288
    v_mfma_f32_32x32x16_bf16 v[208:223], v[152:155], v[164:167], v[208:223]
    v_mfma_f32_32x32x16_bf16 v[224:239], v[152:155], v[168:171], v[224:239]
    s_lshl2_add_u32 s3, s37, s98
    s_add_u32 s3, s3, s37
    buffer_load_dwordx4 v[88:91], v4, s[16:19], s3 offen sc1
    s_waitcnt lgkmcnt(0)
    v_mfma_f32_32x32x16_bf16 v[176:191], v[128:131], v[132:135], v[176:191]
    ds_read_b128 v[152:155], v17 offset:0
    ds_read_b128 v[156:159], v9 offset:0
    ds_read_b128 v[160:163], v9 offset:4096
    v_mfma_f32_32x32x16_bf16 v[192:207], v[128:131], v[136:139], v[192:207]
    ds_read_b128 v[164:167], v9 offset:8192
    ds_read_b128 v[168:171], v9 offset:12288
    v_mfma_f32_32x32x16_bf16 v[208:223], v[128:131], v[140:143], v[208:223]
    buffer_load_dwordx4 v[92:95], v4, s[16:19], s3 offen offset:1024 sc1
    v_mfma_f32_32x32x16_bf16 v[224:239], v[128:131], v[144:147], v[224:239]
    s_waitcnt lgkmcnt(0)
    v_mfma_f32_32x32x16_bf16 v[176:191], v[152:155], v[156:159], v[176:191]
    ds_read_b128 v[128:131], v18 offset:0
    ds_read_b128 v[132:135], v10 offset:0
    ds_read_b128 v[136:139], v10 offset:4096
    v_mfma_f32_32x32x16_bf16 v[192:207], v[152:155], v[160:163], v[192:207]
    ds_read_b128 v[140:143], v10 offset:8192
    ds_read_b128 v[144:147], v10 offset:12288
    buffer_load_dwordx4 v[96:99], v4, s[16:19], s3 offen offset:2048 sc1
    v_mfma_f32_32x32x16_bf16 v[208:223], v[152:155], v[164:167], v[208:223]
    v_mfma_f32_32x32x16_bf16 v[224:239], v[152:155], v[168:171], v[224:239]
    s_waitcnt lgkmcnt(0)
    v_mfma_f32_32x32x16_bf16 v[176:191], v[128:131], v[132:135], v[176:191]
    ds_read_b128 v[152:155], v19 offset:0
    ds_read_b128 v[156:159], v11 offset:0
    ds_read_b128 v[160:163], v11 offset:4096
    buffer_load_dwordx4 v[100:103], v4, s[16:19], s3 offen offset:3072 sc1
    v_mfma_f32_32x32x16_bf16 v[192:207], v[128:131], v[136:139], v[192:207]
    ds_read_b128 v[164:167], v11 offset:8192
    ds_read_b128 v[168:171], v11 offset:12288
    v_mfma_f32_32x32x16_bf16 v[208:223], v[128:131], v[140:143], v[208:223]
    v_mfma_f32_32x32x16_bf16 v[224:239], v[128:131], v[144:147], v[224:239]
    buffer_load_dwordx4 v[104:107], v5, s[16:19], s3 offen sc1
    s_waitcnt lgkmcnt(0)
    s_barrier
    v_mfma_f32_32x32x16_bf16 v[176:191], v[152:155], v[156:159], v[176:191]
    v_mfma_f32_32x32x16_bf16 v[192:207], v[152:155], v[160:163], v[192:207]
    v_mfma_f32_32x32x16_bf16 v[208:223], v[152:155], v[164:167], v[208:223]
    s_lshl2_add_u32 s3, s42, s98
    s_add_u32 s3, s3, s42
    buffer_load_dwordx4 v[108:111], v4, s[16:19], s3 offen sc1
    v_mfma_f32_32x32x16_bf16 v[224:239], v[152:155], v[168:171], v[224:239]
    buffer_load_dwordx4 v[112:115], v4, s[16:19], s3 offen offset:1024 sc1
    s_setprio 3
    s_waitcnt vmcnt(12)
    v_mfma_f32_32x32x16_bf16 v[176:191], v[252:255], v[240:243], v[176:191]
    v_mfma_f32_32x32x16_bf16 v[192:207], v[252:255], v[242:245], v[192:207]
    v_mfma_f32_32x32x16_bf16 v[208:223], v[252:255], v[244:247], v[208:223]
    v_mfma_f32_32x32x16_bf16 v[224:239], v[252:255], v[246:249], v[224:239]
    s_lshl2_add_u32 s3, s45, s98
    s_add_u32 s3, s3, s45
    s_add_u32 m0, s83, 40960
    s_nop 0
    buffer_load_dwordx4 v4, s[16:19], s3 offen sc1 lds
    s_add_u32 m0, s83, 48128
    s_nop 0
    buffer_load_dwordx4 v4, s[16:19], s3 offen offset:1024 sc1 lds
    v_mov_b32_e64 v48, 0
    ds_write_b32 v52, v48
    ds_write_b32 v52, v48 offset:8
    v_pk_mul_f32 v[176:177], v[176:177], v[32:33]
    v_pk_mul_f32 v[178:179], v[178:179], v[34:35]
    v_pk_mul_f32 v[180:181], v[180:181], v[36:37]
    v_pk_mul_f32 v[182:183], v[182:183], v[38:39]
    v_pk_mul_f32 v[184:185], v[184:185], v[40:41]
    v_pk_mul_f32 v[186:187], v[186:187], v[42:43]
    v_pk_mul_f32 v[188:189], v[188:189], v[44:45]
    v_pk_mul_f32 v[190:191], v[190:191], v[46:47]
    v_pk_mul_f32 v[192:193], v[192:193], v[32:33]
    v_pk_mul_f32 v[194:195], v[194:195], v[34:35]
    v_pk_mul_f32 v[196:197], v[196:197], v[36:37]
    v_pk_mul_f32 v[198:199], v[198:199], v[38:39]
    v_pk_mul_f32 v[200:201], v[200:201], v[40:41]
    v_pk_mul_f32 v[202:203], v[202:203], v[42:43]
    v_pk_mul_f32 v[204:205], v[204:205], v[44:45]
    v_pk_mul_f32 v[206:207], v[206:207], v[46:47]
    v_pk_mul_f32 v[208:209], v[208:209], v[32:33]
    v_pk_mul_f32 v[210:211], v[210:211], v[34:35]
    v_pk_mul_f32 v[212:213], v[212:213], v[36:37]
    v_pk_mul_f32 v[214:215], v[214:215], v[38:39]
    v_pk_mul_f32 v[216:217], v[216:217], v[40:41]
    v_pk_mul_f32 v[218:219], v[218:219], v[42:43]
    v_pk_mul_f32 v[220:221], v[220:221], v[44:45]
    v_pk_mul_f32 v[222:223], v[222:223], v[46:47]
    v_pk_mul_f32 v[224:225], v[224:225], v[32:33]
    v_pk_mul_f32 v[226:227], v[226:227], v[34:35]
    v_pk_mul_f32 v[228:229], v[228:229], v[36:37]
    v_pk_mul_f32 v[230:231], v[230:231], v[38:39]
    v_pk_mul_f32 v[232:233], v[232:233], v[40:41]
    v_pk_mul_f32 v[234:235], v[234:235], v[42:43]
    v_pk_mul_f32 v[236:237], v[236:237], v[44:45]
    v_pk_mul_f32 v[238:239], v[238:239], v[46:47]
    v_pk_fma_f32 v[12:13], v[24:25], v[176:177], v[178:179] op_sel_hi:[0,1,1]
    v_pk_fma_f32 v[20:21], v[28:29], v[208:209], v[210:211] op_sel_hi:[0,1,1]
    v_pk_fma_f32 v[14:15], v[24:25], v[192:193], v[194:195] op_sel_hi:[0,1,1]
    v_pk_fma_f32 v[22:23], v[28:29], v[224:225], v[226:227] op_sel_hi:[0,1,1]
    v_pk_fma_f32 v[12:13], v[24:25], v[192:193], v[12:13] op_sel:[1,0,0] neg_lo:[1,0,0] neg_hi:[1,0,0]
    v_pk_fma_f32 v[20:21], v[28:29], v[224:225], v[20:21] op_sel:[1,0,0] neg_lo:[1,0,0] neg_hi:[1,0,0]
    v_pk_fma_f32 v[14:15], v[24:25], v[176:177], v[14:15] op_sel:[1,0,0]
    v_pk_fma_f32 v[22:23], v[28:29], v[208:209], v[22:23] op_sel:[1,0,0]
    v_pk_fma_f32 v[8:9], v[24:25], v[12:13], v[180:181] op_sel_hi:[0,1,1]
    v_pk_fma_f32 v[16:17], v[28:29], v[20:21], v[212:213] op_sel_hi:[0,1,1]
    v_pk_fma_f32 v[10:11], v[24:25], v[14:15], v[196:197] op_sel_hi:[0,1,1]
    v_pk_fma_f32 v[18:19], v[28:29], v[22:23], v[228:229] op_sel_hi:[0,1,1]
    v_pk_fma_f32 v[8:9], v[24:25], v[14:15], v[8:9] op_sel:[1,0,0] neg_lo:[1,0,0] neg_hi:[1,0,0]
    v_pk_fma_f32 v[16:17], v[28:29], v[22:23], v[16:17] op_sel:[1,0,0] neg_lo:[1,0,0] neg_hi:[1,0,0]
    v_pk_fma_f32 v[10:11], v[24:25], v[12:13], v[10:11] op_sel:[1,0,0]
    v_pk_fma_f32 v[18:19], v[28:29], v[20:21], v[18:19] op_sel:[1,0,0]
    v_pk_fma_f32 v[12:13], v[24:25], v[8:9], v[182:183] op_sel_hi:[0,1,1]
    v_pk_fma_f32 v[20:21], v[28:29], v[16:17], v[214:215] op_sel_hi:[0,1,1]
    v_pk_fma_f32 v[14:15], v[24:25], v[10:11], v[198:199] op_sel_hi:[0,1,1]
    v_pk_fma_f32 v[22:23], v[28:29], v[18:19], v[230:231] op_sel_hi:[0,1,1]
    v_pk_fma_f32 v[12:13], v[24:25], v[10:11], v[12:13] op_sel:[1,0,0] neg_lo:[1,0,0] neg_hi:[1,0,0]
    v_pk_fma_f32 v[20:21], v[28:29], v[18:19], v[20:21] op_sel:[1,0,0] neg_lo:[1,0,0] neg_hi:[1,0,0]
    v_pk_fma_f32 v[14:15], v[24:25], v[8:9], v[14:15] op_sel:[1,0,0]
    v_pk_fma_f32 v[22:23], v[28:29], v[16:17], v[22:23] op_sel:[1,0,0]
    v_pk_fma_f32 v[8:9], v[24:25], v[12:13], v[184:185] op_sel_hi:[0,1,1]
    v_pk_fma_f32 v[16:17], v[28:29], v[20:21], v[216:217] op_sel_hi:[0,1,1]
    v_pk_fma_f32 v[10:11], v[24:25], v[14:15], v[200:201] op_sel_hi:[0,1,1]
    v_pk_fma_f32 v[18:19], v[28:29], v[22:23], v[232:233] op_sel_hi:[0,1,1]
    v_pk_fma_f32 v[8:9], v[24:25], v[14:15], v[8:9] op_sel:[1,0,0] neg_lo:[1,0,0] neg_hi:[1,0,0]
    v_pk_fma_f32 v[16:17], v[28:29], v[22:23], v[16:17] op_sel:[1,0,0] neg_lo:[1,0,0] neg_hi:[1,0,0]
    v_pk_fma_f32 v[10:11], v[24:25], v[12:13], v[10:11] op_sel:[1,0,0]
    v_pk_fma_f32 v[18:19], v[28:29], v[20:21], v[18:19] op_sel:[1,0,0]
    v_pk_fma_f32 v[12:13], v[24:25], v[8:9], v[186:187] op_sel_hi:[0,1,1]
    v_pk_fma_f32 v[20:21], v[28:29], v[16:17], v[218:219] op_sel_hi:[0,1,1]
    v_pk_fma_f32 v[14:15], v[24:25], v[10:11], v[202:203] op_sel_hi:[0,1,1]
    v_pk_fma_f32 v[22:23], v[28:29], v[18:19], v[234:235] op_sel_hi:[0,1,1]
    v_pk_fma_f32 v[12:13], v[24:25], v[10:11], v[12:13] op_sel:[1,0,0] neg_lo:[1,0,0] neg_hi:[1,0,0]
    v_pk_fma_f32 v[20:21], v[28:29], v[18:19], v[20:21] op_sel:[1,0,0] neg_lo:[1,0,0] neg_hi:[1,0,0]
    v_pk_fma_f32 v[14:15], v[24:25], v[8:9], v[14:15] op_sel:[1,0,0]
    v_pk_fma_f32 v[22:23], v[28:29], v[16:17], v[22:23] op_sel:[1,0,0]
    v_pk_fma_f32 v[8:9], v[24:25], v[12:13], v[188:189] op_sel_hi:[0,1,1]
    v_pk_fma_f32 v[16:17], v[28:29], v[20:21], v[220:221] op_sel_hi:[0,1,1]
    v_pk_fma_f32 v[10:11], v[24:25], v[14:15], v[204:205] op_sel_hi:[0,1,1]
    v_pk_fma_f32 v[18:19], v[28:29], v[22:23], v[236:237] op_sel_hi:[0,1,1]
    v_pk_fma_f32 v[8:9], v[24:25], v[14:15], v[8:9] op_sel:[1,0,0] neg_lo:[1,0,0] neg_hi:[1,0,0]
    v_pk_fma_f32 v[16:17], v[28:29], v[22:23], v[16:17] op_sel:[1,0,0] neg_lo:[1,0,0] neg_hi:[1,0,0]
    v_pk_fma_f32 v[10:11], v[24:25], v[12:13], v[10:11] op_sel:[1,0,0]
    v_pk_fma_f32 v[18:19], v[28:29], v[20:21], v[18:19] op_sel:[1,0,0]
    v_pk_fma_f32 v[12:13], v[24:25], v[8:9], v[190:191] op_sel_hi:[0,1,1]
    v_pk_fma_f32 v[20:21], v[28:29], v[16:17], v[222:223] op_sel_hi:[0,1,1]
    v_pk_fma_f32 v[14:15], v[24:25], v[10:11], v[206:207] op_sel_hi:[0,1,1]
    v_pk_fma_f32 v[22:23], v[28:29], v[18:19], v[238:239] op_sel_hi:[0,1,1]
    v_pk_fma_f32 v[12:13], v[24:25], v[10:11], v[12:13] op_sel:[1,0,0] neg_lo:[1,0,0] neg_hi:[1,0,0]
    v_pk_fma_f32 v[20:21], v[28:29], v[18:19], v[20:21] op_sel:[1,0,0] neg_lo:[1,0,0] neg_hi:[1,0,0]
    v_pk_fma_f32 v[14:15], v[24:25], v[8:9], v[14:15] op_sel:[1,0,0]
    v_pk_fma_f32 v[22:23], v[28:29], v[16:17], v[22:23] op_sel:[1,0,0]
    v_fma_f32 v10, v60, v12, v13
    v_fma_f32 v18, v62, v20, v21
    v_fma_f32 v11, v60, v14, v15
    v_fma_f32 v19, v62, v22, v23
    v_fma_f32 v10, -v61, v14, v10
    v_fma_f32 v18, -v63, v22, v18
    v_fmac_f32 v11, v61, v12
    v_fmac_f32 v19, v63, v20
    v_mov_b32 v8, v10
    v_mov_b32 v16, v18
    v_mov_b32 v9, v11
    v_mov_b32 v17, v19
    v_permlane32_swap_b32 v10, v18
    v_permlane32_swap_b32 v11, v19
    v_pk_fma_f32 v[18:19], v[56:57], v[10:11], v[18:19] op_sel_hi:[0,1,1]
    v_pk_fma_f32 v[18:19], v[56:57], v[10:11], v[18:19] op_sel:[1,1,0] op_sel_hi:[1,0,1] neg_lo:[1,0,0]
    v_min_u32 v18, -2, v18
    v_min_u32 v19, -2, v19
    buffer_store_dwordx2 v[18:19], v6, s[16:19], 0 offen sc1
    ds_write_b32 v52, v18 offset:4096
    ds_write_b32 v52, v19 offset:4104
    s_setprio 0
    s_add_u32 m0, s83, 55296
    s_nop 0
    buffer_load_dwordx4 v4, s[16:19], s3 offen offset:2048 sc1 lds
    s_add_u32 m0, s83, 62464
    s_nop 0
    buffer_load_dwordx4 v4, s[16:19], s3 offen offset:3072 sc1 lds
    s_add_u32 m0, s83, 73728
    s_nop 0
    buffer_load_dwordx4 v5, s[16:19], s3 offen sc1 lds
    s_lshl2_add_u32 s3, s46, s98
    s_add_u32 s3, s3, s46
    buffer_load_dwordx4 v[128:131], v4, s[16:19], s3 offen sc1
    buffer_load_dwordx4 v[132:135], v4, s[16:19], s3 offen offset:1024 sc1
    buffer_load_dwordx4 v[136:139], v4, s[16:19], s3 offen offset:2048 sc1
    v_pk_mul_f32 v[48:49], v[26:27], v[192:193] op_sel:[1,0]
    v_pk_mul_f32 v[50:51], v[26:27], v[176:177] op_sel:[1,0]
    v_pk_fma_f32 v[176:177], v[26:27], v[176:177], v[48:49] op_sel_hi:[0,1,1] neg_lo:[0,0,1] neg_hi:[0,0,1]
    v_pk_fma_f32 v[192:193], v[26:27], v[192:193], v[50:51] op_sel_hi:[0,1,1]
    v_pk_mul_f32 v[168:169], v[26:27], v[194:195] op_sel:[1,0]
    v_pk_mul_f32 v[170:171], v[26:27], v[178:179] op_sel:[1,0]
    v_pk_fma_f32 v[178:179], v[26:27], v[178:179], v[168:169] op_sel_hi:[0,1,1] neg_lo:[0,0,1] neg_hi:[0,0,1]
    v_pk_fma_f32 v[194:195], v[26:27], v[194:195], v[170:171] op_sel_hi:[0,1,1]
    v_pk_mul_f32 v[48:49], v[26:27], v[196:197] op_sel:[1,0]
    v_pk_mul_f32 v[50:51], v[26:27], v[180:181] op_sel:[1,0]
    v_pk_fma_f32 v[180:181], v[26:27], v[180:181], v[48:49] op_sel_hi:[0,1,1] neg_lo:[0,0,1] neg_hi:[0,0,1]
    v_pk_fma_f32 v[196:197], v[26:27], v[196:197], v[50:51] op_sel_hi:[0,1,1]
    v_pk_mul_f32 v[168:169], v[26:27], v[198:199] op_sel:[1,0]
    v_pk_mul_f32 v[170:171], v[26:27], v[182:183] op_sel:[1,0]
    v_pk_fma_f32 v[182:183], v[26:27], v[182:183], v[168:169] op_sel_hi:[0,1,1] neg_lo:[0,0,1] neg_hi:[0,0,1]
    v_pk_fma_f32 v[198:199], v[26:27], v[198:199], v[170:171] op_sel_hi:[0,1,1]
    v_pk_mul_f32 v[48:49], v[26:27], v[200:201] op_sel:[1,0]
    v_pk_mul_f32 v[50:51], v[26:27], v[184:185] op_sel:[1,0]
    v_pk_fma_f32 v[184:185], v[26:27], v[184:185], v[48:49] op_sel_hi:[0,1,1] neg_lo:[0,0,1] neg_hi:[0,0,1]
    v_pk_fma_f32 v[200:201], v[26:27], v[200:201], v[50:51] op_sel_hi:[0,1,1]
    v_pk_mul_f32 v[168:169], v[26:27], v[202:203] op_sel:[1,0]
    v_pk_mul_f32 v[170:171], v[26:27], v[186:187] op_sel:[1,0]
    v_pk_fma_f32 v[186:187], v[26:27], v[186:187], v[168:169] op_sel_hi:[0,1,1] neg_lo:[0,0,1] neg_hi:[0,0,1]
    v_pk_fma_f32 v[202:203], v[26:27], v[202:203], v[170:171] op_sel_hi:[0,1,1]
    v_pk_mul_f32 v[48:49], v[26:27], v[204:205] op_sel:[1,0]
    v_pk_mul_f32 v[50:51], v[26:27], v[188:189] op_sel:[1,0]
    v_pk_fma_f32 v[188:189], v[26:27], v[188:189], v[48:49] op_sel_hi:[0,1,1] neg_lo:[0,0,1] neg_hi:[0,0,1]
    v_pk_fma_f32 v[204:205], v[26:27], v[204:205], v[50:51] op_sel_hi:[0,1,1]
    v_pk_mul_f32 v[168:169], v[26:27], v[206:207] op_sel:[1,0]
    v_pk_mul_f32 v[170:171], v[26:27], v[190:191] op_sel:[1,0]
    v_pk_fma_f32 v[190:191], v[26:27], v[190:191], v[168:169] op_sel_hi:[0,1,1] neg_lo:[0,0,1] neg_hi:[0,0,1]
    v_pk_fma_f32 v[206:207], v[26:27], v[206:207], v[170:171] op_sel_hi:[0,1,1]
    v_pk_mul_f32 v[48:49], v[30:31], v[224:225] op_sel:[1,0]
    v_pk_mul_f32 v[50:51], v[30:31], v[208:209] op_sel:[1,0]
    v_pk_fma_f32 v[208:209], v[30:31], v[208:209], v[48:49] op_sel_hi:[0,1,1] neg_lo:[0,0,1] neg_hi:[0,0,1]
    v_pk_fma_f32 v[224:225], v[30:31], v[224:225], v[50:51] op_sel_hi:[0,1,1]
    v_pk_mul_f32 v[168:169], v[30:31], v[226:227] op_sel:[1,0]
    v_pk_mul_f32 v[170:171], v[30:31], v[210:211] op_sel:[1,0]
    v_pk_fma_f32 v[210:211], v[30:31], v[210:211], v[168:169] op_sel_hi:[0,1,1] neg_lo:[0,0,1] neg_hi:[0,0,1]
    v_pk_fma_f32 v[226:227], v[30:31], v[226:227], v[170:171] op_sel_hi:[0,1,1]
    v_pk_mul_f32 v[48:49], v[30:31], v[228:229] op_sel:[1,0]
    v_pk_mul_f32 v[50:51], v[30:31], v[212:213] op_sel:[1,0]
    v_pk_fma_f32 v[212:213], v[30:31], v[212:213], v[48:49] op_sel_hi:[0,1,1] neg_lo:[0,0,1] neg_hi:[0,0,1]
    v_pk_fma_f32 v[228:229], v[30:31], v[228:229], v[50:51] op_sel_hi:[0,1,1]
    v_pk_mul_f32 v[168:169], v[30:31], v[230:231] op_sel:[1,0]
    v_pk_mul_f32 v[170:171], v[30:31], v[214:215] op_sel:[1,0]
    v_pk_fma_f32 v[214:215], v[30:31], v[214:215], v[168:169] op_sel_hi:[0,1,1] neg_lo:[0,0,1] neg_hi:[0,0,1]
    v_pk_fma_f32 v[230:231], v[30:31], v[230:231], v[170:171] op_sel_hi:[0,1,1]
    v_pk_mul_f32 v[48:49], v[30:31], v[232:233] op_sel:[1,0]
    v_pk_mul_f32 v[50:51], v[30:31], v[216:217] op_sel:[1,0]
    v_pk_fma_f32 v[216:217], v[30:31], v[216:217], v[48:49] op_sel_hi:[0,1,1] neg_lo:[0,0,1] neg_hi:[0,0,1]
    v_pk_fma_f32 v[232:233], v[30:31], v[232:233], v[50:51] op_sel_hi:[0,1,1]
    v_pk_mul_f32 v[168:169], v[30:31], v[234:235] op_sel:[1,0]
    v_pk_mul_f32 v[170:171], v[30:31], v[218:219] op_sel:[1,0]
    v_pk_fma_f32 v[218:219], v[30:31], v[218:219], v[168:169] op_sel_hi:[0,1,1] neg_lo:[0,0,1] neg_hi:[0,0,1]
    v_pk_fma_f32 v[234:235], v[30:31], v[234:235], v[170:171] op_sel_hi:[0,1,1]
    v_pk_mul_f32 v[48:49], v[30:31], v[236:237] op_sel:[1,0]
    v_pk_mul_f32 v[50:51], v[30:31], v[220:221] op_sel:[1,0]
    v_pk_fma_f32 v[220:221], v[30:31], v[220:221], v[48:49] op_sel_hi:[0,1,1] neg_lo:[0,0,1] neg_hi:[0,0,1]
    v_pk_fma_f32 v[236:237], v[30:31], v[236:237], v[50:51] op_sel_hi:[0,1,1]
    v_pk_mul_f32 v[168:169], v[30:31], v[238:239] op_sel:[1,0]
    v_pk_mul_f32 v[170:171], v[30:31], v[222:223] op_sel:[1,0]
    v_pk_fma_f32 v[222:223], v[30:31], v[222:223], v[168:169] op_sel_hi:[0,1,1] neg_lo:[0,0,1] neg_hi:[0,0,1]
    v_pk_fma_f32 v[238:239], v[30:31], v[238:239], v[170:171] op_sel_hi:[0,1,1]
    s_bitcmp0_b32 s74, 0
    s_cselect_b32 s88, 40952, 0
    buffer_load_dwordx4 v[240:243], v6, s[16:19], s88 offen sc1
    s_add_u32 s88, s88, 40960
    buffer_load_dwordx4 v[244:247], v6, s[16:19], s88 offen sc1
    s_add_u32 s88, s88, 40960
    buffer_load_dwordx4 v[248:251], v6, s[16:19], s88 offen sc1
    s_add_u32 s88, s88, 40960
    buffer_load_dwordx4 v[252:255], v6, s[16:19], s88 offen sc1
    s_add_u32 s88, s88, 40960
    buffer_load_dwordx4 v[32:35], v6, s[16:19], s88 offen sc1
    s_add_u32 s88, s88, 40960
    buffer_load_dwordx4 v[36:39], v6, s[16:19], s88 offen sc1
    s_add_u32 s88, s88, 40960
    buffer_load_dwordx4 v[40:43], v6, s[16:19], s88 offen sc1
    s_add_u32 s88, s88, 40960
    buffer_load_dwordx4 v[44:47], v6, s[16:19], s88 offen sc1
    v_cmp_gt_u32 vcc, 32, v1
    v_mov_b32 v10, 0
    v_mov_b32_e64 v11, 0
    s_nop 0
    v_permlane32_swap_b32 v10, v8
    v_permlane32_swap_b32 v11, v9
    v_fma_f32 v13, v60, v10, v12
    v_fma_f32 v15, v60, v11, v14
    v_fma_f32 v13, -v61, v11, v13
    v_fmac_f32 v15, v61, v10
    v_mov_b32 v12, v10
    v_mov_b32_e64 v14, v11
    v_pk_mul_f32 v[8:9], v[26:27], v[12:13] op_sel_hi:[0,1]
    v_pk_mul_f32 v[10:11], v[26:27], v[14:15] op_sel_hi:[0,1]
    v_pk_fma_f32 v[8:9], v[26:27], v[14:15], v[8:9] op_sel:[1,0,0] neg_lo:[1,0,0] neg_hi:[1,0,0]
    v_pk_fma_f32 v[10:11], v[26:27], v[12:13], v[10:11] op_sel:[1,0,0]
    v_mov_b32 v64, v60
    v_mov_b32 v66, v61
    v_mul_f32 v48, v66, v66
    v_mul_f32 v66, v64, v66
    v_fma_f32 v64, v64, v64, -v48
    v_add_f32 v66, v66, v66
    v_mul_f32 v48, v64, v26
    v_mul_f32_e64 v49, v64, v27
    v_fma_f32 v48, -v66, v27, v48
    v_fmac_f32 v49, v66, v26
    v_cndmask_b32 v168, v48, v26, vcc
    v_cndmask_b32 v170, v49, v27, vcc
    v_mul_f32 v169, v168, v60
    v_mul_f32_e64 v171, v168, v61
    v_fma_f32 v169, -v170, v61, v169
    v_fmac_f32 v171, v170, v60
    v_mul_f32 v48, v66, v66
    v_mul_f32_e64 v66, v64, v66
    v_fma_f32 v64, v64, v64, -v48
    v_add_f32 v66, v66, v66
    v_mov_b32 v18, 0
    v_mov_b32 v19, 0
    s_nop 0
    v_permlane32_swap_b32 v18, v16
    v_permlane32_swap_b32 v19, v17
    v_fma_f32 v21, v62, v18, v20
    v_fma_f32 v23, v62, v19, v22
    v_fma_f32 v21, -v63, v19, v21
    v_fmac_f32 v23, v63, v18
    v_mov_b32 v20, v18
    v_mov_b32_e64 v22, v19
    v_pk_mul_f32 v[16:17], v[30:31], v[20:21] op_sel_hi:[0,1]
    v_pk_mul_f32 v[18:19], v[30:31], v[22:23] op_sel_hi:[0,1]
    v_pk_fma_f32 v[16:17], v[30:31], v[22:23], v[16:17] op_sel:[1,0,0] neg_lo:[1,0,0] neg_hi:[1,0,0]
    v_pk_fma_f32 v[18:19], v[30:31], v[20:21], v[18:19] op_sel:[1,0,0]
    v_mov_b32 v65, v62
    v_mov_b32 v67, v63
    v_mul_f32 v48, v67, v67
    v_mul_f32 v67, v65, v67
    v_fma_f32 v65, v65, v65, -v48
    v_add_f32 v67, v67, v67
    v_mul_f32 v48, v65, v30
    v_mul_f32_e64 v49, v65, v31
    v_fma_f32 v48, -v67, v31, v48
    v_fmac_f32 v49, v67, v30
    v_cndmask_b32 v172, v48, v30, vcc
    v_cndmask_b32 v174, v49, v31, vcc
    v_mul_f32 v173, v172, v62
    v_mul_f32_e64 v175, v172, v63
    v_fma_f32 v173, -v174, v63, v173
    v_fmac_f32 v175, v174, v62
    v_mul_f32 v48, v67, v67
    v_mul_f32_e64 v67, v65, v67
    v_fma_f32 v65, v65, v65, -v48
    v_add_f32 v67, v67, v67
    s_waitcnt vmcnt(14)
    s_waitcnt vmcnt(0)
L_gpoll:
    v_max_u32 v48, v240, v241
    v_max3_u32 v48, v242, v243, v48
    v_max3_u32 v48, v244, v245, v48
    v_max3_u32 v48, v246, v247, v48
    v_max3_u32 v48, v248, v249, v48
    v_max3_u32 v48, v250, v251, v48
    v_max3_u32 v48, v252, v253, v48
    v_max3_u32 v48, v254, v255, v48
    v_max3_u32 v48, v32, v33, v48
    v_max3_u32 v48, v34, v35, v48
    v_max3_u32 v48, v36, v37, v48
    v_max3_u32 v48, v38, v39, v48
    v_max3_u32 v48, v40, v41, v48
    v_max3_u32 v48, v42, v43, v48
    v_max3_u32 v48, v44, v45, v48
    v_max3_u32 v48, v46, v47, v48
    v_cmp_eq_u32_e64 vcc, -1, v48
    s_nop 0
    s_cmp_eq_u64 vcc, 0
    s_cbranch_scc1 L_gdone
    s_bitcmp0_b32 s74, 0
    s_cselect_b32 s88, 40952, 0
    buffer_load_dwordx4 v[240:243], v6, s[16:19], s88 offen sc1
    s_add_u32 s88, s88, 40960
    buffer_load_dwordx4 v[244:247], v6, s[16:19], s88 offen sc1
    s_add_u32 s88, s88, 40960
    buffer_load_dwordx4 v[248:251], v6, s[16:19], s88 offen sc1
    s_add_u32 s88, s88, 40960
    buffer_load_dwordx4 v[252:255], v6, s[16:19], s88 offen sc1
    s_add_u32 s88, s88, 40960
    buffer_load_dwordx4 v[32:35], v6, s[16:19], s88 offen sc1
    s_add_u32 s88, s88, 40960
    buffer_load_dwordx4 v[36:39], v6, s[16:19], s88 offen sc1
    s_add_u32 s88, s88, 40960
    buffer_load_dwordx4 v[40:43], v6, s[16:19], s88 offen sc1
    s_add_u32 s88, s88, 40960
    buffer_load_dwordx4 v[44:47], v6, s[16:19], s88 offen sc1
    s_waitcnt vmcnt(0)
    s_sub_u32 s99, s99, 1
    s_cmp_gt_i32 s99, 0
    s_cbranch_scc1 L_gpoll
L_gdone:
    v_pk_fma_f32 v[44:45], v[58:59], v[46:47], v[44:45] op_sel_hi:[0,1,1]
    v_pk_fma_f32 v[44:45], v[58:59], v[46:47], v[44:45] op_sel:[1,1,0] op_sel_hi:[1,0,1] neg_lo:[1,0,0]
    v_pk_fma_f32 v[42:43], v[58:59], v[44:45], v[42:43] op_sel_hi:[0,1,1]
    v_pk_fma_f32 v[42:43], v[58:59], v[44:45], v[42:43] op_sel:[1,1,0] op_sel_hi:[1,0,1] neg_lo:[1,0,0]
    v_pk_fma_f32 v[40:41], v[58:59], v[42:43], v[40:41] op_sel_hi:[0,1,1]
    v_pk_fma_f32 v[40:41], v[58:59], v[42:43], v[40:41] op_sel:[1,1,0] op_sel_hi:[1,0,1] neg_lo:[1,0,0]
    v_pk_fma_f32 v[38:39], v[58:59], v[40:41], v[38:39] op_sel_hi:[0,1,1]
    v_pk_fma_f32 v[38:39], v[58:59], v[40:41], v[38:39] op_sel:[1,1,0] op_sel_hi:[1,0,1] neg_lo:[1,0,0]
    v_pk_fma_f32 v[36:37], v[58:59], v[38:39], v[36:37] op_sel_hi:[0,1,1]
    v_pk_fma_f32 v[36:37], v[58:59], v[38:39], v[36:37] op_sel:[1,1,0] op_sel_hi:[1,0,1] neg_lo:[1,0,0]
    v_pk_fma_f32 v[34:35], v[58:59], v[36:37], v[34:35] op_sel_hi:[0,1,1]
    v_pk_fma_f32 v[34:35], v[58:59], v[36:37], v[34:35] op_sel:[1,1,0] op_sel_hi:[1,0,1] neg_lo:[1,0,0]
    v_pk_fma_f32 v[32:33], v[58:59], v[34:35], v[32:33] op_sel_hi:[0,1,1]
    v_pk_fma_f32 v[32:33], v[58:59], v[34:35], v[32:33] op_sel:[1,1,0] op_sel_hi:[1,0,1] neg_lo:[1,0,0]
    v_pk_fma_f32 v[254:255], v[58:59], v[32:33], v[254:255] op_sel_hi:[0,1,1]
    v_pk_fma_f32 v[254:255], v[58:59], v[32:33], v[254:255] op_sel:[1,1,0] op_sel_hi:[1,0,1] neg_lo:[1,0,0]
    v_pk_fma_f32 v[252:253], v[58:59], v[254:255], v[252:253] op_sel_hi:[0,1,1]
    v_pk_fma_f32 v[252:253], v[58:59], v[254:255], v[252:253] op_sel:[1,1,0] op_sel_hi:[1,0,1] neg_lo:[1,0,0]
    v_pk_fma_f32 v[250:251], v[58:59], v[252:253], v[250:251] op_sel_hi:[0,1,1]
    v_pk_fma_f32 v[250:251], v[58:59], v[252:253], v[250:251] op_sel:[1,1,0] op_sel_hi:[1,0,1] neg_lo:[1,0,0]
    v_pk_fma_f32 v[248:249], v[58:59], v[250:251], v[248:249] op_sel_hi:[0,1,1]
    v_pk_fma_f32 v[248:249], v[58:59], v[250:251], v[248:249] op_sel:[1,1,0] op_sel_hi:[1,0,1] neg_lo:[1,0,0]
    v_pk_fma_f32 v[246:247], v[58:59], v[248:249], v[246:247] op_sel_hi:[0,1,1]
    v_pk_fma_f32 v[246:247], v[58:59], v[248:249], v[246:247] op_sel:[1,1,0] op_sel_hi:[1,0,1] neg_lo:[1,0,0]
    v_pk_fma_f32 v[244:245], v[58:59], v[246:247], v[244:245] op_sel_hi:[0,1,1]
    v_pk_fma_f32 v[244:245], v[58:59], v[246:247], v[244:245] op_sel:[1,1,0] op_sel_hi:[1,0,1] neg_lo:[1,0,0]
    v_pk_fma_f32 v[242:243], v[58:59], v[244:245], v[242:243] op_sel_hi:[0,1,1]
    v_pk_fma_f32 v[242:243], v[58:59], v[244:245], v[242:243] op_sel:[1,1,0] op_sel_hi:[1,0,1] neg_lo:[1,0,0]
    v_pk_fma_f32 v[240:241], v[58:59], v[242:243], v[240:241] op_sel_hi:[0,1,1]
    v_pk_fma_f32 v[240:241], v[58:59], v[242:243], v[240:241] op_sel:[1,1,0] op_sel_hi:[1,0,1] neg_lo:[1,0,0]
    s_bitcmp0_b32 s74, 0
    s_cselect_b64 vcc, -1, 0
    v_cndmask_b32 v240, v242, v240, vcc
    v_cndmask_b32 v241, v243, v241, vcc
    ds_write_b32 v52, v240 offset:2048
    ds_write_b32 v52, v241 offset:2056
    s_mul_i32 s88, s62, 52
    s_lshr_b32 s88, s88, 8
    s_lshl_b32 s88, s88, 12
    s_add_u32 s88, s88, 16221184
    v_mov_b32 v48, s88
    s_lshr_b32 s89, s62, 1
    s_lshl_b32 s89, s89, 12
    s_add_u32 s89, s89, 16249856
    v_mov_b32 v6, s89
    v_cmp_gt_u32 vcc, 32, v1
    s_nop 1
    v_cndmask_b32 v6, v6, v48, vcc
    v_lshl_add_u32 v6, v1, 7, v6
    s_cmp_eq_u32 s68, 0
    s_cselect_b32 vcc_lo, 0x7ffffff, 0
    s_cselect_b32 vcc_hi, 0x1f, 0
    v_mov_b32 v48, 1073741824
    v_cndmask_b32 v6, v48, v6, vcc
    buffer_load_dwordx4 v[140:143], v4, s[16:19], s3 offen offset:3072 sc1
    buffer_load_dwordx4 v[144:147], v5, s[16:19], s3 offen sc1
    s_lshl2_add_u32 s3, s50, s98
    s_add_u32 s3, s3, s50
    buffer_load_dwordx4 v[148:151], v4, s[16:19], s3 offen sc1
    buffer_load_dwordx4 v[152:155], v4, s[16:19], s3 offen offset:1024 sc1
    s_waitcnt lgkmcnt(0)
    s_barrier
    ds_read_b128 v[32:35], v53 offset:512
    ds_read_b128 v[36:39], v53 offset:1024
    ds_read_b128 v[40:43], v53 offset:1536
    ds_read_b128 v[44:47], v53 offset:2048
    ds_read_b128 v[240:243], v53 offset:2560
    ds_read_b128 v[244:247], v53 offset:3072
    ds_read_b128 v[248:251], v53 offset:3584
    s_waitcnt lgkmcnt(5)
    s_nop 0
    v_pk_fma_f32 v[36:37], v[64:65], v[32:33], v[36:37]
    v_pk_fma_f32 v[38:39], v[64:65], v[34:35], v[38:39]
    v_pk_fma_f32 v[36:37], v[66:67], v[34:35], v[36:37] neg_lo:[1,0,0] neg_hi:[1,0,0]
    v_pk_fma_f32 v[38:39], v[66:67], v[32:33], v[38:39]
    s_waitcnt lgkmcnt(4)
    s_nop 0
    v_pk_fma_f32 v[40:41], v[64:65], v[36:37], v[40:41]
    v_pk_fma_f32 v[42:43], v[64:65], v[38:39], v[42:43]
    v_pk_fma_f32 v[40:41], v[66:67], v[38:39], v[40:41] neg_lo:[1,0,0] neg_hi:[1,0,0]
    v_pk_fma_f32 v[42:43], v[66:67], v[36:37], v[42:43]
    s_waitcnt lgkmcnt(3)
    s_nop 0
    v_pk_fma_f32 v[44:45], v[64:65], v[40:41], v[44:45]
    v_pk_fma_f32 v[46:47], v[64:65], v[42:43], v[46:47]
    v_pk_fma_f32 v[44:45], v[66:67], v[42:43], v[44:45] neg_lo:[1,0,0] neg_hi:[1,0,0]
    v_pk_fma_f32 v[46:47], v[66:67], v[40:41], v[46:47]
    s_waitcnt lgkmcnt(2)
    s_nop 0
    v_pk_fma_f32 v[240:241], v[64:65], v[44:45], v[240:241]
    v_pk_fma_f32 v[242:243], v[64:65], v[46:47], v[242:243]
    v_pk_fma_f32 v[240:241], v[66:67], v[46:47], v[240:241] neg_lo:[1,0,0] neg_hi:[1,0,0]
    v_pk_fma_f32 v[242:243], v[66:67], v[44:45], v[242:243]
    s_waitcnt lgkmcnt(1)
    s_nop 0
    v_pk_fma_f32 v[244:245], v[64:65], v[240:241], v[244:245]
    v_pk_fma_f32 v[246:247], v[64:65], v[242:243], v[246:247]
    v_pk_fma_f32 v[244:245], v[66:67], v[242:243], v[244:245] neg_lo:[1,0,0] neg_hi:[1,0,0]
    v_pk_fma_f32 v[246:247], v[66:67], v[240:241], v[246:247]
    s_waitcnt lgkmcnt(0)
    s_nop 0
    v_pk_fma_f32 v[248:249], v[64:65], v[244:245], v[248:249]
    v_pk_fma_f32 v[250:251], v[64:65], v[246:247], v[250:251]
    v_pk_fma_f32 v[248:249], v[66:67], v[246:247], v[248:249] neg_lo:[1,0,0] neg_hi:[1,0,0]
    v_pk_fma_f32 v[250:251], v[66:67], v[244:245], v[250:251]
    v_pk_fma_f32 v[8:9], v[248:249], v[168:169], v[8:9] op_sel:[0,0,0] op_sel_hi:[0,1,1]
    v_pk_fma_f32 v[16:17], v[248:249], v[172:173], v[16:17] op_sel:[1,0,0] op_sel_hi:[1,1,1]
    v_pk_fma_f32 v[10:11], v[250:251], v[168:169], v[10:11] op_sel:[0,0,0] op_sel_hi:[0,1,1]
    v_pk_fma_f32 v[18:19], v[250:251], v[172:173], v[18:19] op_sel:[1,0,0] op_sel_hi:[1,1,1]
    v_pk_fma_f32 v[8:9], v[250:251], v[170:171], v[8:9] op_sel:[0,0,0] op_sel_hi:[0,1,1] neg_lo:[1,0,0] neg_hi:[1,0,0]
    v_pk_fma_f32 v[16:17], v[250:251], v[174:175], v[16:17] op_sel:[1,0,0] op_sel_hi:[1,1,1] neg_lo:[1,0,0] neg_hi:[1,0,0]
    v_pk_fma_f32 v[10:11], v[248:249], v[170:171], v[10:11] op_sel:[0,0,0] op_sel_hi:[0,1,1]
    v_pk_fma_f32 v[18:19], v[248:249], v[174:175], v[18:19] op_sel:[1,0,0] op_sel_hi:[1,1,1]
    v_pk_fma_f32 v[176:177], v[24:25], v[8:9], v[176:177] op_sel_hi:[0,1,1]
    v_pk_fma_f32 v[192:193], v[24:25], v[10:11], v[192:193] op_sel_hi:[0,1,1]
    v_pk_fma_f32 v[176:177], v[24:25], v[10:11], v[176:177] op_sel:[1,0,0] neg_lo:[1,0,0] neg_hi:[1,0,0]
    v_pk_fma_f32 v[192:193], v[24:25], v[8:9], v[192:193] op_sel:[1,0,0]
    v_pk_fma_f32 v[178:179], v[24:25], v[176:177], v[178:179] op_sel_hi:[0,1,1]
    v_pk_fma_f32 v[194:195], v[24:25], v[192:193], v[194:195] op_sel_hi:[0,1,1]
    v_pk_fma_f32 v[178:179], v[24:25], v[192:193], v[178:179] op_sel:[1,0,0] neg_lo:[1,0,0] neg_hi:[1,0,0]
    v_pk_fma_f32 v[194:195], v[24:25], v[176:177], v[194:195] op_sel:[1,0,0]
    v_pk_fma_f32 v[180:181], v[24:25], v[178:179], v[180:181] op_sel_hi:[0,1,1]
    v_pk_fma_f32 v[196:197], v[24:25], v[194:195], v[196:197] op_sel_hi:[0,1,1]
    v_pk_fma_f32 v[180:181], v[24:25], v[194:195], v[180:181] op_sel:[1,0,0] neg_lo:[1,0,0] neg_hi:[1,0,0]
    v_pk_fma_f32 v[196:197], v[24:25], v[178:179], v[196:197] op_sel:[1,0,0]
    v_pk_fma_f32 v[182:183], v[24:25], v[180:181], v[182:183] op_sel_hi:[0,1,1]
    v_pk_fma_f32 v[198:199], v[24:25], v[196:197], v[198:199] op_sel_hi:[0,1,1]
    v_pk_fma_f32 v[182:183], v[24:25], v[196:197], v[182:183] op_sel:[1,0,0] neg_lo:[1,0,0] neg_hi:[1,0,0]
    v_pk_fma_f32 v[198:199], v[24:25], v[180:181], v[198:199] op_sel:[1,0,0]
    v_pk_fma_f32 v[184:185], v[24:25], v[182:183], v[184:185] op_sel_hi:[0,1,1]
    v_pk_fma_f32 v[200:201], v[24:25], v[198:199], v[200:201] op_sel_hi:[0,1,1]
    v_pk_fma_f32 v[184:185], v[24:25], v[198:199], v[184:185] op_sel:[1,0,0] neg_lo:[1,0,0] neg_hi:[1,0,0]
    v_pk_fma_f32 v[200:201], v[24:25], v[182:183], v[200:201] op_sel:[1,0,0]
    v_pk_fma_f32 v[186:187], v[24:25], v[184:185], v[186:187] op_sel_hi:[0,1,1]
    v_pk_fma_f32 v[202:203], v[24:25], v[200:201], v[202:203] op_sel_hi:[0,1,1]
    v_pk_fma_f32 v[186:187], v[24:25], v[200:201], v[186:187] op_sel:[1,0,0] neg_lo:[1,0,0] neg_hi:[1,0,0]
    v_pk_fma_f32 v[202:203], v[24:25], v[184:185], v[202:203] op_sel:[1,0,0]
    v_pk_fma_f32 v[188:189], v[24:25], v[186:187], v[188:189] op_sel_hi:[0,1,1]
    v_pk_fma_f32 v[204:205], v[24:25], v[202:203], v[204:205] op_sel_hi:[0,1,1]
    v_pk_fma_f32 v[188:189], v[24:25], v[202:203], v[188:189] op_sel:[1,0,0] neg_lo:[1,0,0] neg_hi:[1,0,0]
    v_pk_fma_f32 v[204:205], v[24:25], v[186:187], v[204:205] op_sel:[1,0,0]
    v_pk_fma_f32 v[190:191], v[24:25], v[188:189], v[190:191] op_sel_hi:[0,1,1]
    v_pk_fma_f32 v[206:207], v[24:25], v[204:205], v[206:207] op_sel_hi:[0,1,1]
    v_pk_fma_f32 v[190:191], v[24:25], v[204:205], v[190:191] op_sel:[1,0,0] neg_lo:[1,0,0] neg_hi:[1,0,0]
    v_pk_fma_f32 v[206:207], v[24:25], v[188:189], v[206:207] op_sel:[1,0,0]
    v_cvt_pk_bf16_f32 v32, v176, v178
    v_cvt_pk_bf16_f32 v33, v180, v182
    v_cvt_pk_bf16_f32 v34, v184, v186
    v_cvt_pk_bf16_f32 v35, v188, v190
    v_cvt_pk_bf16_f32 v36, v177, v179
    v_cvt_pk_bf16_f32 v37, v181, v183
    v_cvt_pk_bf16_f32 v38, v185, v187
    v_cvt_pk_bf16_f32 v39, v189, v191
    ds_write_b128 v54, v[32:35]
    ds_write_b128 v54, v[36:39] offset:16
    ds_read_b64_tr_b16 v[240:241], v55 offset:0
    ds_read_b64_tr_b16 v[242:243], v55 offset:320
    ds_read_b64_tr_b16 v[244:245], v55 offset:32
    ds_read_b64_tr_b16 v[246:247], v55 offset:352
    v_cvt_pk_bf16_f32 v40, -v192, -v194
    v_cvt_pk_bf16_f32 v41, -v196, -v198
    v_cvt_pk_bf16_f32 v42, -v200, -v202
    v_cvt_pk_bf16_f32 v43, -v204, -v206
    v_cvt_pk_bf16_f32 v44, -v193, -v195
    v_cvt_pk_bf16_f32 v45, -v197, -v199
    v_cvt_pk_bf16_f32 v46, -v201, -v203
    v_cvt_pk_bf16_f32 v47, -v205, -v207
    ds_write_b128 v54, v[40:43]
    ds_write_b128 v54, v[44:47] offset:16
    ds_read_b64_tr_b16 v[248:249], v55 offset:0
    ds_read_b64_tr_b16 v[250:251], v55 offset:320
    ds_read_b64_tr_b16 v[252:253], v55 offset:32
    ds_read_b64_tr_b16 v[254:255], v55 offset:352
    v_pk_fma_f32 v[208:209], v[28:29], v[16:17], v[208:209] op_sel_hi:[0,1,1]
    v_pk_fma_f32 v[224:225], v[28:29], v[18:19], v[224:225] op_sel_hi:[0,1,1]
    v_pk_fma_f32 v[208:209], v[28:29], v[18:19], v[208:209] op_sel:[1,0,0] neg_lo:[1,0,0] neg_hi:[1,0,0]
    v_pk_fma_f32 v[224:225], v[28:29], v[16:17], v[224:225] op_sel:[1,0,0]
    v_pk_fma_f32 v[210:211], v[28:29], v[208:209], v[210:211] op_sel_hi:[0,1,1]
    v_pk_fma_f32 v[226:227], v[28:29], v[224:225], v[226:227] op_sel_hi:[0,1,1]
    v_pk_fma_f32 v[210:211], v[28:29], v[224:225], v[210:211] op_sel:[1,0,0] neg_lo:[1,0,0] neg_hi:[1,0,0]
    v_pk_fma_f32 v[226:227], v[28:29], v[208:209], v[226:227] op_sel:[1,0,0]
    s_waitcnt lgkmcnt(6)
    s_nop 0
    buffer_store_dwordx4 v[240:243], v4, s[16:19], s54 offen offset:0 sc1
    buffer_store_dwordx4 v[244:247], v4, s[16:19], s54 offen offset:1024 sc1
    v_pk_fma_f32 v[212:213], v[28:29], v[210:211], v[212:213] op_sel_hi:[0,1,1]
    v_pk_fma_f32 v[228:229], v[28:29], v[226:227], v[228:229] op_sel_hi:[0,1,1]
    v_pk_fma_f32 v[212:213], v[28:29], v[226:227], v[212:213] op_sel:[1,0,0] neg_lo:[1,0,0] neg_hi:[1,0,0]
    v_pk_fma_f32 v[228:229], v[28:29], v[210:211], v[228:229] op_sel:[1,0,0]
    v_pk_fma_f32 v[214:215], v[28:29], v[212:213], v[214:215] op_sel_hi:[0,1,1]
    v_pk_fma_f32 v[230:231], v[28:29], v[228:229], v[230:231] op_sel_hi:[0,1,1]
    v_pk_fma_f32 v[214:215], v[28:29], v[228:229], v[214:215] op_sel:[1,0,0] neg_lo:[1,0,0] neg_hi:[1,0,0]
    v_pk_fma_f32 v[230:231], v[28:29], v[212:213], v[230:231] op_sel:[1,0,0]
    s_waitcnt lgkmcnt(0)
    s_nop 0
    buffer_store_dwordx4 v[248:251], v4, s[16:19], s55 offen offset:0 sc1
    buffer_store_dwordx4 v[252:255], v4, s[16:19], s55 offen offset:1024 sc1
    v_pk_fma_f32 v[216:217], v[28:29], v[214:215], v[216:217] op_sel_hi:[0,1,1]
    v_pk_fma_f32 v[232:233], v[28:29], v[230:231], v[232:233] op_sel_hi:[0,1,1]
    v_pk_fma_f32 v[216:217], v[28:29], v[230:231], v[216:217] op_sel:[1,0,0] neg_lo:[1,0,0] neg_hi:[1,0,0]
    v_pk_fma_f32 v[232:233], v[28:29], v[214:215], v[232:233] op_sel:[1,0,0]
    v_pk_fma_f32 v[218:219], v[28:29], v[216:217], v[218:219] op_sel_hi:[0,1,1]
    v_pk_fma_f32 v[234:235], v[28:29], v[232:233], v[234:235] op_sel_hi:[0,1,1]
    v_pk_fma_f32 v[218:219], v[28:29], v[232:233], v[218:219] op_sel:[1,0,0] neg_lo:[1,0,0] neg_hi:[1,0,0]
    v_pk_fma_f32 v[234:235], v[28:29], v[216:217], v[234:235] op_sel:[1,0,0]
    v_pk_fma_f32 v[220:221], v[28:29], v[218:219], v[220:221] op_sel_hi:[0,1,1]
    v_pk_fma_f32 v[236:237], v[28:29], v[234:235], v[236:237] op_sel_hi:[0,1,1]
    v_pk_fma_f32 v[220:221], v[28:29], v[234:235], v[220:221] op_sel:[1,0,0] neg_lo:[1,0,0] neg_hi:[1,0,0]
    v_pk_fma_f32 v[236:237], v[28:29], v[218:219], v[236:237] op_sel:[1,0,0]
    v_pk_fma_f32 v[222:223], v[28:29], v[220:221], v[222:223] op_sel_hi:[0,1,1]
    v_pk_fma_f32 v[238:239], v[28:29], v[236:237], v[238:239] op_sel_hi:[0,1,1]
    v_pk_fma_f32 v[222:223], v[28:29], v[236:237], v[222:223] op_sel:[1,0,0] neg_lo:[1,0,0] neg_hi:[1,0,0]
    v_pk_fma_f32 v[238:239], v[28:29], v[220:221], v[238:239] op_sel:[1,0,0]
    v_cvt_pk_bf16_f32 v32, v208, v210
    v_cvt_pk_bf16_f32 v33, v212, v214
    v_cvt_pk_bf16_f32 v34, v216, v218
    v_cvt_pk_bf16_f32 v35, v220, v222
    v_cvt_pk_bf16_f32 v36, v209, v211
    v_cvt_pk_bf16_f32 v37, v213, v215
    v_cvt_pk_bf16_f32 v38, v217, v219
    v_cvt_pk_bf16_f32 v39, v221, v223
    ds_write_b128 v54, v[32:35]
    ds_write_b128 v54, v[36:39] offset:16
    ds_read_b64_tr_b16 v[8:9], v55 offset:0
    ds_read_b64_tr_b16 v[10:11], v55 offset:320
    ds_read_b64_tr_b16 v[12:13], v55 offset:32
    ds_read_b64_tr_b16 v[14:15], v55 offset:352
    v_cvt_pk_bf16_f32 v40, -v224, -v226
    v_cvt_pk_bf16_f32 v41, -v228, -v230
    v_cvt_pk_bf16_f32 v42, -v232, -v234
    v_cvt_pk_bf16_f32 v43, -v236, -v238
    v_cvt_pk_bf16_f32 v44, -v225, -v227
    v_cvt_pk_bf16_f32 v45, -v229, -v231
    v_cvt_pk_bf16_f32 v46, -v233, -v235
    v_cvt_pk_bf16_f32 v47, -v237, -v239
    ds_write_b128 v54, v[40:43]
    ds_write_b128 v54, v[44:47] offset:16
    ds_read_b64_tr_b16 v[16:17], v55 offset:0
    ds_read_b64_tr_b16 v[18:19], v55 offset:320
    ds_read_b64_tr_b16 v[20:21], v55 offset:32
    ds_read_b64_tr_b16 v[22:23], v55 offset:352
    s_waitcnt lgkmcnt(6)
    buffer_store_dwordx4 v[8:11], v4, s[16:19], s56 offen offset:0 sc1
    buffer_store_dwordx4 v[12:15], v4, s[16:19], s56 offen offset:1024 sc1
    s_waitcnt lgkmcnt(0)
    buffer_store_dwordx4 v[16:19], v4, s[16:19], s57 offen offset:0 sc1
    buffer_store_dwordx4 v[20:23], v4, s[16:19], s57 offen offset:1024 sc1
    buffer_load_dwordx4 v[156:159], v4, s[16:19], s3 offen offset:2048 sc1
    buffer_load_dwordx4 v[160:163], v4, s[16:19], s3 offen offset:3072 sc1
    buffer_load_dwordx4 v[164:167], v5, s[16:19], s3 offen sc1
    s_lshl2_add_u32 s3, s42, s98
    s_add_u32 s3, s3, s42
    buffer_load_dwordx4 v[116:119], v4, s[16:19], s3 offen offset:2048 sc1
    s_waitcnt vmcnt(4)
    s_barrier
    v_mov_b32_e64 v3, 1
    buffer_store_dword v3, v2, s[16:19], s87 offen sc1
    s_cmp_lg_u32 s68, 4
    s_cbranch_scc1 L_si39
    v_and_b32 v254, 7, v1
    v_lshlrev_b32 v254, 10, v254
    v_mov_b32_e64 v255, 0
    ds_write_b32 v254, v255 offset:512
    v_mov_b32_e64 v254, 8
    ds_write_b32 v255, v254 offset:4612
L_si39:
    buffer_load_dwordx4 v[120:123], v4, s[16:19], s3 offen offset:3072 sc1
    buffer_load_dwordx4 v[124:127], v5, s[16:19], s3 offen sc1
    s_lshl2_add_u32 s3, s44, s98
    s_add_u32 s3, s3, s44
    s_add_u32 m0, s83, 122880
    s_nop 0
    buffer_load_dwordx4 v4, s[16:19], s3 offen sc1 lds
    s_add_u32 m0, s83, 130048
    s_nop 0
    buffer_load_dwordx4 v4, s[16:19], s3 offen offset:1024 sc1 lds
    s_add_u32 m0, s83, 137216
    s_nop 0
    buffer_load_dwordx4 v4, s[16:19], s3 offen offset:2048 sc1 lds
    s_add_u32 m0, s83, 144384
    s_nop 0
    buffer_load_dwordx4 v4, s[16:19], s3 offen offset:3072 sc1 lds
    s_add_u32 m0, s83, 155648
    s_nop 0
    buffer_load_dwordx4 v5, s[16:19], s3 offen sc1 lds
    s_lshl2_add_u32 s3, s43, s98
    s_add_u32 s3, s3, s43
    s_add_u32 m0, s83, 81920
    s_nop 0
    buffer_load_dwordx4 v4, s[16:19], s3 offen sc1 lds
    s_add_u32 m0, s83, 89088
    s_nop 0
    buffer_load_dwordx4 v4, s[16:19], s3 offen offset:1024 sc1 lds
    s_add_u32 m0, s83, 96256
    s_nop 0
    buffer_load_dwordx4 v4, s[16:19], s3 offen offset:2048 sc1 lds
    s_add_u32 m0, s83, 103424
    s_nop 0
    buffer_load_dwordx4 v4, s[16:19], s3 offen offset:3072 sc1 lds
    s_add_u32 m0, s83, 114688
    s_nop 0
    buffer_load_dwordx4 v5, s[16:19], s3 offen sc1 lds
    s_lshl2_add_u32 s3, s51, s98
    s_add_u32 s3, s3, s51
    s_add_u32 m0, s83, 7168
    s_nop 0
    buffer_load_dwordx4 v4, s[16:19], s3 offen offset:1024 sc1 lds
    s_add_u32 m0, s83, 14336
    s_nop 0
    buffer_load_dwordx4 v4, s[16:19], s3 offen offset:2048 sc1 lds
    s_add_u32 m0, s83, 21504
    s_nop 0
    buffer_load_dwordx4 v4, s[16:19], s3 offen offset:3072 sc1 lds
    s_add_u32 m0, s83, 32768
    s_nop 0
    buffer_load_dwordx4 v5, s[16:19], s3 offen sc1 lds
    s_lshl2_add_u32 s3, s63, s98
    s_add_u32 s3, s3, s63
    buffer_load_dwordx4 v[8:11], v4, s[16:19], s3 offen sc1
    buffer_load_dwordx4 v[12:15], v4, s[16:19], s3 offen offset:1024 sc1
    buffer_load_dwordx4 v[16:19], v4, s[16:19], s3 offen offset:2048 sc1
    buffer_load_dwordx4 v[20:23], v4, s[16:19], s3 offen offset:3072 sc1
    buffer_load_dwordx4 v[24:27], v5, s[16:19], s3 offen sc1
    s_mov_b32 s92, 1
    s_cmp_lg_u32 s68, 0
    s_cbranch_scc1 L_fd
    s_mov_b32 exec_lo, 0
L_fp:
    buffer_load_dword v3, v6, s[16:19], 0 offen sc1
    s_waitcnt vmcnt(0)
    v_cmp_eq_u32 vcc, 1, v3
    s_nop 0
    s_and_b32 s88, vcc_hi, 31
    s_cmp_eq_u32 s88, 31
    s_cbranch_scc1 L_fd
    s_sub_u32 s99, s99, 1
    s_cmp_gt_i32 s99, 0
    s_cbranch_scc1 L_fp
L_fd:
    s_mov_b64 exec, -1
    s_waitcnt lgkmcnt(0)
    s_barrier
    s_branch L_p2
L_f4:
    v_and_b32 v34, 2, v32
    v_xor_b32_e64 v34, v33, v34
    v_mul_u32_u24 v35, 0xd80, v32
    v_lshl_add_u32 v20, v34, 4, v35
    v_xor_b32_e64 v34, 4, v34
    v_lshl_add_u32 v21, v34, 4, v35
    s_mul_i32 s81, s68, 27648
    s_lshl_b32 s88, s73, 7
    s_add_u32 s81, s81, s88
    s_lshl_b32 s88, s68, 3
    s_add_u32 s88, s88, s75
    s_mul_i32 s76, s88, 1280
    s_add_u32 s77, s76, 81920
    s_mov_b32 s6, 2211840
    s_mov_b32 s7, 0x20000
    s_mov_b32 s10, 2211840
    s_mov_b32 s11, 0x20000
    s_mov_b32 s4, s56
    s_mov_b32 s5, s57
    s_mov_b32 s8, s58
    s_mov_b32 s9, s59
    v_mov_b32_e64 v64, 0
    buffer_store_dword v64, v2, s[16:19], s95 offen sc1
    v_cmp_eq_u32_e64 vcc, 1, v0
    v_mov_b32 v65, 0x80
    s_nop 0
    v_cndmask_b32 v65, v2, v65, vcc
    buffer_store_dword v64, v65, s[16:19], s87 offen sc1
    s_add_u32 m0, s83, 8192
    s_nop 0
    buffer_load_dwordx4 v22, s[12:15], s76 offen lds
    s_add_u32 m0, s83, 16384
    s_nop 0
    buffer_load_dwordx4 v22, s[12:15], s77 offen lds
    s_add_u32 m0, s83, 24576
    s_nop 0
    buffer_load_dwordx4 v20, s[4:7], s81 offen lds
    v_bfe_u32 v32, v1, 4, 1
    v_lshrrev_b32 v33, 5, v1
    v_bfe_u32 v34, v1, 2, 2
    v_and_b32 v35, 3, v1
    v_lshlrev_b32 v52, 13, v32
    v_lshl_add_u32 v52, v33, 10, v52
    v_lshl_add_u32 v52, v34, 7, v52
    v_lshrrev_b32 v53, 1, v35
    s_lshl_b32 s88, s69, 1
    v_add_u32 v53, s88, v53
    v_and_b32 v54, 2, v34
    v_xor_b32 v53, v53, v54
    v_lshlrev_b32 v54, 2, v32
    v_xor_b32_e64 v53, v53, v54
    v_lshl_add_u32 v52, v53, 4, v52
    v_and_b32_e64 v53, 1, v35
    v_lshl_add_u32 v52, v53, 3, v52
    s_lshl_b32 s88, s70, 12
    s_mul_i32 s89, s88, 5
    s_add_u32 s89, s89, 24576
    s_mul_i32 s90, s88, 3
    s_add_u32 s90, s90, 24576
    v_add_u32 v16, s89, v52
    v_add_u32_e64 v17, s90, v52
    v_add_u32 v18, 98304, v16
    v_add_u32 v19, 98304, v17
    v_add_u32 v8, 8192, v40
    v_add_u32 v12, 106496, v40
    v_add_u32 v9, 8192, v41
    v_add_u32 v13, 106496, v41
    v_add_u32 v10, 8192, v42
    v_add_u32 v14, 106496, v42
    v_add_u32 v11, 8192, v43
    v_add_u32 v15, 106496, v43
    v_xor_b32 v32, v32, v34
    v_and_b32 v32, 1, v32
    v_cmp_eq_u32_e64 vcc, 0, v32
    v_mov_b32 v33, 0x3f803f80
    s_nop 0
    v_cndmask_b32 v24, 0, v33, vcc
    v_mov_b32 v25, v24
    v_mov_b32 v26, v24
    v_mov_b32 v27, v24
    s_lshr_b32 s62, s71, 1
    s_lshl_b32 s62, s62, 3
    s_lshr_b32 s90, s72, 2
    s_add_u32 s62, s62, s90
    s_and_b32 s0, s71, 1
    s_lshl_b32 s0, s0, 2
    s_and_b32 s89, s72, 3
    s_add_u32 s0, s0, s89
    s_xor_b32 s62, s62, 16
    s_mul_i32 s97, s62, 94
    s_add_u32 s97, s97, s68
    s_lshl_b32 s97, s97, 12
    s_mul_i32 s98, s0, 94
    s_add_u32 s98, s98, s68
    s_mul_i32 s98, s98, 5120
    s_add_u32 s98, s98, 12320768
    s_mul_i32 s59, s62, 81920
    s_mul_i32 s60, s0, 160
    s_add_u32 s59, s59, s60
    s_lshl_b32 s61, s62, 10
    s_add_u32 s61, s61, 16171008
    s_mul_i32 s88, s62, 52
    s_lshr_b32 s88, s88, 8
    s_lshl_b32 s88, s88, 12
    s_add_u32 s88, s88, 16221184
    v_mov_b32_e64 v58, s88
    s_lshr_b32 s89, s62, 1
    s_lshl_b32 s89, s89, 12
    s_add_u32 s89, s89, 16249856
    v_mov_b32 v6, s89
    v_cmp_gt_u32 vcc, 32, v1
    s_nop 1
    v_cndmask_b32 v6, v6, v58, vcc
    v_lshl_add_u32 v6, v1, 7, v6
    s_cmp_eq_u32 s68, 0
    s_cselect_b32 vcc_lo, 0x7ffffff, 0
    s_cselect_b32 vcc_hi, 0x1f, 0
    v_mov_b32 v58, 1073741824
    v_cndmask_b32 v6, v58, v6, vcc
    v_mov_b32 v52, 0
    v_mov_b32 v53, 0
    v_mov_b32_e64 v54, 0
    v_bfe_u32 v56, v1, 4, 1
    v_lshlrev_b32 v56, 10, v56
    v_lshrrev_b32 v58, 5, v1
    v_lshl_add_u32 v56, v58, 8, v56
    v_and_b32_e64 v58, 15, v1
    v_lshl_add_u32 v56, v58, 4, v56
    v_and_b32 v59, 0x1f0, v4
    s_lshl_b32 s0, s73, 1
    s_lshr_b32 s88, s68, 1
    s_add_u32 s0, s0, s88
    s_cmp_ge_u32 s0, 54
    s_cselect_b32 s0, 0x40000, s0
    s_mov_b32 s1, 60
    s_lshl_b32 s0, s0, 12
    s_and_b32 s88, s69, 1
    s_lshl_b32 s88, s88, 9
    s_add_u32 s0, s0, s88
    s_lshl_b32 s47, s1, 9
    s_add_u32 s47, s47, 16171008
    s_lshr_b32 s88, s1, 1
    s_mul_i32 s88, s88, 385024
    s_and_b32 s89, s1, 1
    s_lshl_b32 s89, s89, 11
    s_add_u32 s88, s88, s89
    s_add_u32 s54, s88, s0
    s_add_u32 s1, s1, 1
    s_lshr_b32 s88, s1, 1
    s_mul_i32 s88, s88, 385024
    s_and_b32 s89, s1, 1
    s_lshl_b32 s89, s89, 11
    s_add_u32 s88, s88, s89
    s_add_u32 s55, s88, s0
    s_add_u32 s1, s1, 1
    s_lshr_b32 s88, s1, 1
    s_mul_i32 s88, s88, 385024
    s_and_b32 s89, s1, 1
    s_lshl_b32 s89, s89, 11
    s_add_u32 s88, s88, s89
    s_add_u32 s56, s88, s0
    s_add_u32 s1, s1, 1
    s_lshr_b32 s88, s1, 1
    s_mul_i32 s88, s88, 385024
    s_and_b32 s89, s1, 1
    s_lshl_b32 s89, s89, 11
    s_add_u32 s88, s88, s89
    s_add_u32 s57, s88, s0
    s_add_u32 s1, s1, 1
    s_cmp_lg_u32 s92, 1
    s_cbranch_scc1 L_jc42
    v_lshrrev_b32_e64 v64, 5, v1
    v_mul_u32_u24 v64, 2176, v64
    v_bfe_u32 v65, v1, 2, 3
    v_lshl_add_u32 v64, v65, 7, v64
    v_and_b32_e64 v65, 3, v1
    v_lshl_add_u32 v64, v65, 3, v64
    v_add_u32 v111, s93, v64
    s_waitcnt vmcnt(5)
    ds_read_b64_tr_b16 v[112:113], v111 offset:0
    ds_read_b64_tr_b16 v[114:115], v111 offset:1088
    ds_read_b64_tr_b16 v[116:117], v111 offset:32
    ds_read_b64_tr_b16 v[118:119], v111 offset:1120
    ds_read_b64_tr_b16 v[120:121], v111 offset:64
    ds_read_b64_tr_b16 v[122:123], v111 offset:1152
    ds_read_b64_tr_b16 v[124:125], v111 offset:96
    ds_read_b64_tr_b16 v[126:127], v111 offset:1184
    s_branch L_js43
L_jc42:
    v_bfe_u32 v64, v1, 2, 2
    v_mul_u32_u24 v64, 1088, v64
    v_and_b32 v65, 3, v1
    v_lshl_add_u32 v64, v65, 8, v64
    v_and_b32_e64 v65, 48, v1
    v_add3_u32 v111, s93, v64, v65
    s_waitcnt vmcnt(5)
    ds_read_b128 v[112:115], v111 offset:0
    ds_read_b128 v[116:119], v111 offset:64
    ds_read_b128 v[120:123], v111 offset:128
    ds_read_b128 v[124:127], v111 offset:192
L_js43:
    s_cmp_ge_u32 s68, 6
    s_cbranch_scc1 L_wb40
    s_add_u32 m0, s83, 32768
    s_nop 0
    buffer_load_dwordx4 v21, s[8:11], s81 offen lds
    v_lshlrev_b32_e64 v78, 16, v68
    v_and_b32 v79, 0xffff0000, v68
    v_lshlrev_b32_e64 v80, 16, v69
    v_and_b32 v81, 0xffff0000, v69
    v_lshlrev_b32_e64 v82, 16, v70
    v_and_b32 v83, 0xffff0000, v70
    v_lshlrev_b32_e64 v84, 16, v71
    v_and_b32 v85, 0xffff0000, v71
    v_lshlrev_b32_e64 v86, 16, v72
    v_and_b32 v87, 0xffff0000, v72
    v_lshlrev_b32_e64 v88, 16, v73
    v_and_b32 v89, 0xffff0000, v73
    v_lshlrev_b32_e64 v90, 16, v74
    v_and_b32 v91, 0xffff0000, v74
    s_add_u32 m0, s83, 40832
    s_nop 0
    buffer_load_dwordx4 v20, s[4:7], s81 offen offset:128 lds
    v_lshlrev_b32 v92, 16, v75
    v_and_b32 v93, 0xffff0000, v75
    v_lshlrev_b32_e64 v94, 16, v76
    v_and_b32 v95, 0xffff0000, v76
    v_lshlrev_b32_e64 v96, 16, v77
    v_and_b32 v97, 0xffff0000, v77
    v_add_f32 v98, v78, v79
    v_add_f32 v99, v80, v81
    v_add_f32 v100, v82, v83
    v_add_f32 v101, v84, v85
    v_add_f32 v98, v98, v86
    v_add_f32 v99, v99, v87
    v_add_f32 v100, v100, v88
    v_add_f32 v101, v101, v89
    s_add_u32 m0, s83, 49024
    s_nop 0
    buffer_load_dwordx4 v21, s[8:11], s81 offen offset:128 lds
    v_add_f32 v98, v98, v90
    v_add_f32 v99, v99, v91
    v_add_f32 v100, v100, v92
    v_add_f32 v101, v101, v93
    v_add_f32 v98, v98, v94
    v_add_f32 v99, v99, v95
    v_add_f32 v100, v100, v96
    v_add_f32 v101, v101, v97
    v_add_f32 v98, v98, v99
    v_add_f32 v100, v100, v101
    v_add_f32_e64 v98, v98, v100
    s_nop 1
    v_add_f32_dpp v98, v98, v98 row_ror:8 row_mask:0xf bank_mask:0xf
    s_nop 1
    v_add_f32_dpp v98, v98, v98 row_ror:4 row_mask:0xf bank_mask:0xf
    s_nop 1
    v_add_f32_dpp v98, v98, v98 row_ror:2 row_mask:0xf bank_mask:0xf
    s_add_u32 s81, s81, 221184
    s_nop 0
    v_add_f32_dpp v98, v98, v98 row_ror:1 row_mask:0xf bank_mask:0xf
    v_mov_b32 v102, v98
    s_nop 1
    v_permlane16_swap_b32 v98, v102
    v_add_f32_e64 v98, v98, v102
    v_mul_f32 v98, 0x3acccccd, v98
    v_sub_f32 v78, v78, v98
    v_sub_f32 v79, v79, v98
    v_sub_f32 v80, v80, v98
    v_sub_f32 v81, v81, v98
    v_sub_f32 v82, v82, v98
    v_sub_f32 v83, v83, v98
    v_sub_f32 v84, v84, v98
    v_sub_f32 v85, v85, v98
    v_sub_f32_e64 v86, v86, v98
    s_add_u32 m0, s83, 106368
    s_nop 0
    buffer_load_dwordx4 v22, s[12:15], s76 offen offset:128 lds
    v_sub_f32 v87, v87, v98
    v_sub_f32 v88, v88, v98
    v_sub_f32 v89, v89, v98
    v_sub_f32 v90, v90, v98
    v_sub_f32 v91, v91, v98
    v_sub_f32 v92, v92, v98
    v_sub_f32 v93, v93, v98
    v_sub_f32 v94, v94, v98
    v_sub_f32 v95, v95, v98
    v_sub_f32 v96, v96, v98
    v_sub_f32 v97, v97, v98
    v_mul_f32 v100, v78, v78
    v_mul_f32 v101, v79, v79
    v_fmac_f32_e64 v100, v80, v80
    s_add_u32 m0, s83, 114560
    s_nop 0
    buffer_load_dwordx4 v22, s[12:15], s77 offen offset:128 lds
    v_fmac_f32 v101, v81, v81
    v_fmac_f32 v100, v82, v82
    v_fmac_f32 v101, v83, v83
    v_fmac_f32 v100, v84, v84
    v_fmac_f32 v101, v85, v85
    v_fmac_f32 v100, v86, v86
    v_fmac_f32 v101, v87, v87
    v_fmac_f32 v100, v88, v88
    v_fmac_f32 v101, v89, v89
    v_fmac_f32 v100, v90, v90
    v_fmac_f32 v101, v91, v91
    v_fmac_f32 v100, v92, v92
    v_fmac_f32 v101, v93, v93
    v_fmac_f32_e64 v100, v94, v94
    s_add_u32 m0, s83, 122880
    s_nop 0
    buffer_load_dwordx4 v20, s[4:7], s81 offen lds
    v_fmac_f32 v101, v95, v95
    v_fmac_f32 v100, v96, v96
    v_fmac_f32 v101, v97, v97
    v_add_f32_e64 v100, v100, v101
    v_cvt_pk_bf16_f32 v71, -v98, -v98
    s_nop 0
    v_add_f32_dpp v100, v100, v100 row_ror:8 row_mask:0xf bank_mask:0xf
    s_nop 1
    v_add_f32_dpp v100, v100, v100 row_ror:4 row_mask:0xf bank_mask:0xf
    s_nop 1
    v_add_f32_dpp v100, v100, v100 row_ror:2 row_mask:0xf bank_mask:0xf
    s_nop 1
    v_add_f32_dpp v100, v100, v100 row_ror:1 row_mask:0xf bank_mask:0xf
    v_mov_b32 v102, v100
    s_nop 1
    v_permlane16_swap_b32 v100, v102
    v_add_f32 v100, v100, v102
    v_mul_f32 v100, 0x3acccccd, v100
    v_cvt_pk_bf16_f32 v102, v100, v100
    v_lshlrev_b32_e64 v100, 16, v102
    v_add_f32 v100, 0x3727c5ac, v100
    v_cvt_pk_bf16_f32 v102, v100, v100
    v_lshlrev_b32 v100, 16, v102
    v_sqrt_f32_e64 v100, v100
    s_nop 0
    v_cvt_pk_bf16_f32 v102, v100, v100
    v_lshlrev_b32 v100, 16, v102
    v_rcp_f32 v103, v100
    v_mul_f32_e64 v70, v100, v100
    v_mul_f32 v68, 0xc0135761, v103
    v_mul_f32 v102, v103, v103
    v_mul_f32 v102, v102, v103
    v_mul_f32 v69, 0xbdd2d3e8, v102
    v_and_b32 v68, 0xffffff7f, v68
    v_and_b32 v69, 0xffffff7f, v69
    v_and_b32 v70, 0xffffff7f, v70
    s_branch L_wd41
L_wb40:
    s_add_u32 m0, s83, 32768
    s_nop 0
    buffer_load_dwordx4 v21, s[8:11], s81 offen lds
    v_lshlrev_b32_e64 v98, 16, v68
    v_and_b32 v99, 0xffff0000, v68
    v_lshlrev_b32_e64 v100, 16, v69
    v_and_b32 v101, 0xffff0000, v69
    v_lshlrev_b32_e64 v88, 16, v70
    v_and_b32 v89, 0xffff0000, v70
    v_add_f32 v98, v98, v88
    v_add_f32 v99, v99, v89
    v_lshlrev_b32_e64 v90, 16, v71
    v_and_b32 v91, 0xffff0000, v71
    s_add_u32 m0, s83, 40832
    s_nop 0
    buffer_load_dwordx4 v20, s[4:7], s81 offen offset:128 lds
    v_add_f32 v100, v100, v90
    v_add_f32 v101, v101, v91
    v_lshlrev_b32 v88, 16, v72
    v_and_b32 v89, 0xffff0000, v72
    v_add_f32 v98, v98, v88
    v_add_f32 v99, v99, v89
    v_lshlrev_b32_e64 v90, 16, v73
    v_and_b32 v91, 0xffff0000, v73
    v_add_f32 v100, v100, v90
    v_add_f32 v101, v101, v91
    s_add_u32 m0, s83, 49024
    s_nop 0
    buffer_load_dwordx4 v21, s[8:11], s81 offen offset:128 lds
    v_lshlrev_b32 v88, 16, v74
    v_and_b32 v89, 0xffff0000, v74
    v_add_f32 v98, v98, v88
    v_add_f32 v99, v99, v89
    v_lshlrev_b32_e64 v90, 16, v75
    v_and_b32 v91, 0xffff0000, v75
    v_add_f32 v100, v100, v90
    v_add_f32 v101, v101, v91
    v_lshlrev_b32_e64 v88, 16, v76
    v_and_b32 v89, 0xffff0000, v76
    s_add_u32 s81, s81, 221184
    v_add_f32 v98, v98, v88
    v_add_f32 v99, v99, v89
    v_lshlrev_b32_e64 v90, 16, v77
    v_and_b32 v91, 0xffff0000, v77
    v_add_f32 v100, v100, v90
    v_add_f32 v101, v101, v91
    v_lshlrev_b32_e64 v88, 16, v78
    v_and_b32 v89, 0xffff0000, v78
    v_add_f32 v98, v98, v88
    v_add_f32 v99, v99, v89
    s_add_u32 m0, s83, 106368
    s_nop 0
    buffer_load_dwordx4 v22, s[12:15], s76 offen offset:128 lds
    v_lshlrev_b32 v90, 16, v79
    v_and_b32 v91, 0xffff0000, v79
    v_add_f32 v100, v100, v90
    v_add_f32 v101, v101, v91
    v_lshlrev_b32_e64 v88, 16, v80
    v_and_b32 v89, 0xffff0000, v80
    v_add_f32 v98, v98, v88
    v_add_f32 v99, v99, v89
    v_lshlrev_b32_e64 v90, 16, v81
    v_and_b32 v91, 0xffff0000, v81
    s_add_u32 m0, s83, 114560
    s_nop 0
    buffer_load_dwordx4 v22, s[12:15], s77 offen offset:128 lds
    v_add_f32 v100, v100, v90
    v_add_f32 v101, v101, v91
    v_lshlrev_b32 v88, 16, v82
    v_and_b32 v89, 0xffff0000, v82
    v_add_f32 v98, v98, v88
    v_add_f32 v99, v99, v89
    v_lshlrev_b32_e64 v90, 16, v83
    v_and_b32 v91, 0xffff0000, v83
    v_add_f32 v100, v100, v90
    v_add_f32 v101, v101, v91
    s_add_u32 m0, s83, 122880
    s_nop 0
    buffer_load_dwordx4 v20, s[4:7], s81 offen lds
    v_lshlrev_b32 v88, 16, v84
    v_and_b32 v89, 0xffff0000, v84
    v_add_f32 v98, v98, v88
    v_add_f32 v99, v99, v89
    v_lshlrev_b32_e64 v90, 16, v85
    v_and_b32 v91, 0xffff0000, v85
    v_add_f32 v100, v100, v90
    v_add_f32 v101, v101, v91
    v_lshlrev_b32_e64 v88, 16, v86
    v_and_b32 v89, 0xffff0000, v86
    v_add_f32 v98, v98, v88
    v_add_f32 v99, v99, v89
    v_lshlrev_b32_e64 v90, 16, v87
    v_and_b32 v91, 0xffff0000, v87
    v_add_f32 v100, v100, v90
    v_add_f32 v101, v101, v91
    v_add_f32 v98, v98, v99
    v_add_f32 v100, v100, v101
    v_add_f32 v98, v98, v100
    s_nop 1
    v_add_f32_dpp v98, v98, v98 row_ror:8 row_mask:0xf bank_mask:0xf
    s_nop 1
    v_add_f32_dpp v98, v98, v98 row_ror:4 row_mask:0xf bank_mask:0xf
    s_nop 1
    v_add_f32_dpp v98, v98, v98 row_ror:2 row_mask:0xf bank_mask:0xf
    s_nop 1
    v_add_f32_dpp v98, v98, v98 row_ror:1 row_mask:0xf bank_mask:0xf
    v_cvt_pk_bf16_f32 v88, v98, v98
    v_lshlrev_b32 v88, 16, v88
    v_sub_f32_e64 v88, v98, v88
    v_cvt_pk_bf16_f32 v103, v98, v88
L_wd41:
    s_waitcnt lgkmcnt(0)
    buffer_store_dwordx4 v[68:71], v106, s[16:19], 0 offen sc1
    buffer_store_dword v103, v107, s[16:19], 0 offen sc1
    s_cmp_lt_u32 s68, 4
    s_cbranch_scc1 L_pr44
    s_setprio 1
L_pr44:
    s_waitcnt vmcnt(5)
    s_barrier
    ds_read_b64_tr_b16 v[128:129], v16 offset:0
    ds_read_b64_tr_b16 v[130:131], v16 offset:512
    ds_read_b128 v[132:135], v8 offset:0
    ds_read_b128 v[136:139], v8 offset:4096
    ds_read_b128 v[140:143], v8 offset:8192
    ds_read_b128 v[144:147], v8 offset:12288
    s_waitcnt lgkmcnt(0)
    v_mfma_f32_32x32x16_bf16 v[176:191], v[128:131], v[132:135], 0
    ds_read_b64_tr_b16 v[152:153], v16 offset:2048
    s_add_u32 m0, s83, 131072
    ds_read_b64_tr_b16 v[154:155], v16 offset:2560
    ds_read_b128 v[156:159], v9 offset:0
    buffer_load_dwordx4 v21, s[8:11], s81 offen lds
    s_and_b32 s88, s72, 3
    s_mul_i32 s88, s88, 0
    s_lshr_b32 s86, s72, 2
    s_mul_i32 s86, s86, 1
    s_add_u32 s86, s86, s88
    v_mfma_f32_32x32x16_bf16 v[192:207], v[128:131], v[136:139], 0
    ds_read_b128 v[160:163], v9 offset:4096
    s_add_u32 m0, s83, 139136
    ds_read_b128 v[164:167], v9 offset:8192
    ds_read_b128 v[168:171], v9 offset:12288
    buffer_load_dwordx4 v20, s[4:7], s81 offen offset:128 lds
    s_mul_i32 s88, s86, 205
    s_lshr_b32 s88, s88, 10
    s_mul_i32 s88, s88, 5
    s_sub_u32 s86, s86, s88
    s_lshl_b32 s86, s86, 13
    s_add_u32 m0, s83, 147328
    v_mfma_f32_32x32x16_bf16 v[208:223], v[128:131], v[140:143], 0
    v_mfma_f32_16x16x32_bf16 v[28:31], v[24:27], v[128:131], 0
    buffer_load_dwordx4 v21, s[8:11], s81 offen offset:128 lds
    s_add_u32 s81, s81, 221184
    s_add_u32 s36, s86, 55296
    v_mfma_f32_32x32x16_bf16 v[224:239], v[128:131], v[144:147], 0
    buffer_store_dwordx4 v[112:115], v4, s[16:19], s38 offen sc1
    s_add_u32 s86, s86, 0x2000
    s_cmp_eq_u32 s86, 40960
    s_cselect_b32 s86, 0, s86
    s_waitcnt lgkmcnt(0)
    v_mfma_f32_32x32x16_bf16 v[176:191], v[152:155], v[156:159], v[176:191]
    ds_read_b64_tr_b16 v[128:129], v17 offset:4096
    ds_read_b64_tr_b16 v[130:131], v17 offset:4608
    ds_read_b128 v[132:135], v10 offset:0
    buffer_store_dwordx4 v[116:119], v4, s[16:19], s39 offen sc1
    s_add_u32 s37, s86, 55296
    s_add_u32 s86, s86, 0x2000
    s_cmp_eq_u32 s86, 40960
    s_cselect_b32 s86, 0, s86
    v_mfma_f32_32x32x16_bf16 v[192:207], v[152:155], v[160:163], v[192:207]
    ds_read_b128 v[136:139], v10 offset:4096
    ds_read_b128 v[140:143], v10 offset:8192
    ds_read_b128 v[144:147], v10 offset:12288
    buffer_store_dwordx4 v[120:123], v4, s[16:19], s40 offen sc1
    s_add_u32 s42, s86, 55296
    s_add_u32 s86, s86, 0x2000
    s_cmp_eq_u32 s86, 40960
    s_cselect_b32 s86, 0, s86
    v_mfma_f32_32x32x16_bf16 v[208:223], v[152:155], v[164:167], v[208:223]
    v_mfma_f32_16x16x32_bf16 v[28:31], v[24:27], v[152:155], v[28:31]
    buffer_store_dwordx4 v[124:127], v4, s[16:19], s41 offen sc1
    s_add_u32 s43, s86, 55296
    s_add_u32 s86, s86, 0x2000
    s_cmp_eq_u32 s86, 40960
    s_cselect_b32 s86, 0, s86
    v_mfma_f32_32x32x16_bf16 v[224:239], v[152:155], v[168:171], v[224:239]
    s_and_b32 s88, s2, 1
    s_lshl_b32 s88, s88, 7
    v_mov_b32 v64, 1
    buffer_atomic_add v64, v2, s[24:27], s88 offen sc1
    s_add_u32 s44, s86, 55296
    s_and_b32 s88, s72, 3
    s_mul_i32 s88, s88, 0
    s_lshr_b32 s86, s72, 2
    s_mul_i32 s86, s86, 2
    s_add_u32 s86, s86, s88
    s_waitcnt lgkmcnt(0)
    v_mfma_f32_32x32x16_bf16 v[176:191], v[128:131], v[132:135], v[176:191]
    ds_read_b64_tr_b16 v[152:153], v17 offset:6144
    s_add_u32 m0, s83, 73728
    ds_read_b64_tr_b16 v[154:155], v17 offset:6656
    ds_read_b128 v[156:159], v11 offset:0
    buffer_load_dwordx4 v20, s[4:7], s81 offen lds
    s_mul_i32 s88, s86, 147
    s_lshr_b32 s88, s88, 10
    s_mul_i32 s88, s88, 7
    s_sub_u32 s86, s86, s88
    s_lshl_b32 s86, s86, 13
    v_mfma_f32_32x32x16_bf16 v[192:207], v[128:131], v[136:139], v[192:207]
    ds_read_b128 v[160:163], v11 offset:4096
    s_add_u32 m0, s83, 81920
    ds_read_b128 v[164:167], v11 offset:8192
    ds_read_b128 v[168:171], v11 offset:12288
    buffer_load_dwordx4 v21, s[8:11], s81 offen lds
    s_add_u32 s88, s86, s83
    s_cmp_ge_u32 s88, 55296
    s_cselect_b32 s45, 0x8000000, s86
    s_add_u32 m0, s83, 89984
    v_mfma_f32_32x32x16_bf16 v[208:223], v[128:131], v[140:143], v[208:223]
    v_mfma_f32_16x16x32_bf16 v[28:31], v[24:27], v[128:131], v[28:31]
    buffer_load_dwordx4 v20, s[4:7], s81 offen offset:128 lds
    s_add_u32 s86, s86, 0x2000
    s_cmp_eq_u32 s86, 57344
    s_cselect_b32 s86, 0, s86
    s_add_u32 m0, s83, 98176
    v_mfma_f32_32x32x16_bf16 v[224:239], v[128:131], v[144:147], v[224:239]
    buffer_load_dwordx4 v21, s[8:11], s81 offen offset:128 lds
    s_add_u32 s81, s81, 221184
    s_add_u32 s88, s86, s83
    s_cmp_ge_u32 s88, 55296
    s_cselect_b32 s46, 0x8000000, s86
    s_add_u32 m0, s83, 57088
    s_nop 0
    buffer_load_dwordx4 v22, s[12:15], s76 offen offset:256 lds
    s_add_u32 m0, s83, 65280
    s_nop 0
    buffer_load_dwordx4 v22, s[12:15], s77 offen offset:256 lds
    s_waitcnt vmcnt(7) lgkmcnt(0)
    s_barrier
    v_mfma_f32_32x32x16_bf16 v[176:191], v[152:155], v[156:159], v[176:191]
    ds_read_b64_tr_b16 v[128:129], v18 offset:0
    s_add_u32 m0, s83, 7808
    ds_read_b64_tr_b16 v[130:131], v18 offset:512
    ds_read_b128 v[132:135], v12 offset:0
    buffer_load_dwordx4 v22, s[12:15], s76 offen offset:384 lds
    s_add_u32 s86, s86, 0x2000
    s_cmp_eq_u32 s86, 57344
    s_cselect_b32 s86, 0, s86
    v_mfma_f32_32x32x16_bf16 v[192:207], v[152:155], v[160:163], v[192:207]
    ds_read_b128 v[136:139], v12 offset:4096
    ds_read_b128 v[140:143], v12 offset:8192
    ds_read_b128 v[144:147], v12 offset:12288
    s_add_u32 s88, s86, s83
    s_cmp_ge_u32 s88, 55296
    s_cselect_b32 s50, 0x8000000, s86
    s_add_u32 m0, s83, 16000
    v_mfma_f32_32x32x16_bf16 v[208:223], v[152:155], v[164:167], v[208:223]
    v_mfma_f32_16x16x32_bf16 v[28:31], v[24:27], v[152:155], v[28:31]
    buffer_load_dwordx4 v22, s[12:15], s77 offen offset:384 lds
    s_add_u32 s86, s86, 0x2000
    s_cmp_eq_u32 s86, 57344
    s_cselect_b32 s86, 0, s86
    v_mfma_f32_32x32x16_bf16 v[224:239], v[152:155], v[168:171], v[224:239]
    s_add_u32 s88, s86, s83
    s_cmp_ge_u32 s88, 55296
    s_cselect_b32 s51, 0x8000000, s86
    s_waitcnt lgkmcnt(0)
    v_mfma_f32_32x32x16_bf16 v[176:191], v[128:131], v[132:135], v[176:191]
    ds_read_b64_tr_b16 v[152:153], v18 offset:2048
    ds_read_b64_tr_b16 v[154:155], v18 offset:2560
    ds_read_b128 v[156:159], v13 offset:0
    v_mov_b32_e64 v64, 1
    buffer_store_dword v64, v2, s[16:19], s95 offen sc1
    s_add_u32 s86, s86, 0x2000
    s_cmp_eq_u32 s86, 57344
    s_cselect_b32 s86, 0, s86
    v_mfma_f32_32x32x16_bf16 v[192:207], v[128:131], v[136:139], v[192:207]
    ds_read_b128 v[160:163], v13 offset:4096
    ds_read_b128 v[164:167], v13 offset:8192
    ds_read_b128 v[168:171], v13 offset:12288
    s_add_u32 s88, s86, s83
    s_cmp_ge_u32 s88, 55296
    s_cselect_b32 s63, 0x8000000, s86
    s_add_u32 m0, s83, 24576
    v_mfma_f32_32x32x16_bf16 v[208:223], v[128:131], v[140:143], v[208:223]
    v_mfma_f32_16x16x32_bf16 v[28:31], v[24:27], v[128:131], v[28:31]
    buffer_load_dwordx4 v20, s[4:7], s81 offen lds
    s_add_u32 s86, s86, 0x2000
    s_cmp_eq_u32 s86, 57344
    s_cselect_b32 s86, 0, s86
    v_mfma_f32_32x32x16_bf16 v[224:239], v[128:131], v[144:147], v[224:239]
    s_add_u32 s88, s86, s83
    s_cmp_ge_u32 s88, 55296
    s_cselect_b32 s84, 0x8000000, s86
    s_waitcnt lgkmcnt(0)
    v_mfma_f32_32x32x16_bf16 v[176:191], v[152:155], v[156:159], v[176:191]
    ds_read_b64_tr_b16 v[128:129], v19 offset:4096
    s_add_u32 m0, s83, 32768
    ds_read_b64_tr_b16 v[130:131], v19 offset:4608
    ds_read_b128 v[132:135], v14 offset:0
    buffer_load_dwordx4 v21, s[8:11], s81 offen lds
    s_add_u32 s86, s86, 0x2000
    s_cmp_eq_u32 s86, 57344
    s_cselect_b32 s86, 0, s86
    v_mfma_f32_32x32x16_bf16 v[192:207], v[152:155], v[160:163], v[192:207]
    ds_read_b128 v[136:139], v14 offset:4096
    ds_read_b128 v[140:143], v14 offset:8192
    ds_read_b128 v[144:147], v14 offset:12288
    s_add_u32 s88, s86, s83
    s_cmp_ge_u32 s88, 55296
    s_cselect_b32 s85, 0x8000000, s86
    s_add_u32 m0, s83, 40832
    v_mfma_f32_32x32x16_bf16 v[208:223], v[152:155], v[164:167], v[208:223]
    v_mfma_f32_16x16x32_bf16 v[28:31], v[24:27], v[152:155], v[28:31]
    buffer_load_dwordx4 v20, s[4:7], s81 offen offset:128 lds
    v_mfma_f32_32x32x16_bf16 v[224:239], v[152:155], v[168:171], v[224:239]
    s_waitcnt lgkmcnt(0)
    v_mfma_f32_32x32x16_bf16 v[176:191], v[128:131], v[132:135], v[176:191]
    ds_read_b64_tr_b16 v[152:153], v19 offset:6144
    s_add_u32 m0, s83, 49024
    ds_read_b64_tr_b16 v[154:155], v19 offset:6656
    ds_read_b128 v[156:159], v15 offset:0
    buffer_load_dwordx4 v21, s[8:11], s81 offen offset:128 lds
    s_add_u32 s81, s81, 221184
    v_mfma_f32_32x32x16_bf16 v[192:207], v[128:131], v[136:139], v[192:207]
    ds_read_b128 v[160:163], v15 offset:4096
    ds_read_b128 v[164:167], v15 offset:8192
    ds_read_b128 v[168:171], v15 offset:12288
    v_mfma_f32_32x32x16_bf16 v[208:223], v[128:131], v[140:143], v[208:223]
    v_mfma_f32_16x16x32_bf16 v[28:31], v[24:27], v[128:131], v[28:31]
    v_mfma_f32_32x32x16_bf16 v[224:239], v[128:131], v[144:147], v[224:239]
    s_waitcnt vmcnt(7) lgkmcnt(0)
    s_barrier
    v_mfma_f32_32x32x16_bf16 v[176:191], v[152:155], v[156:159], v[176:191]
    ds_read_b64_tr_b16 v[128:129], v16 offset:49152
    s_add_u32 m0, s83, 105984
    ds_read_b64_tr_b16 v[130:131], v16 offset:49664
    ds_read_b128 v[132:135], v8 offset:49152
    buffer_load_dwordx4 v22, s[12:15], s76 offen offset:512 lds
    v_mfma_f32_32x32x16_bf16 v[192:207], v[152:155], v[160:163], v[192:207]
    ds_read_b128 v[136:139], v8 offset:53248
    ds_read_b128 v[140:143], v8 offset:57344
    ds_read_b128 v[144:147], v8 offset:61440
    s_add_u32 m0, s83, 114176
    v_mfma_f32_32x32x16_bf16 v[208:223], v[152:155], v[164:167], v[208:223]
    v_mfma_f32_16x16x32_bf16 v[28:31], v[24:27], v[152:155], v[28:31]
    buffer_load_dwordx4 v22, s[12:15], s77 offen offset:512 lds
    v_mfma_f32_32x32x16_bf16 v[224:239], v[152:155], v[168:171], v[224:239]
    s_waitcnt lgkmcnt(0)
    v_mfma_f32_32x32x16_bf16 v[176:191], v[128:131], v[132:135], v[176:191]
    ds_read_b64_tr_b16 v[152:153], v16 offset:51200
    s_add_u32 m0, s83, 122880
    ds_read_b64_tr_b16 v[154:155], v16 offset:51712
    ds_read_b128 v[156:159], v9 offset:49152
    buffer_load_dwordx4 v20, s[4:7], s81 offen lds
    v_mfma_f32_32x32x16_bf16 v[192:207], v[128:131], v[136:139], v[192:207]
    ds_read_b128 v[160:163], v9 offset:53248
    ds_read_b128 v[164:167], v9 offset:57344
    ds_read_b128 v[168:171], v9 offset:61440
    s_add_u32 m0, s83, 131072
    v_mfma_f32_32x32x16_bf16 v[208:223], v[128:131], v[140:143], v[208:223]
    v_mfma_f32_16x16x32_bf16 v[28:31], v[24:27], v[128:131], v[28:31]
    buffer_load_dwordx4 v21, s[8:11], s81 offen lds
    v_mfma_f32_32x32x16_bf16 v[224:239], v[128:131], v[144:147], v[224:239]
    s_waitcnt lgkmcnt(0)
    v_mfma_f32_32x32x16_bf16 v[176:191], v[152:155], v[156:159], v[176:191]
    ds_read_b64_tr_b16 v[128:129], v17 offset:53248
    s_add_u32 m0, s83, 139136
    ds_read_b64_tr_b16 v[130:131], v17 offset:53760
    ds_read_b128 v[132:135], v10 offset:49152
    buffer_load_dwordx4 v20, s[4:7], s81 offen offset:128 lds
    v_mfma_f32_32x32x16_bf16 v[192:207], v[152:155], v[160:163], v[192:207]
    ds_read_b128 v[136:139], v10 offset:53248
    ds_read_b128 v[140:143], v10 offset:57344
    ds_read_b128 v[144:147], v10 offset:61440
    s_add_u32 m0, s83, 147328
    v_mfma_f32_32x32x16_bf16 v[208:223], v[152:155], v[164:167], v[208:223]
    v_mfma_f32_16x16x32_bf16 v[28:31], v[24:27], v[152:155], v[28:31]
    buffer_load_dwordx4 v21, s[8:11], s81 offen offset:128 lds
    s_add_u32 s81, s81, 221184
    v_mfma_f32_32x32x16_bf16 v[224:239], v[152:155], v[168:171], v[224:239]
    s_waitcnt lgkmcnt(0)
    v_mfma_f32_32x32x16_bf16 v[176:191], v[128:131], v[132:135], v[176:191]
    ds_read_b64_tr_b16 v[152:153], v17 offset:55296
    ds_read_b64_tr_b16 v[154:155], v17 offset:55808
    ds_read_b128 v[156:159], v11 offset:49152
    v_mfma_f32_32x32x16_bf16 v[192:207], v[128:131], v[136:139], v[192:207]
    ds_read_b128 v[160:163], v11 offset:53248
    ds_read_b128 v[164:167], v11 offset:57344
    ds_read_b128 v[168:171], v11 offset:61440
    v_mfma_f32_32x32x16_bf16 v[208:223], v[128:131], v[140:143], v[208:223]
    v_mfma_f32_16x16x32_bf16 v[28:31], v[24:27], v[128:131], v[28:31]
    v_mfma_f32_32x32x16_bf16 v[224:239], v[128:131], v[144:147], v[224:239]
    s_waitcnt vmcnt(6) lgkmcnt(0)
    s_barrier
    v_mfma_f32_32x32x16_bf16 v[176:191], v[152:155], v[156:159], v[176:191]
    ds_read_b64_tr_b16 v[128:129], v16 offset:0
    s_add_u32 m0, s83, 56704
    ds_read_b64_tr_b16 v[130:131], v16 offset:512
    ds_read_b128 v[132:135], v8 offset:0
    buffer_load_dwordx4 v22, s[12:15], s76 offen offset:640 lds
    v_mfma_f32_32x32x16_bf16 v[192:207], v[152:155], v[160:163], v[192:207]
    ds_read_b128 v[136:139], v8 offset:4096
    ds_read_b128 v[140:143], v8 offset:8192
    ds_read_b128 v[144:147], v8 offset:12288
    s_add_u32 m0, s83, 64896
    v_mfma_f32_32x32x16_bf16 v[208:223], v[152:155], v[164:167], v[208:223]
    v_mfma_f32_16x16x32_bf16 v[28:31], v[24:27], v[152:155], v[28:31]
    buffer_load_dwordx4 v22, s[12:15], s77 offen offset:640 lds
    v_mfma_f32_32x32x16_bf16 v[224:239], v[152:155], v[168:171], v[224:239]
    s_waitcnt lgkmcnt(0)
    v_mfma_f32_32x32x16_bf16 v[176:191], v[128:131], v[132:135], v[176:191]
    ds_read_b64_tr_b16 v[152:153], v16 offset:2048
    s_add_u32 m0, s83, 73728
    ds_read_b64_tr_b16 v[154:155], v16 offset:2560
    ds_read_b128 v[156:159], v9 offset:0
    buffer_load_dwordx4 v20, s[4:7], s81 offen lds
    v_mfma_f32_32x32x16_bf16 v[192:207], v[128:131], v[136:139], v[192:207]
    ds_read_b128 v[160:163], v9 offset:4096
    ds_read_b128 v[164:167], v9 offset:8192
    ds_read_b128 v[168:171], v9 offset:12288
    s_add_u32 m0, s83, 81920
    v_mfma_f32_32x32x16_bf16 v[208:223], v[128:131], v[140:143], v[208:223]
    v_mfma_f32_16x16x32_bf16 v[28:31], v[24:27], v[128:131], v[28:31]
    buffer_load_dwordx4 v21, s[8:11], s81 offen lds
    v_mfma_f32_32x32x16_bf16 v[224:239], v[128:131], v[144:147], v[224:239]
    s_waitcnt lgkmcnt(0)
    v_mfma_f32_32x32x16_bf16 v[176:191], v[152:155], v[156:159], v[176:191]
    ds_read_b64_tr_b16 v[128:129], v17 offset:4096
    s_add_u32 m0, s83, 89984
    ds_read_b64_tr_b16 v[130:131], v17 offset:4608
    ds_read_b128 v[132:135], v10 offset:0
    buffer_load_dwordx4 v20, s[4:7], s81 offen offset:128 lds
    v_mfma_f32_32x32x16_bf16 v[192:207], v[152:155], v[160:163], v[192:207]
    ds_read_b128 v[136:139], v10 offset:4096
    ds_read_b128 v[140:143], v10 offset:8192
    ds_read_b128 v[144:147], v10 offset:12288
    s_add_u32 m0, s83, 98176
    v_mfma_f32_32x32x16_bf16 v[208:223], v[152:155], v[164:167], v[208:223]
    v_mfma_f32_16x16x32_bf16 v[28:31], v[24:27], v[152:155], v[28:31]
    buffer_load_dwordx4 v21, s[8:11], s81 offen offset:128 lds
    s_add_u32 s81, s81, 221184
    v_mfma_f32_32x32x16_bf16 v[224:239], v[152:155], v[168:171], v[224:239]
    s_waitcnt lgkmcnt(0)
    v_mfma_f32_32x32x16_bf16 v[176:191], v[128:131], v[132:135], v[176:191]
    ds_read_b64_tr_b16 v[152:153], v17 offset:6144
    ds_read_b64_tr_b16 v[154:155], v17 offset:6656
    ds_read_b128 v[156:159], v11 offset:0
    v_mfma_f32_32x32x16_bf16 v[192:207], v[128:131], v[136:139], v[192:207]
    ds_read_b128 v[160:163], v11 offset:4096
    ds_read_b128 v[164:167], v11 offset:8192
    ds_read_b128 v[168:171], v11 offset:12288
    v_mfma_f32_32x32x16_bf16 v[208:223], v[128:131], v[140:143], v[208:223]
    v_mfma_f32_16x16x32_bf16 v[28:31], v[24:27], v[128:131], v[28:31]
    v_mfma_f32_32x32x16_bf16 v[224:239], v[128:131], v[144:147], v[224:239]
    s_waitcnt vmcnt(6) lgkmcnt(0)
    s_barrier
    v_mfma_f32_32x32x16_bf16 v[176:191], v[152:155], v[156:159], v[176:191]
    ds_read_b64_tr_b16 v[128:129], v18 offset:0
    s_add_u32 m0, s83, 7424
    ds_read_b64_tr_b16 v[130:131], v18 offset:512
    ds_read_b128 v[132:135], v12 offset:0
    buffer_load_dwordx4 v22, s[12:15], s76 offen offset:768 lds
    v_mfma_f32_32x32x16_bf16 v[192:207], v[152:155], v[160:163], v[192:207]
    ds_read_b128 v[136:139], v12 offset:4096
    ds_read_b128 v[140:143], v12 offset:8192
    ds_read_b128 v[144:147], v12 offset:12288
    s_add_u32 m0, s83, 15616
    v_mfma_f32_32x32x16_bf16 v[208:223], v[152:155], v[164:167], v[208:223]
    v_mfma_f32_16x16x32_bf16 v[28:31], v[24:27], v[152:155], v[28:31]
    buffer_load_dwordx4 v22, s[12:15], s77 offen offset:768 lds
    v_mfma_f32_32x32x16_bf16 v[224:239], v[152:155], v[168:171], v[224:239]
    s_waitcnt lgkmcnt(0)
    v_mfma_f32_32x32x16_bf16 v[176:191], v[128:131], v[132:135], v[176:191]
    ds_read_b64_tr_b16 v[152:153], v18 offset:2048
    ds_read_b64_tr_b16 v[154:155], v18 offset:2560
    ds_read_b128 v[156:159], v13 offset:0
    v_lshlrev_b32 v64, 7, v0
    buffer_load_dword v23, v64, s[24:27], 0 offen sc1
    v_mfma_f32_32x32x16_bf16 v[192:207], v[128:131], v[136:139], v[192:207]
    ds_read_b128 v[160:163], v13 offset:4096
    ds_read_b128 v[164:167], v13 offset:8192
    ds_read_b128 v[168:171], v13 offset:12288
    s_add_u32 m0, s83, 24576
    v_mfma_f32_32x32x16_bf16 v[208:223], v[128:131], v[140:143], v[208:223]
    v_mfma_f32_16x16x32_bf16 v[28:31], v[24:27], v[128:131], v[28:31]
    buffer_load_dwordx4 v20, s[4:7], s81 offen lds
    v_mfma_f32_32x32x16_bf16 v[224:239], v[128:131], v[144:147], v[224:239]
    s_waitcnt lgkmcnt(0)
    v_mfma_f32_32x32x16_bf16 v[176:191], v[152:155], v[156:159], v[176:191]
    ds_read_b64_tr_b16 v[128:129], v19 offset:4096
    s_add_u32 m0, s83, 32768
    ds_read_b64_tr_b16 v[130:131], v19 offset:4608
    ds_read_b128 v[132:135], v14 offset:0
    buffer_load_dwordx4 v21, s[8:11], s81 offen lds
    v_mfma_f32_32x32x16_bf16 v[192:207], v[152:155], v[160:163], v[192:207]
    ds_read_b128 v[136:139], v14 offset:4096
    ds_read_b128 v[140:143], v14 offset:8192
    ds_read_b128 v[144:147], v14 offset:12288
    s_add_u32 m0, s83, 40832
    v_mfma_f32_32x32x16_bf16 v[208:223], v[152:155], v[164:167], v[208:223]
    v_mfma_f32_16x16x32_bf16 v[28:31], v[24:27], v[152:155], v[28:31]
    buffer_load_dwordx4 v20, s[4:7], s81 offen offset:128 lds
    v_mfma_f32_32x32x16_bf16 v[224:239], v[152:155], v[168:171], v[224:239]
    s_waitcnt lgkmcnt(0)
    v_mfma_f32_32x32x16_bf16 v[176:191], v[128:131], v[132:135], v[176:191]
    ds_read_b64_tr_b16 v[152:153], v19 offset:6144
    s_add_u32 m0, s83, 49024
    ds_read_b64_tr_b16 v[154:155], v19 offset:6656
    ds_read_b128 v[156:159], v15 offset:0
    buffer_load_dwordx4 v21, s[8:11], s81 offen offset:128 lds
    s_add_u32 s81, s81, 221184
    v_mfma_f32_32x32x16_bf16 v[192:207], v[128:131], v[136:139], v[192:207]
    ds_read_b128 v[160:163], v15 offset:4096
    ds_read_b128 v[164:167], v15 offset:8192
    ds_read_b128 v[168:171], v15 offset:12288
    v_mfma_f32_32x32x16_bf16 v[208:223], v[128:131], v[140:143], v[208:223]
    v_mfma_f32_16x16x32_bf16 v[28:31], v[24:27], v[128:131], v[28:31]
    v_mfma_f32_32x32x16_bf16 v[224:239], v[128:131], v[144:147], v[224:239]
    s_cmp_lg_u32 s68, 0
    s_cbranch_scc1 L_cd46
    s_waitcnt vmcnt(4)
L_cp45:
    v_cmp_gt_u32 vcc, 0x80, v23
    s_nop 0
    s_and_b32 s88, vcc_lo, 3
    s_cbranch_scc0 L_cd46
    v_lshlrev_b32_e64 v64, 7, v0
    buffer_load_dword v23, v64, s[24:27], 0 offen sc1
    s_waitcnt vmcnt(0)
    s_sub_u32 s99, s99, 1
    s_cmp_gt_i32 s99, 0
    s_cbranch_scc1 L_cp45
L_cd46:
    s_waitcnt vmcnt(7) lgkmcnt(0)
    s_barrier
    v_mfma_f32_32x32x16_bf16 v[176:191], v[152:155], v[156:159], v[176:191]
    ds_read_b64_tr_b16 v[128:129], v16 offset:49152
    s_add_u32 m0, s83, 105600
    ds_read_b64_tr_b16 v[130:131], v16 offset:49664
    ds_read_b128 v[132:135], v8 offset:49152
    buffer_load_dwordx4 v22, s[12:15], s76 offen offset:896 lds
    v_mfma_f32_32x32x16_bf16 v[192:207], v[152:155], v[160:163], v[192:207]
    ds_read_b128 v[136:139], v8 offset:53248
    ds_read_b128 v[140:143], v8 offset:57344
    ds_read_b128 v[144:147], v8 offset:61440
    s_add_u32 m0, s83, 113792
    v_mfma_f32_32x32x16_bf16 v[208:223], v[152:155], v[164:167], v[208:223]
    v_mfma_f32_16x16x32_bf16 v[28:31], v[24:27], v[152:155], v[28:31]
    buffer_load_dwordx4 v22, s[12:15], s77 offen offset:896 lds
    v_mfma_f32_32x32x16_bf16 v[224:239], v[152:155], v[168:171], v[224:239]
    s_waitcnt lgkmcnt(0)
    v_mfma_f32_32x32x16_bf16 v[176:191], v[128:131], v[132:135], v[176:191]
    ds_read_b64_tr_b16 v[152:153], v16 offset:51200
    ds_read_b64_tr_b16 v[154:155], v16 offset:51712
    ds_read_b128 v[156:159], v9 offset:49152
    buffer_load_dwordx4 v[148:151], v67, s[16:19], 0 offen sc1
    v_mfma_f32_32x32x16_bf16 v[192:207], v[128:131], v[136:139], v[192:207]
    ds_read_b128 v[160:163], v9 offset:53248
    ds_read_b128 v[164:167], v9 offset:57344
    ds_read_b128 v[168:171], v9 offset:61440
    s_add_u32 m0, s83, 122880
    v_mfma_f32_32x32x16_bf16 v[208:223], v[128:131], v[140:143], v[208:223]
    v_mfma_f32_16x16x32_bf16 v[28:31], v[24:27], v[128:131], v[28:31]
    buffer_load_dwordx4 v20, s[4:7], s81 offen lds
    v_mfma_f32_32x32x16_bf16 v[224:239], v[128:131], v[144:147], v[224:239]
    s_waitcnt lgkmcnt(0)
    v_mfma_f32_32x32x16_bf16 v[176:191], v[152:155], v[156:159], v[176:191]
    ds_read_b64_tr_b16 v[128:129], v17 offset:53248
    s_add_u32 m0, s83, 131072
    ds_read_b64_tr_b16 v[130:131], v17 offset:53760
    ds_read_b128 v[132:135], v10 offset:49152
    buffer_load_dwordx4 v21, s[8:11], s81 offen lds
    v_mfma_f32_32x32x16_bf16 v[192:207], v[152:155], v[160:163], v[192:207]
    ds_read_b128 v[136:139], v10 offset:53248
    ds_read_b128 v[140:143], v10 offset:57344
    ds_read_b128 v[144:147], v10 offset:61440
    s_add_u32 m0, s83, 139136
    v_mfma_f32_32x32x16_bf16 v[208:223], v[152:155], v[164:167], v[208:223]
    v_mfma_f32_16x16x32_bf16 v[28:31], v[24:27], v[152:155], v[28:31]
    buffer_load_dwordx4 v20, s[4:7], s81 offen offset:128 lds
    v_mfma_f32_32x32x16_bf16 v[224:239], v[152:155], v[168:171], v[224:239]
    s_waitcnt lgkmcnt(0)
    v_mfma_f32_32x32x16_bf16 v[176:191], v[128:131], v[132:135], v[176:191]
    ds_read_b64_tr_b16 v[152:153], v17 offset:55296
    s_add_u32 m0, s83, 147328
    ds_read_b64_tr_b16 v[154:155], v17 offset:55808
    ds_read_b128 v[156:159], v11 offset:49152
    buffer_load_dwordx4 v21, s[8:11], s81 offen offset:128 lds
    s_add_u32 s81, s81, 221184
    v_mfma_f32_32x32x16_bf16 v[192:207], v[128:131], v[136:139], v[192:207]
    ds_read_b128 v[160:163], v11 offset:53248
    ds_read_b128 v[164:167], v11 offset:57344
    ds_read_b128 v[168:171], v11 offset:61440
    v_mfma_f32_32x32x16_bf16 v[208:223], v[128:131], v[140:143], v[208:223]
    v_mfma_f32_16x16x32_bf16 v[28:31], v[24:27], v[128:131], v[28:31]
    v_mfma_f32_32x32x16_bf16 v[224:239], v[128:131], v[144:147], v[224:239]
    s_cmp_lg_u32 s68, 0
    s_cbranch_scc1 L_cd48
    s_waitcnt vmcnt(4)
L_cp47:
    v_and_b32 v148, v148, v149
    v_and_b32 v150, v150, v151
    v_and_b32 v148, 1, v148
    v_and_b32 v148, v148, v150
    v_cmp_ne_u32 vcc, 1, v148
    s_nop 0
    s_and_b32 vcc_hi, vcc_hi, 0xfff
    s_cmp_lg_u64 vcc, 0
    s_cbranch_scc0 L_cd48
    buffer_load_dwordx4 v[148:151], v67, s[16:19], 0 offen sc1
    s_waitcnt vmcnt(0)
    s_sub_u32 s99, s99, 1
    s_cmp_gt_i32 s99, 0
    s_cbranch_scc1 L_cp47
L_cd48:
    s_waitcnt vmcnt(7) lgkmcnt(0)
    s_barrier
    v_mfma_f32_32x32x16_bf16 v[176:191], v[152:155], v[156:159], v[176:191]
    ds_read_b64_tr_b16 v[128:129], v16 offset:0
    s_add_u32 m0, s83, 56320
    ds_read_b64_tr_b16 v[130:131], v16 offset:512
    ds_read_b128 v[132:135], v8 offset:0
    buffer_load_dwordx4 v22, s[12:15], s76 offen offset:1024 lds
    v_mfma_f32_32x32x16_bf16 v[192:207], v[152:155], v[160:163], v[192:207]
    ds_read_b128 v[136:139], v8 offset:4096
    ds_read_b128 v[140:143], v8 offset:8192
    ds_read_b128 v[144:147], v8 offset:12288
    s_add_u32 m0, s83, 64512
    v_mfma_f32_32x32x16_bf16 v[208:223], v[152:155], v[164:167], v[208:223]
    v_mfma_f32_16x16x32_bf16 v[28:31], v[24:27], v[152:155], v[28:31]
    buffer_load_dwordx4 v22, s[12:15], s77 offen offset:1024 lds
    v_mfma_f32_32x32x16_bf16 v[224:239], v[152:155], v[168:171], v[224:239]
    s_waitcnt lgkmcnt(0)
    v_mfma_f32_32x32x16_bf16 v[176:191], v[128:131], v[132:135], v[176:191]
    ds_read_b64_tr_b16 v[152:153], v16 offset:2048
    s_add_u32 m0, s83, 73728
    ds_read_b64_tr_b16 v[154:155], v16 offset:2560
    ds_read_b128 v[156:159], v9 offset:0
    buffer_load_dwordx4 v20, s[4:7], s81 offen lds
    v_mfma_f32_32x32x16_bf16 v[192:207], v[128:131], v[136:139], v[192:207]
    ds_read_b128 v[160:163], v9 offset:4096
    ds_read_b128 v[164:167], v9 offset:8192
    ds_read_b128 v[168:171], v9 offset:12288
    s_add_u32 m0, s83, 81920
    v_mfma_f32_32x32x16_bf16 v[208:223], v[128:131], v[140:143], v[208:223]
    v_mfma_f32_16x16x32_bf16 v[28:31], v[24:27], v[128:131], v[28:31]
    buffer_load_dwordx4 v21, s[8:11], s81 offen lds
    v_mfma_f32_32x32x16_bf16 v[224:239], v[128:131], v[144:147], v[224:239]
    s_waitcnt lgkmcnt(0)
    v_mfma_f32_32x32x16_bf16 v[176:191], v[152:155], v[156:159], v[176:191]
    ds_read_b64_tr_b16 v[128:129], v17 offset:4096
    s_add_u32 m0, s83, 89984
    ds_read_b64_tr_b16 v[130:131], v17 offset:4608
    ds_read_b128 v[132:135], v10 offset:0
    buffer_load_dwordx4 v20, s[4:7], s81 offen offset:128 lds
    v_mfma_f32_32x32x16_bf16 v[192:207], v[152:155], v[160:163], v[192:207]
    ds_read_b128 v[136:139], v10 offset:4096
    ds_read_b128 v[140:143], v10 offset:8192
    ds_read_b128 v[144:147], v10 offset:12288
    s_add_u32 m0, s83, 98176
    v_mfma_f32_32x32x16_bf16 v[208:223], v[152:155], v[164:167], v[208:223]
    v_mfma_f32_16x16x32_bf16 v[28:31], v[24:27], v[152:155], v[28:31]
    buffer_load_dwordx4 v21, s[8:11], s81 offen offset:128 lds
    s_add_u32 s81, s81, 221184
    v_mfma_f32_32x32x16_bf16 v[224:239], v[152:155], v[168:171], v[224:239]
    s_waitcnt lgkmcnt(0)
    v_mfma_f32_32x32x16_bf16 v[176:191], v[128:131], v[132:135], v[176:191]
    ds_read_b64_tr_b16 v[152:153], v17 offset:6144
    ds_read_b64_tr_b16 v[154:155], v17 offset:6656
    ds_read_b128 v[156:159], v11 offset:0
    buffer_load_dwordx4 v[32:35], v59, s[16:19], s47 offen offset:0 sc1
    v_mfma_f32_32x32x16_bf16 v[192:207], v[128:131], v[136:139], v[192:207]
    ds_read_b128 v[160:163], v11 offset:4096
    ds_read_b128 v[164:167], v11 offset:8192
    ds_read_b128 v[168:171], v11 offset:12288
    v_mfma_f32_32x32x16_bf16 v[208:223], v[128:131], v[140:143], v[208:223]
    v_mfma_f32_16x16x32_bf16 v[28:31], v[24:27], v[128:131], v[28:31]
    buffer_load_dwordx4 v[36:39], v59, s[16:19], s47 offen offset:512 sc1
    v_mfma_f32_32x32x16_bf16 v[224:239], v[128:131], v[144:147], v[224:239]
    s_waitcnt vmcnt(8) lgkmcnt(0)
    s_barrier
    v_mfma_f32_32x32x16_bf16 v[176:191], v[152:155], v[156:159], v[176:191]
    ds_read_b64_tr_b16 v[128:129], v18 offset:0
    s_add_u32 m0, s83, 7040
    ds_read_b64_tr_b16 v[130:131], v18 offset:512
    ds_read_b128 v[132:135], v12 offset:0
    buffer_load_dwordx4 v22, s[12:15], s76 offen offset:1152 lds
    v_mfma_f32_32x32x16_bf16 v[192:207], v[152:155], v[160:163], v[192:207]
    ds_read_b128 v[136:139], v12 offset:4096
    ds_read_b128 v[140:143], v12 offset:8192
    ds_read_b128 v[144:147], v12 offset:12288
    s_add_u32 m0, s83, 15232
    v_mfma_f32_32x32x16_bf16 v[208:223], v[152:155], v[164:167], v[208:223]
    v_mfma_f32_16x16x32_bf16 v[28:31], v[24:27], v[152:155], v[28:31]
    buffer_load_dwordx4 v22, s[12:15], s77 offen offset:1152 lds
    v_mfma_f32_32x32x16_bf16 v[224:239], v[152:155], v[168:171], v[224:239]
    s_waitcnt lgkmcnt(0)
    v_mfma_f32_32x32x16_bf16 v[176:191], v[128:131], v[132:135], v[176:191]
    ds_read_b64_tr_b16 v[152:153], v18 offset:2048
    s_add_u32 m0, s83, 24576
    ds_read_b64_tr_b16 v[154:155], v18 offset:2560
    ds_read_b128 v[156:159], v13 offset:0
    buffer_load_dwordx4 v20, s[4:7], s81 offen lds
    v_mfma_f32_32x32x16_bf16 v[192:207], v[128:131], v[136:139], v[192:207]
    ds_read_b128 v[160:163], v13 offset:4096
    ds_read_b128 v[164:167], v13 offset:8192
    ds_read_b128 v[168:171], v13 offset:12288
    s_add_u32 m0, s83, 32768
    v_mfma_f32_32x32x16_bf16 v[208:223], v[128:131], v[140:143], v[208:223]
    v_mfma_f32_16x16x32_bf16 v[28:31], v[24:27], v[128:131], v[28:31]
    buffer_load_dwordx4 v21, s[8:11], s81 offen lds
    v_mfma_f32_32x32x16_bf16 v[224:239], v[128:131], v[144:147], v[224:239]
    s_waitcnt lgkmcnt(0)
    v_mfma_f32_32x32x16_bf16 v[176:191], v[152:155], v[156:159], v[176:191]
    ds_read_b64_tr_b16 v[128:129], v19 offset:4096
    s_add_u32 m0, s83, 40832
    ds_read_b64_tr_b16 v[130:131], v19 offset:4608
    ds_read_b128 v[132:135], v14 offset:0
    buffer_load_dwordx4 v20, s[4:7], s81 offen offset:128 lds
    v_mfma_f32_32x32x16_bf16 v[192:207], v[152:155], v[160:163], v[192:207]
    ds_read_b128 v[136:139], v14 offset:4096
    ds_read_b128 v[140:143], v14 offset:8192
    ds_read_b128 v[144:147], v14 offset:12288
    s_add_u32 m0, s83, 49024
    v_mfma_f32_32x32x16_bf16 v[208:223], v[152:155], v[164:167], v[208:223]
    v_mfma_f32_16x16x32_bf16 v[28:31], v[24:27], v[152:155], v[28:31]
    buffer_load_dwordx4 v21, s[8:11], s81 offen offset:128 lds
    v_mfma_f32_32x32x16_bf16 v[224:239], v[152:155], v[168:171], v[224:239]
    s_waitcnt lgkmcnt(0)
    v_mfma_f32_32x32x16_bf16 v[176:191], v[128:131], v[132:135], v[176:191]
    ds_read_b64_tr_b16 v[152:153], v19 offset:6144
    ds_read_b64_tr_b16 v[154:155], v19 offset:6656
    ds_read_b128 v[156:159], v15 offset:0
    buffer_load_dwordx4 v[40:43], v59, s[16:19], s47 offen offset:1024 sc1
    v_mfma_f32_32x32x16_bf16 v[192:207], v[128:131], v[136:139], v[192:207]
    ds_read_b128 v[160:163], v15 offset:4096
    ds_read_b128 v[164:167], v15 offset:8192
    ds_read_b128 v[168:171], v15 offset:12288
    v_mfma_f32_32x32x16_bf16 v[208:223], v[128:131], v[140:143], v[208:223]
    v_mfma_f32_16x16x32_bf16 v[28:31], v[24:27], v[128:131], v[28:31]
    buffer_load_dwordx4 v[44:47], v59, s[16:19], s47 offen offset:1536 sc1
    v_mfma_f32_32x32x16_bf16 v[224:239], v[128:131], v[144:147], v[224:239]
    s_waitcnt vmcnt(10) lgkmcnt(0)
    s_barrier
    v_mfma_f32_32x32x16_bf16 v[176:191], v[152:155], v[156:159], v[176:191]
    ds_read_b64_tr_b16 v[128:129], v16 offset:49152
    ds_read_b64_tr_b16 v[130:131], v16 offset:49664
    ds_read_b128 v[132:135], v8 offset:49152
    s_lshl2_add_u32 s3, s36, s98
    s_add_u32 s3, s3, s36
    buffer_load_dwordx4 v[68:71], v4, s[16:19], s3 offen sc1
    v_mfma_f32_32x32x16_bf16 v[192:207], v[152:155], v[160:163], v[192:207]
    ds_read_b128 v[136:139], v8 offset:53248
    ds_read_b128 v[140:143], v8 offset:57344
    ds_read_b128 v[144:147], v8 offset:61440
    v_mfma_f32_32x32x16_bf16 v[208:223], v[152:155], v[164:167], v[208:223]
    v_mfma_f32_16x16x32_bf16 v[28:31], v[24:27], v[152:155], v[28:31]
    buffer_load_dwordx4 v[72:75], v4, s[16:19], s3 offen offset:1024 sc1
    v_mfma_f32_32x32x16_bf16 v[224:239], v[152:155], v[168:171], v[224:239]
    s_waitcnt lgkmcnt(0)
    v_mfma_f32_32x32x16_bf16 v[176:191], v[128:131], v[132:135], v[176:191]
    ds_read_b64_tr_b16 v[152:153], v16 offset:51200
    ds_read_b64_tr_b16 v[154:155], v16 offset:51712
    ds_read_b128 v[156:159], v9 offset:49152
    buffer_load_dwordx4 v[76:79], v4, s[16:19], s3 offen offset:2048 sc1
    v_mfma_f32_32x32x16_bf16 v[192:207], v[128:131], v[136:139], v[192:207]
    ds_read_b128 v[160:163], v9 offset:53248
    ds_read_b128 v[164:167], v9 offset:57344
    ds_read_b128 v[168:171], v9 offset:61440
    v_mfma_f32_32x32x16_bf16 v[208:223], v[128:131], v[140:143], v[208:223]
    v_mfma_f32_16x16x32_bf16 v[28:31], v[24:27], v[128:131], v[28:31]
    buffer_load_dwordx4 v[80:83], v4, s[16:19], s3 offen offset:3072 sc1
    v_mfma_f32_32x32x16_bf16 v[224:239], v[128:131], v[144:147], v[224:239]
    s_waitcnt lgkmcnt(0)
    v_mfma_f32_32x32x16_bf16 v[176:191], v[152:155], v[156:159], v[176:191]
    ds_read_b64_tr_b16 v[128:129], v17 offset:53248
    ds_read_b64_tr_b16 v[130:131], v17 offset:53760
    ds_read_b128 v[132:135], v10 offset:49152
    buffer_load_dwordx4 v[84:87], v5, s[16:19], s3 offen sc1
    v_mfma_f32_32x32x16_bf16 v[192:207], v[152:155], v[160:163], v[192:207]
    ds_read_b128 v[136:139], v10 offset:53248
    ds_read_b128 v[140:143], v10 offset:57344
    ds_read_b128 v[144:147], v10 offset:61440
    v_mfma_f32_32x32x16_bf16 v[208:223], v[152:155], v[164:167], v[208:223]
    v_mfma_f32_16x16x32_bf16 v[28:31], v[24:27], v[152:155], v[28:31]
    s_lshl2_add_u32 s3, s37, s98
    s_add_u32 s3, s3, s37
    buffer_load_dwordx4 v[88:91], v4, s[16:19], s3 offen sc1
    v_mfma_f32_32x32x16_bf16 v[224:239], v[152:155], v[168:171], v[224:239]
    s_waitcnt lgkmcnt(0)
    v_mfma_f32_32x32x16_bf16 v[176:191], v[128:131], v[132:135], v[176:191]
    ds_read_b64_tr_b16 v[152:153], v17 offset:55296
    ds_read_b64_tr_b16 v[154:155], v17 offset:55808
    ds_read_b128 v[156:159], v11 offset:49152
    buffer_load_dwordx4 v[92:95], v4, s[16:19], s3 offen offset:1024 sc1
    v_mfma_f32_32x32x16_bf16 v[192:207], v[128:131], v[136:139], v[192:207]
    ds_read_b128 v[160:163], v11 offset:53248
    ds_read_b128 v[164:167], v11 offset:57344
    ds_read_b128 v[168:171], v11 offset:61440
    v_mfma_f32_32x32x16_bf16 v[208:223], v[128:131], v[140:143], v[208:223]
    v_mfma_f32_16x16x32_bf16 v[28:31], v[24:27], v[128:131], v[28:31]
    buffer_load_dwordx4 v[96:99], v4, s[16:19], s3 offen offset:2048 sc1
    v_mfma_f32_32x32x16_bf16 v[224:239], v[128:131], v[144:147], v[224:239]
    s_cmp_lg_u32 s68, 4
    s_cbranch_scc1 L_si49
    v_and_b32 v64, 7, v1
    v_lshlrev_b32 v64, 10, v64
    v_mov_b32 v65, 0
    ds_write_b32 v64, v65 offset:512
    v_mov_b32_e64 v64, 0
    ds_write_b32 v65, v64 offset:4612
L_si49:
    s_waitcnt vmcnt(10) lgkmcnt(0)
    s_barrier
    v_mfma_f32_32x32x16_bf16 v[176:191], v[152:155], v[156:159], v[176:191]
    ds_read_b64_tr_b16 v[128:129], v16 offset:0
    ds_read_b64_tr_b16 v[130:131], v16 offset:512
    ds_read_b128 v[132:135], v8 offset:0
    buffer_load_dwordx4 v[100:103], v4, s[16:19], s3 offen offset:3072 sc1
    v_mov_b32 v58, 1073741824
    v_lshlrev_b32 v2, 7, v1
    v_cmp_gt_u32 vcc, 2, v1
    s_nop 1
    v_cndmask_b32_e64 v2, v58, v2, vcc
    v_mfma_f32_32x32x16_bf16 v[192:207], v[152:155], v[160:163], v[192:207]
    ds_read_b128 v[136:139], v8 offset:4096
    ds_read_b128 v[140:143], v8 offset:8192
    ds_read_b128 v[144:147], v8 offset:12288
    v_mfma_f32_32x32x16_bf16 v[208:223], v[152:155], v[164:167], v[208:223]
    v_mfma_f32_16x16x32_bf16 v[28:31], v[24:27], v[152:155], v[28:31]
    buffer_load_dwordx4 v[104:107], v5, s[16:19], s3 offen sc1
    v_mfma_f32_32x32x16_bf16 v[224:239], v[152:155], v[168:171], v[224:239]
    s_waitcnt lgkmcnt(0)
    v_mfma_f32_32x32x16_bf16 v[176:191], v[128:131], v[132:135], v[176:191]
    ds_read_b64_tr_b16 v[152:153], v16 offset:2048
    ds_read_b64_tr_b16 v[154:155], v16 offset:2560
    ds_read_b128 v[156:159], v9 offset:0
    s_lshl2_add_u32 s3, s42, s98
    s_add_u32 s3, s3, s42
    buffer_load_dwordx4 v[108:111], v4, s[16:19], s3 offen sc1
    v_mfma_f32_32x32x16_bf16 v[192:207], v[128:131], v[136:139], v[192:207]
    ds_read_b128 v[160:163], v9 offset:4096
    ds_read_b128 v[164:167], v9 offset:8192
    ds_read_b128 v[168:171], v9 offset:12288
    v_mfma_f32_32x32x16_bf16 v[208:223], v[128:131], v[140:143], v[208:223]
    v_mfma_f32_16x16x32_bf16 v[28:31], v[24:27], v[128:131], v[28:31]
    buffer_load_dwordx4 v[112:115], v4, s[16:19], s3 offen offset:1024 sc1
    v_mfma_f32_32x32x16_bf16 v[224:239], v[128:131], v[144:147], v[224:239]
    s_waitcnt lgkmcnt(0)
    v_mfma_f32_32x32x16_bf16 v[176:191], v[152:155], v[156:159], v[176:191]
    ds_read_b64_tr_b16 v[128:129], v17 offset:4096
    ds_read_b64_tr_b16 v[130:131], v17 offset:4608
    ds_read_b128 v[132:135], v10 offset:0
    buffer_load_dwordx4 v[116:119], v4, s[16:19], s3 offen offset:2048 sc1
    v_mfma_f32_32x32x16_bf16 v[192:207], v[152:155], v[160:163], v[192:207]
    ds_read_b128 v[136:139], v10 offset:4096
    ds_read_b128 v[140:143], v10 offset:8192
    ds_read_b128 v[144:147], v10 offset:12288
    v_mfma_f32_32x32x16_bf16 v[208:223], v[152:155], v[164:167], v[208:223]
    v_mfma_f32_16x16x32_bf16 v[28:31], v[24:27], v[152:155], v[28:31]
    buffer_load_dwordx4 v[120:123], v4, s[16:19], s3 offen offset:3072 sc1
    v_mfma_f32_32x32x16_bf16 v[224:239], v[152:155], v[168:171], v[224:239]
    s_waitcnt lgkmcnt(0)
    v_mfma_f32_32x32x16_bf16 v[176:191], v[128:131], v[132:135], v[176:191]
    ds_read_b64_tr_b16 v[152:153], v17 offset:6144
    ds_read_b64_tr_b16 v[154:155], v17 offset:6656
    ds_read_b128 v[156:159], v11 offset:0
    buffer_load_dwordx4 v[124:127], v5, s[16:19], s3 offen sc1
    v_mfma_f32_32x32x16_bf16 v[192:207], v[128:131], v[136:139], v[192:207]
    ds_read_b128 v[160:163], v11 offset:4096
    ds_read_b128 v[164:167], v11 offset:8192
    ds_read_b128 v[168:171], v11 offset:12288
    v_mfma_f32_32x32x16_bf16 v[208:223], v[128:131], v[140:143], v[208:223]
    v_mfma_f32_16x16x32_bf16 v[28:31], v[24:27], v[128:131], v[28:31]
    s_lshl2_add_u32 s3, s44, s98
    s_add_u32 s3, s3, s44
    s_add_u32 m0, s83, 122880
    s_nop 0
    buffer_load_dwordx4 v4, s[16:19], s3 offen sc1 lds
    v_mfma_f32_32x32x16_bf16 v[224:239], v[128:131], v[144:147], v[224:239]
    s_waitcnt lgkmcnt(0)
    s_barrier
    s_add_u32 m0, s83, 130048
    v_mfma_f32_32x32x16_bf16 v[176:191], v[152:155], v[156:159], v[176:191]
    buffer_load_dwordx4 v4, s[16:19], s3 offen offset:1024 sc1 lds
    s_add_u32 m0, s83, 137216
    v_mfma_f32_32x32x16_bf16 v[192:207], v[152:155], v[160:163], v[192:207]
    buffer_load_dwordx4 v4, s[16:19], s3 offen offset:2048 sc1 lds
    s_add_u32 m0, s83, 144384
    v_mfma_f32_32x32x16_bf16 v[208:223], v[152:155], v[164:167], v[208:223]
    v_mfma_f32_16x16x32_bf16 v[28:31], v[24:27], v[152:155], v[28:31]
    buffer_load_dwordx4 v4, s[16:19], s3 offen offset:3072 sc1 lds
    s_add_u32 m0, s83, 155648
    v_mfma_f32_32x32x16_bf16 v[224:239], v[152:155], v[168:171], v[224:239]
    buffer_load_dwordx4 v5, s[16:19], s3 offen sc1 lds
    s_setprio 3
    v_cmp_gt_u32_e64 vcc, 32, v1
    s_nop 1
    v_cvt_pk_bf16_f32 v58, v28, v28
    v_lshlrev_b32 v58, 16, v58
    v_sub_f32 v58, v28, v58
    v_cvt_pk_bf16_f32 v55, v28, v58
    v_cndmask_b32_e64 v55, 0, v55, vcc
    s_waitcnt vmcnt(20)
    s_nop 0
    v_mfma_f32_32x32x16_bf16 v[176:191], v[52:55], v[32:35], v[176:191]
    v_mfma_f32_32x32x16_bf16 v[192:207], v[52:55], v[36:39], v[192:207]
    v_mfma_f32_32x32x16_bf16 v[208:223], v[52:55], v[40:43], v[208:223]
    v_mfma_f32_32x32x16_bf16 v[224:239], v[52:55], v[44:47], v[224:239]
    s_lshl2_add_u32 s3, s43, s98
    s_add_u32 s3, s3, s43
    s_add_u32 m0, s83, 81920
    s_nop 0
    buffer_load_dwordx4 v4, s[16:19], s3 offen sc1 lds
    s_add_u32 m0, s83, 89088
    s_nop 0
    buffer_load_dwordx4 v4, s[16:19], s3 offen offset:1024 sc1 lds
    s_nop 0
    s_nop 0
    v_pk_mul_f32 v[8:9], v[176:177], v[176:177]
    v_pk_mul_f32 v[10:11], v[178:179], v[178:179]
    v_pk_mul_f32 v[12:13], v[180:181], v[180:181]
    v_pk_mul_f32 v[14:15], v[182:183], v[182:183]
    v_pk_fma_f32 v[8:9], v[32:33], v[8:9], v[32:33] op_sel:[1,0,0] op_sel_hi:[1,1,0]
    v_pk_fma_f32 v[10:11], v[32:33], v[10:11], v[32:33] op_sel:[1,0,0] op_sel_hi:[1,1,0]
    v_pk_fma_f32 v[12:13], v[32:33], v[12:13], v[32:33] op_sel:[1,0,0] op_sel_hi:[1,1,0]
    v_pk_fma_f32 v[14:15], v[32:33], v[14:15], v[32:33] op_sel:[1,0,0] op_sel_hi:[1,1,0]
    v_pk_mul_f32 v[8:9], v[8:9], v[176:177]
    v_pk_mul_f32 v[10:11], v[10:11], v[178:179]
    v_pk_mul_f32 v[12:13], v[12:13], v[180:181]
    v_pk_mul_f32 v[14:15], v[14:15], v[182:183]
    v_exp_f32 v8, v8
    v_exp_f32 v9, v9
    v_exp_f32_e64 v10, v10
    s_add_u32 m0, s83, 96256
    v_exp_f32 v11, v11
    v_exp_f32 v12, v12
    buffer_load_dwordx4 v4, s[16:19], s3 offen offset:2048 sc1 lds
    v_exp_f32 v13, v13
    v_exp_f32 v14, v14
    v_exp_f32_e64 v15, v15
    v_pk_mul_f32 v[16:17], v[176:177], v[184:185]
    v_pk_mul_f32 v[18:19], v[178:179], v[186:187]
    v_pk_mul_f32 v[20:21], v[180:181], v[188:189]
    v_pk_mul_f32 v[22:23], v[182:183], v[190:191]
    v_pk_fma_f32 v[8:9], v[8:9], v[34:35], v[34:35] op_sel_hi:[1,0,0]
    v_pk_fma_f32 v[10:11], v[10:11], v[34:35], v[34:35] op_sel_hi:[1,0,0]
    v_pk_fma_f32 v[12:13], v[12:13], v[34:35], v[34:35] op_sel_hi:[1,0,0]
    v_pk_fma_f32 v[14:15], v[14:15], v[34:35], v[34:35] op_sel_hi:[1,0,0]
    v_rcp_f32 v8, v8
    v_rcp_f32 v9, v9
    s_add_u32 m0, s83, 103424
    v_rcp_f32 v10, v10
    v_rcp_f32 v11, v11
    buffer_load_dwordx4 v4, s[16:19], s3 offen offset:3072 sc1 lds
    v_rcp_f32 v12, v12
    v_rcp_f32 v13, v13
    v_rcp_f32 v14, v14
    v_rcp_f32 v15, v15
    v_pk_mul_f32 v[8:9], v[8:9], v[16:17]
    v_pk_mul_f32 v[10:11], v[10:11], v[18:19]
    v_pk_mul_f32 v[12:13], v[12:13], v[20:21]
    v_pk_mul_f32 v[14:15], v[14:15], v[22:23]
    v_cvt_pk_bf16_f32 v24, v8, v9
    v_cvt_pk_bf16_f32 v25, v10, v11
    v_cvt_pk_bf16_f32 v26, v12, v13
    v_cvt_pk_bf16_f32 v27, v14, v15
    buffer_store_dwordx4 v[24:27], v56, s[16:19], s54 offen sc1
    v_pk_mul_f32 v[8:9], v[192:193], v[192:193]
    v_pk_mul_f32 v[10:11], v[194:195], v[194:195]
    v_pk_mul_f32 v[12:13], v[196:197], v[196:197]
    v_pk_mul_f32 v[14:15], v[198:199], v[198:199]
    s_add_u32 m0, s83, 114688
    v_pk_fma_f32 v[8:9], v[36:37], v[8:9], v[36:37] op_sel:[1,0,0] op_sel_hi:[1,1,0]
    v_pk_fma_f32 v[10:11], v[36:37], v[10:11], v[36:37] op_sel:[1,0,0] op_sel_hi:[1,1,0]
    buffer_load_dwordx4 v5, s[16:19], s3 offen sc1 lds
    v_pk_fma_f32 v[12:13], v[36:37], v[12:13], v[36:37] op_sel:[1,0,0] op_sel_hi:[1,1,0]
    v_pk_fma_f32 v[14:15], v[36:37], v[14:15], v[36:37] op_sel:[1,0,0] op_sel_hi:[1,1,0]
    v_pk_mul_f32 v[8:9], v[8:9], v[192:193]
    v_pk_mul_f32 v[10:11], v[10:11], v[194:195]
    v_pk_mul_f32 v[12:13], v[12:13], v[196:197]
    v_pk_mul_f32 v[14:15], v[14:15], v[198:199]
    v_exp_f32 v8, v8
    v_exp_f32 v9, v9
    v_exp_f32 v10, v10
    v_exp_f32 v11, v11
    v_exp_f32 v12, v12
    v_exp_f32 v13, v13
    v_exp_f32 v14, v14
    v_exp_f32 v15, v15
    s_lshl2_add_u32 s3, s45, s98
    s_add_u32 s3, s3, s45
    s_add_u32 m0, s83, 40960
    s_nop 0
    s_nop 0
    buffer_load_dwordx4 v4, s[16:19], s3 offen sc1 lds
    v_pk_mul_f32 v[16:17], v[192:193], v[200:201]
    v_pk_mul_f32 v[18:19], v[194:195], v[202:203]
    v_pk_mul_f32 v[20:21], v[196:197], v[204:205]
    v_pk_mul_f32 v[22:23], v[198:199], v[206:207]
    v_pk_fma_f32 v[8:9], v[8:9], v[38:39], v[38:39] op_sel_hi:[1,0,0]
    v_pk_fma_f32 v[10:11], v[10:11], v[38:39], v[38:39] op_sel_hi:[1,0,0]
    v_pk_fma_f32 v[12:13], v[12:13], v[38:39], v[38:39] op_sel_hi:[1,0,0]
    v_pk_fma_f32 v[14:15], v[14:15], v[38:39], v[38:39] op_sel_hi:[1,0,0]
    v_rcp_f32 v8, v8
    v_rcp_f32 v9, v9
    v_rcp_f32 v10, v10
    v_rcp_f32 v11, v11
    v_rcp_f32_e64 v12, v12
    s_add_u32 m0, s83, 48128
    v_rcp_f32 v13, v13
    v_rcp_f32 v14, v14
    buffer_load_dwordx4 v4, s[16:19], s3 offen offset:1024 sc1 lds
    v_rcp_f32_e64 v15, v15
    v_pk_mul_f32 v[8:9], v[8:9], v[16:17]
    v_pk_mul_f32 v[10:11], v[10:11], v[18:19]
    v_pk_mul_f32 v[12:13], v[12:13], v[20:21]
    v_pk_mul_f32 v[14:15], v[14:15], v[22:23]
    v_cvt_pk_bf16_f32 v28, v8, v9
    v_cvt_pk_bf16_f32 v29, v10, v11
    v_cvt_pk_bf16_f32 v30, v12, v13
    v_cvt_pk_bf16_f32 v31, v14, v15
    buffer_store_dwordx4 v[28:31], v56, s[16:19], s55 offen sc1
    v_pk_mul_f32 v[8:9], v[208:209], v[208:209]
    v_pk_mul_f32 v[10:11], v[210:211], v[210:211]
    v_pk_mul_f32 v[12:13], v[212:213], v[212:213]
    v_pk_mul_f32 v[14:15], v[214:215], v[214:215]
    v_pk_fma_f32 v[8:9], v[40:41], v[8:9], v[40:41] op_sel:[1,0,0] op_sel_hi:[1,1,0]
    v_pk_fma_f32 v[10:11], v[40:41], v[10:11], v[40:41] op_sel:[1,0,0] op_sel_hi:[1,1,0]
    v_pk_fma_f32 v[12:13], v[40:41], v[12:13], v[40:41] op_sel:[1,0,0] op_sel_hi:[1,1,0]
    v_pk_fma_f32 v[14:15], v[40:41], v[14:15], v[40:41] op_sel:[1,0,0] op_sel_hi:[1,1,0]
    v_pk_mul_f32 v[8:9], v[8:9], v[208:209]
    v_pk_mul_f32 v[10:11], v[10:11], v[210:211]
    s_add_u32 m0, s83, 55296
    v_pk_mul_f32 v[12:13], v[12:13], v[212:213]
    v_pk_mul_f32 v[14:15], v[14:15], v[214:215]
    buffer_load_dwordx4 v4, s[16:19], s3 offen offset:2048 sc1 lds
    v_exp_f32 v8, v8
    v_exp_f32 v9, v9
    v_exp_f32 v10, v10
    v_exp_f32 v11, v11
    v_exp_f32 v12, v12
    v_exp_f32 v13, v13
    v_exp_f32 v14, v14
    v_exp_f32 v15, v15
    v_pk_mul_f32 v[16:17], v[208:209], v[216:217]
    v_pk_mul_f32 v[18:19], v[210:211], v[218:219]
    v_pk_mul_f32 v[20:21], v[212:213], v[220:221]
    v_pk_mul_f32 v[22:23], v[214:215], v[222:223]
    s_add_u32 m0, s83, 62464
    v_pk_fma_f32 v[8:9], v[8:9], v[42:43], v[42:43] op_sel_hi:[1,0,0]
    v_pk_fma_f32 v[10:11], v[10:11], v[42:43], v[42:43] op_sel_hi:[1,0,0]
    buffer_load_dwordx4 v4, s[16:19], s3 offen offset:3072 sc1 lds
    v_pk_fma_f32 v[12:13], v[12:13], v[42:43], v[42:43] op_sel_hi:[1,0,0]
    v_pk_fma_f32 v[14:15], v[14:15], v[42:43], v[42:43] op_sel_hi:[1,0,0]
    v_rcp_f32 v8, v8
    v_rcp_f32 v9, v9
    v_rcp_f32 v10, v10
    v_rcp_f32 v11, v11
    v_rcp_f32 v12, v12
    v_rcp_f32 v13, v13
    v_rcp_f32 v14, v14
    v_rcp_f32 v15, v15
    v_pk_mul_f32 v[8:9], v[8:9], v[16:17]
    v_pk_mul_f32 v[10:11], v[10:11], v[18:19]
    s_add_u32 m0, s83, 73728
    v_pk_mul_f32 v[12:13], v[12:13], v[20:21]
    v_pk_mul_f32 v[14:15], v[14:15], v[22:23]
    buffer_load_dwordx4 v5, s[16:19], s3 offen sc1 lds
    v_cvt_pk_bf16_f32 v24, v8, v9
    v_cvt_pk_bf16_f32 v25, v10, v11
    v_cvt_pk_bf16_f32 v26, v12, v13
    v_cvt_pk_bf16_f32 v27, v14, v15
    buffer_store_dwordx4 v[24:27], v56, s[16:19], s56 offen sc1
    v_pk_mul_f32 v[8:9], v[224:225], v[224:225]
    v_pk_mul_f32 v[10:11], v[226:227], v[226:227]
    v_pk_mul_f32 v[12:13], v[228:229], v[228:229]
    v_pk_mul_f32 v[14:15], v[230:231], v[230:231]
    v_pk_fma_f32 v[8:9], v[44:45], v[8:9], v[44:45] op_sel:[1,0,0] op_sel_hi:[1,1,0]
    v_pk_fma_f32 v[10:11], v[44:45], v[10:11], v[44:45] op_sel:[1,0,0] op_sel_hi:[1,1,0]
    v_pk_fma_f32 v[12:13], v[44:45], v[12:13], v[44:45] op_sel:[1,0,0] op_sel_hi:[1,1,0]
    v_pk_fma_f32 v[14:15], v[44:45], v[14:15], v[44:45] op_sel:[1,0,0] op_sel_hi:[1,1,0]
    v_pk_mul_f32 v[8:9], v[8:9], v[224:225]
    v_pk_mul_f32 v[10:11], v[10:11], v[226:227]
    v_pk_mul_f32 v[12:13], v[12:13], v[228:229]
    v_pk_mul_f32 v[14:15], v[14:15], v[230:231]
    v_exp_f32 v8, v8
    v_exp_f32 v9, v9
    v_exp_f32 v10, v10
    v_exp_f32 v11, v11
    v_exp_f32 v12, v12
    v_exp_f32 v13, v13
    v_exp_f32 v14, v14
    v_exp_f32 v15, v15
    v_pk_mul_f32 v[16:17], v[224:225], v[232:233]
    v_pk_mul_f32 v[18:19], v[226:227], v[234:235]
    v_pk_mul_f32 v[20:21], v[228:229], v[236:237]
    v_pk_mul_f32 v[22:23], v[230:231], v[238:239]
    v_pk_fma_f32 v[8:9], v[8:9], v[46:47], v[46:47] op_sel_hi:[1,0,0]
    v_pk_fma_f32 v[10:11], v[10:11], v[46:47], v[46:47] op_sel_hi:[1,0,0]
    v_pk_fma_f32 v[12:13], v[12:13], v[46:47], v[46:47] op_sel_hi:[1,0,0]
    v_pk_fma_f32 v[14:15], v[14:15], v[46:47], v[46:47] op_sel_hi:[1,0,0]
    v_rcp_f32 v8, v8
    v_rcp_f32 v9, v9
    v_rcp_f32 v10, v10
    v_rcp_f32 v11, v11
    v_rcp_f32 v12, v12
    v_rcp_f32 v13, v13
    v_rcp_f32 v14, v14
    v_rcp_f32 v15, v15
    v_pk_mul_f32 v[8:9], v[8:9], v[16:17]
    v_pk_mul_f32 v[10:11], v[10:11], v[18:19]
    v_pk_mul_f32 v[12:13], v[12:13], v[20:21]
    v_pk_mul_f32 v[14:15], v[14:15], v[22:23]
    v_cvt_pk_bf16_f32 v28, v8, v9
    v_cvt_pk_bf16_f32 v29, v10, v11
    v_cvt_pk_bf16_f32 v30, v12, v13
    v_cvt_pk_bf16_f32 v31, v14, v15
    buffer_store_dwordx4 v[28:31], v56, s[16:19], s57 offen sc1
    s_setprio 0
    s_mov_b32 s92, 0
    s_cmp_lg_u32 s92, 0
    s_cbranch_scc1 L_pb55
    s_waitcnt vmcnt(0)
    s_mov_b32 s92, 1
    v_mov_b32 v253, 1
    s_mov_b64 exec, 1
    ds_add_rtn_u32 v253, v4, v253 offset:4612
    s_mov_b64 exec, -1
    s_waitcnt lgkmcnt(0)
    v_readfirstlane_b32 s88, v253
    v_mov_b32 v253, 1
    s_cmp_lg_u32 s88, 7
    s_cbranch_scc1 L_pb55
    buffer_store_dword v253, v2, s[16:19], s87 offen sc1
L_pb55:
    s_lshl2_add_u32 s3, s46, s98
    s_add_u32 s3, s3, s46
    buffer_load_dwordx4 v[128:131], v4, s[16:19], s3 offen sc1
    buffer_load_dwordx4 v[132:135], v4, s[16:19], s3 offen offset:1024 sc1
    s_mov_b32 exec_lo, 0
    buffer_load_dword v58, v6, s[16:19], 0 offen sc1
    s_mov_b64 exec, -1
    buffer_load_dwordx4 v[136:139], v4, s[16:19], s3 offen offset:2048 sc1
    buffer_load_dwordx4 v[140:143], v4, s[16:19], s3 offen offset:3072 sc1
    buffer_load_dwordx4 v[144:147], v5, s[16:19], s3 offen sc1
    s_lshl2_add_u32 s3, s50, s98
    s_add_u32 s3, s3, s50
    buffer_load_dwordx4 v[148:151], v4, s[16:19], s3 offen sc1
    buffer_load_dwordx4 v[152:155], v4, s[16:19], s3 offen offset:1024 sc1
    buffer_load_dwordx4 v[156:159], v4, s[16:19], s3 offen offset:2048 sc1
    buffer_load_dwordx4 v[160:163], v4, s[16:19], s3 offen offset:3072 sc1
    buffer_load_dwordx4 v[164:167], v5, s[16:19], s3 offen sc1
    s_lshl2_add_u32 s3, s51, s98
    s_add_u32 s3, s3, s51
    s_add_u32 m0, s83, 7168
    s_nop 0
    buffer_load_dwordx4 v4, s[16:19], s3 offen offset:1024 sc1 lds
    s_add_u32 m0, s83, 14336
    s_nop 0
    buffer_load_dwordx4 v4, s[16:19], s3 offen offset:2048 sc1 lds
    s_add_u32 m0, s83, 21504
    s_nop 0
    buffer_load_dwordx4 v4, s[16:19], s3 offen offset:3072 sc1 lds
    s_add_u32 m0, s83, 32768
    s_nop 0
    buffer_load_dwordx4 v5, s[16:19], s3 offen sc1 lds
    s_lshl2_add_u32 s3, s63, s98
    s_add_u32 s3, s3, s63
    buffer_load_dwordx4 v[8:11], v4, s[16:19], s3 offen sc1
    buffer_load_dwordx4 v[12:15], v4, s[16:19], s3 offen offset:1024 sc1
    buffer_load_dwordx4 v[16:19], v4, s[16:19], s3 offen offset:2048 sc1
    s_mov_b32 exec_lo, 0
    buffer_load_dword v3, v6, s[16:19], 0 offen sc1
    s_mov_b64 exec, -1
    buffer_load_dwordx4 v[20:23], v4, s[16:19], s3 offen offset:3072 sc1
    buffer_load_dwordx4 v[24:27], v5, s[16:19], s3 offen sc1
    s_cmp_lg_u32 s68, 0
    s_cbranch_scc1 L_fs51
    s_waitcnt vmcnt(18)
    v_cmp_eq_u32 vcc, 1, v58
    s_nop 0
    s_and_b32 s88, vcc_hi, 0x1f
    s_cmp_eq_u32 s88, 0x1f
    s_cbranch_scc1 L_fw53
    s_waitcnt vmcnt(2)
    v_cmp_eq_u32_e64 vcc, 1, v3
    s_nop 0
    s_and_b32 s88, vcc_hi, 31
    s_cmp_eq_u32 s88, 31
    s_cbranch_scc1 L_fw53
    s_mov_b32 exec_lo, 0
L_fp50:
    buffer_load_dword v3, v6, s[16:19], 0 offen sc1
    s_waitcnt vmcnt(0)
    v_cmp_eq_u32 vcc, 1, v3
    s_nop 0
    s_and_b32 s88, vcc_hi, 31
    s_cmp_eq_u32 s88, 31
    s_cbranch_scc1 L_fw53
    s_sub_u32 s99, s99, 1
    s_cmp_gt_i32 s99, 0
    s_cbranch_scc1 L_fp50
L_fw53:
    s_mov_b64 exec, -1
    v_and_b32 v255, 7, v1
    v_lshlrev_b32 v255, 10, v255
    v_mov_b32_e64 v254, 1
    ds_write_b32 v255, v254 offset:512
    s_waitcnt lgkmcnt(0)
    s_branch L_fq52
L_fs51:
    v_mov_b32_e64 v255, s83
L_ft54:
    ds_read_b32 v254, v255 offset:512
    s_waitcnt lgkmcnt(0)
    v_readfirstlane_b32 s88, v254
    s_nop 0
    s_cmp_ge_u32 s88, 1
    s_cbranch_scc1 L_fq52
    s_sub_u32 s99, s99, 1
    s_cmp_gt_i32 s99, 0
    s_cbranch_scc1 L_ft54
L_fq52:
    s_branch L_p2
L_p2:
    s_and_b32 s88, s72, 7
    s_lshl_b32 s88, s88, 9
    s_add_u32 s88, s88, s97
    s_add_u32 s88, s88, 124
    s_add_u32 s4, s66, s88
    s_addc_u32 s5, s67, 0
    s_cmp_ge_u32 s68, 4
    s_movk_i32 s89, 0x4000
    s_cselect_b32 s89, 0xffffc000, s89
    s_add_u32 s88, s88, s89
    s_add_u32 s6, s66, s88
    s_addc_u32 s7, s67, 0
    s_lshl2_add_u32 s1, s36, s97
    buffer_load_dwordx4 v[32:35], v4, s[16:19], s1 offen sc1
    buffer_load_dwordx4 v[36:39], v4, s[16:19], s1 offen offset:1024 sc1
    buffer_load_dwordx4 v[40:43], v4, s[16:19], s1 offen offset:2048 sc1
    buffer_load_dwordx4 v[44:47], v4, s[16:19], s1 offen offset:3072 sc1
    s_lshl2_add_u32 s1, s37, s97
    buffer_load_dwordx4 v[48:51], v4, s[16:19], s1 offen sc1
    buffer_load_dwordx4 v[52:55], v4, s[16:19], s1 offen offset:1024 sc1
    buffer_load_dwordx4 v[56:59], v4, s[16:19], s1 offen offset:2048 sc1
    buffer_load_dwordx4 v[60:63], v4, s[16:19], s1 offen offset:3072 sc1
    s_lshl2_add_u32 s1, s42, s97
    buffer_load_dwordx4 v[28:31], v4, s[16:19], s1 offen sc1
    buffer_load_dwordx4 v[64:67], v4, s[16:19], s1 offen offset:1024 sc1
    buffer_load_dwordx4 v[168:171], v4, s[16:19], s1 offen offset:2048 sc1
    buffer_load_dwordx4 v[172:175], v4, s[16:19], s1 offen offset:3072 sc1
    s_waitcnt vmcnt(11)
    v_mfma_f32_16x16x32_bf16 v[176:179], v[68:71], v[32:35], 0
    v_mfma_f32_16x16x32_bf16 v[192:195], v[72:75], v[32:35], 0
    v_mfma_f32_16x16x32_bf16 v[208:211], v[76:79], v[32:35], 0
    v_mfma_f32_16x16x32_bf16 v[224:227], v[80:83], v[32:35], 0
    v_mfma_f32_16x16x32_bf16 v[240:243], v[84:87], v[32:35], 0
    s_lshl2_add_u32 s1, s43, s97
    buffer_load_dwordx4 v[32:35], v4, s[16:19], s1 offen sc1
    s_waitcnt vmcnt(11)
    v_mfma_f32_16x16x32_bf16 v[180:183], v[36:39], v[68:71], 0
    v_mfma_f32_16x16x32_bf16 v[196:199], v[36:39], v[72:75], 0
    v_mfma_f32_16x16x32_bf16 v[212:215], v[36:39], v[76:79], 0
    v_mfma_f32_16x16x32_bf16 v[228:231], v[36:39], v[80:83], 0
    v_mfma_f32_16x16x32_bf16 v[244:247], v[36:39], v[84:87], 0
    buffer_load_dwordx4 v[36:39], v4, s[16:19], s1 offen offset:1024 sc1
    s_waitcnt vmcnt(11)
    v_mfma_f32_16x16x32_bf16 v[184:187], v[40:43], v[68:71], 0
    v_mfma_f32_16x16x32_bf16 v[200:203], v[40:43], v[72:75], 0
    v_mfma_f32_16x16x32_bf16 v[216:219], v[40:43], v[76:79], 0
    v_mfma_f32_16x16x32_bf16 v[232:235], v[40:43], v[80:83], 0
    v_mfma_f32_16x16x32_bf16 v[248:251], v[40:43], v[84:87], 0
    buffer_load_dwordx4 v[40:43], v4, s[16:19], s1 offen offset:2048 sc1
    s_waitcnt vmcnt(11)
    s_mov_b32 s88, 81920
    v_lshl_add_u32 v2, v0, 4, s88
    v_mfma_f32_16x16x32_bf16 v[188:191], v[44:47], v[68:71], 0
    ds_read_b128 v[68:71], v2 offset:0
    v_mfma_f32_16x16x32_bf16 v[204:207], v[44:47], v[72:75], 0
    ds_read_b128 v[72:75], v2 offset:8192
    v_mfma_f32_16x16x32_bf16 v[220:223], v[44:47], v[76:79], 0
    ds_read_b128 v[76:79], v2 offset:16384
    v_mfma_f32_16x16x32_bf16 v[236:239], v[44:47], v[80:83], 0
    ds_read_b128 v[80:83], v2 offset:24576
    v_mfma_f32_16x16x32_bf16 v[252:255], v[44:47], v[84:87], 0
    ds_read_b128 v[84:87], v2 offset:32768
    buffer_load_dwordx4 v[44:47], v4, s[16:19], s1 offen offset:3072 sc1
    s_waitcnt vmcnt(11)
    v_mfma_f32_16x16x32_bf16 v[176:179], v[88:91], v[48:51], v[176:179]
    v_mfma_f32_16x16x32_bf16 v[192:195], v[92:95], v[48:51], v[192:195]
    v_mfma_f32_16x16x32_bf16 v[208:211], v[96:99], v[48:51], v[208:211]
    v_mfma_f32_16x16x32_bf16 v[224:227], v[100:103], v[48:51], v[224:227]
    v_mfma_f32_16x16x32_bf16 v[240:243], v[104:107], v[48:51], v[240:243]
    s_lshl2_add_u32 s1, s44, s97
    buffer_load_dwordx4 v[48:51], v4, s[16:19], s1 offen sc1
    s_waitcnt vmcnt(11)
    v_mfma_f32_16x16x32_bf16 v[180:183], v[52:55], v[88:91], v[180:183]
    v_mfma_f32_16x16x32_bf16 v[196:199], v[52:55], v[92:95], v[196:199]
    v_mfma_f32_16x16x32_bf16 v[212:215], v[52:55], v[96:99], v[212:215]
    v_mfma_f32_16x16x32_bf16 v[228:231], v[52:55], v[100:103], v[228:231]
    v_mfma_f32_16x16x32_bf16 v[244:247], v[52:55], v[104:107], v[244:247]
    buffer_load_dwordx4 v[52:55], v4, s[16:19], s1 offen offset:1024 sc1
    s_waitcnt vmcnt(11)
    v_mfma_f32_16x16x32_bf16 v[184:187], v[56:59], v[88:91], v[184:187]
    v_mfma_f32_16x16x32_bf16 v[200:203], v[56:59], v[92:95], v[200:203]
    v_mfma_f32_16x16x32_bf16 v[216:219], v[56:59], v[96:99], v[216:219]
    v_mfma_f32_16x16x32_bf16 v[232:235], v[56:59], v[100:103], v[232:235]
    v_mfma_f32_16x16x32_bf16 v[248:251], v[56:59], v[104:107], v[248:251]
    buffer_load_dwordx4 v[56:59], v4, s[16:19], s1 offen offset:2048 sc1
    s_waitcnt vmcnt(11)
    s_mov_b32 s88, 122880
    v_lshl_add_u32 v2, v0, 4, s88
    v_mfma_f32_16x16x32_bf16 v[188:191], v[60:63], v[88:91], v[188:191]
    ds_read_b128 v[88:91], v2 offset:0
    v_mfma_f32_16x16x32_bf16 v[204:207], v[60:63], v[92:95], v[204:207]
    ds_read_b128 v[92:95], v2 offset:8192
    v_mfma_f32_16x16x32_bf16 v[220:223], v[60:63], v[96:99], v[220:223]
    ds_read_b128 v[96:99], v2 offset:16384
    v_mfma_f32_16x16x32_bf16 v[236:239], v[60:63], v[100:103], v[236:239]
    ds_read_b128 v[100:103], v2 offset:24576
    v_mfma_f32_16x16x32_bf16 v[252:255], v[60:63], v[104:107], v[252:255]
    ds_read_b128 v[104:107], v2 offset:32768
    buffer_load_dwordx4 v[60:63], v4, s[16:19], s1 offen offset:3072 sc1
    s_waitcnt vmcnt(11)
    v_mfma_f32_16x16x32_bf16 v[176:179], v[108:111], v[28:31], v[176:179]
    v_mfma_f32_16x16x32_bf16 v[192:195], v[112:115], v[28:31], v[192:195]
    v_mfma_f32_16x16x32_bf16 v[208:211], v[116:119], v[28:31], v[208:211]
    v_mfma_f32_16x16x32_bf16 v[224:227], v[120:123], v[28:31], v[224:227]
    v_mfma_f32_16x16x32_bf16 v[240:243], v[124:127], v[28:31], v[240:243]
    s_waitcnt vmcnt(10)
    v_mfma_f32_16x16x32_bf16 v[180:183], v[64:67], v[108:111], v[180:183]
    v_mfma_f32_16x16x32_bf16 v[196:199], v[64:67], v[112:115], v[196:199]
    v_mfma_f32_16x16x32_bf16 v[212:215], v[64:67], v[116:119], v[212:215]
    v_mfma_f32_16x16x32_bf16 v[228:231], v[64:67], v[120:123], v[228:231]
    v_mfma_f32_16x16x32_bf16 v[244:247], v[64:67], v[124:127], v[244:247]
    s_waitcnt vmcnt(9)
    v_mfma_f32_16x16x32_bf16 v[184:187], v[168:171], v[108:111], v[184:187]
    v_mfma_f32_16x16x32_bf16 v[200:203], v[168:171], v[112:115], v[200:203]
    v_mfma_f32_16x16x32_bf16 v[216:219], v[168:171], v[116:119], v[216:219]
    v_mfma_f32_16x16x32_bf16 v[232:235], v[168:171], v[120:123], v[232:235]
    v_mfma_f32_16x16x32_bf16 v[248:251], v[168:171], v[124:127], v[248:251]
    s_waitcnt vmcnt(8)
    s_mov_b32 s88, 40960
    v_lshl_add_u32 v2, v0, 4, s88
    v_mfma_f32_16x16x32_bf16 v[188:191], v[172:175], v[108:111], v[188:191]
    ds_read_b128 v[108:111], v2 offset:0
    v_mfma_f32_16x16x32_bf16 v[204:207], v[172:175], v[112:115], v[204:207]
    ds_read_b128 v[112:115], v2 offset:8192
    v_mfma_f32_16x16x32_bf16 v[220:223], v[172:175], v[116:119], v[220:223]
    ds_read_b128 v[116:119], v2 offset:16384
    v_mfma_f32_16x16x32_bf16 v[236:239], v[172:175], v[120:123], v[236:239]
    ds_read_b128 v[120:123], v2 offset:24576
    v_mfma_f32_16x16x32_bf16 v[252:255], v[172:175], v[124:127], v[252:255]
    ds_read_b128 v[124:127], v2 offset:32768
    s_waitcnt vmcnt(7)
    s_waitcnt lgkmcnt(10)
    s_mov_b32 exec_hi, 0
    buffer_load_dword v3, v6, s[16:19], 0 offen sc1
    s_mov_b64 exec, -1
    v_mfma_f32_16x16x32_bf16 v[176:179], v[68:71], v[32:35], v[176:179]
    v_mfma_f32_16x16x32_bf16 v[192:195], v[72:75], v[32:35], v[192:195]
    v_mfma_f32_16x16x32_bf16 v[208:211], v[76:79], v[32:35], v[208:211]
    v_mfma_f32_16x16x32_bf16 v[224:227], v[80:83], v[32:35], v[224:227]
    v_mfma_f32_16x16x32_bf16 v[240:243], v[84:87], v[32:35], v[240:243]
    s_waitcnt vmcnt(7)
    v_mfma_f32_16x16x32_bf16 v[180:183], v[36:39], v[68:71], v[180:183]
    v_mfma_f32_16x16x32_bf16 v[196:199], v[36:39], v[72:75], v[196:199]
    v_mfma_f32_16x16x32_bf16 v[212:215], v[36:39], v[76:79], v[212:215]
    v_mfma_f32_16x16x32_bf16 v[228:231], v[36:39], v[80:83], v[228:231]
    v_mfma_f32_16x16x32_bf16 v[244:247], v[36:39], v[84:87], v[244:247]
    s_waitcnt vmcnt(6)
    v_mfma_f32_16x16x32_bf16 v[184:187], v[40:43], v[68:71], v[184:187]
    v_mfma_f32_16x16x32_bf16 v[200:203], v[40:43], v[72:75], v[200:203]
    v_mfma_f32_16x16x32_bf16 v[216:219], v[40:43], v[76:79], v[216:219]
    v_mfma_f32_16x16x32_bf16 v[232:235], v[40:43], v[80:83], v[232:235]
    v_mfma_f32_16x16x32_bf16 v[248:251], v[40:43], v[84:87], v[248:251]
    s_waitcnt vmcnt(5)
    v_mfma_f32_16x16x32_bf16 v[188:191], v[44:47], v[68:71], v[188:191]
    v_mfma_f32_16x16x32_bf16 v[204:207], v[44:47], v[72:75], v[204:207]
    v_mfma_f32_16x16x32_bf16 v[220:223], v[44:47], v[76:79], v[220:223]
    v_mfma_f32_16x16x32_bf16 v[236:239], v[44:47], v[80:83], v[236:239]
    v_mfma_f32_16x16x32_bf16 v[252:255], v[44:47], v[84:87], v[252:255]
    s_waitcnt vmcnt(4)
    s_waitcnt lgkmcnt(5)
    v_mfma_f32_16x16x32_bf16 v[176:179], v[88:91], v[48:51], v[176:179]
    v_mfma_f32_16x16x32_bf16 v[192:195], v[92:95], v[48:51], v[192:195]
    v_mfma_f32_16x16x32_bf16 v[208:211], v[96:99], v[48:51], v[208:211]
    v_mfma_f32_16x16x32_bf16 v[224:227], v[100:103], v[48:51], v[224:227]
    v_mfma_f32_16x16x32_bf16 v[240:243], v[104:107], v[48:51], v[240:243]
    s_waitcnt vmcnt(3)
    v_mfma_f32_16x16x32_bf16 v[180:183], v[52:55], v[88:91], v[180:183]
    s_lshl2_add_u32 s3, s84, s98
    s_add_u32 s3, s3, s84
    buffer_load_dwordx4 v[68:71], v4, s[16:19], s3 offen sc1
    v_mfma_f32_16x16x32_bf16 v[196:199], v[52:55], v[92:95], v[196:199]
    v_mfma_f32_16x16x32_bf16 v[212:215], v[52:55], v[96:99], v[212:215]
    v_mfma_f32_16x16x32_bf16 v[228:231], v[52:55], v[100:103], v[228:231]
    v_mfma_f32_16x16x32_bf16 v[244:247], v[52:55], v[104:107], v[244:247]
    s_waitcnt vmcnt(3)
    v_mfma_f32_16x16x32_bf16 v[184:187], v[56:59], v[88:91], v[184:187]
    v_mfma_f32_16x16x32_bf16 v[200:203], v[56:59], v[92:95], v[200:203]
    v_mfma_f32_16x16x32_bf16 v[216:219], v[56:59], v[96:99], v[216:219]
    v_mfma_f32_16x16x32_bf16 v[232:235], v[56:59], v[100:103], v[232:235]
    v_mfma_f32_16x16x32_bf16 v[248:251], v[56:59], v[104:107], v[248:251]
    s_waitcnt vmcnt(2)
    v_mfma_f32_16x16x32_bf16 v[188:191], v[60:63], v[88:91], v[188:191]
    buffer_load_dwordx4 v[72:75], v4, s[16:19], s3 offen offset:1024 sc1
    v_mfma_f32_16x16x32_bf16 v[204:207], v[60:63], v[92:95], v[204:207]
    v_mfma_f32_16x16x32_bf16 v[220:223], v[60:63], v[96:99], v[220:223]
    v_mfma_f32_16x16x32_bf16 v[236:239], v[60:63], v[100:103], v[236:239]
    v_mfma_f32_16x16x32_bf16 v[252:255], v[60:63], v[104:107], v[252:255]
    s_cmp_lg_u32 s68, 0
    s_cbranch_scc1 L_fs57
    s_waitcnt vmcnt(2)
    v_mov_b32 v2, 0
    ds_read_b32 v2, v2 offset:4612
    v_cmp_eq_u32_e64 vcc, 1, v3
    s_waitcnt lgkmcnt(0)
    v_readfirstlane_b32 s89, v2
    s_and_b32 s88, vcc_lo, 0x7ffffff
    s_lshl_b32 s89, s89, 24
    s_add_u32 s88, s88, s89
    s_cmp_eq_u32 s88, 0xfffffff
    s_cbranch_scc1 L_fw59
    s_mov_b32 exec_hi, 0
L_fp56:
    buffer_load_dword v3, v6, s[16:19], 0 offen sc1
    s_waitcnt vmcnt(0)
    s_mov_b64 exec, -1
    v_mov_b32_e64 v2, 0
    ds_read_b32 v2, v2 offset:4612
    v_cmp_eq_u32_e64 vcc, 1, v3
    s_waitcnt lgkmcnt(0)
    v_readfirstlane_b32 s89, v2
    s_and_b32 s88, vcc_lo, 0x7ffffff
    s_lshl_b32 s89, s89, 24
    s_add_u32 s88, s88, s89
    s_cmp_eq_u32 s88, 0xfffffff
    s_mov_b32 exec_hi, 0
    s_cbranch_scc1 L_fw59
    s_sub_u32 s99, s99, 1
    s_cmp_gt_i32 s99, 0
    s_cbranch_scc1 L_fp56
L_fw59:
    s_mov_b64 exec, -1
    v_and_b32 v2, 7, v1
    v_lshlrev_b32 v2, 10, v2
    v_mov_b32_e64 v3, 2
    ds_write_b32 v2, v3 offset:512
    s_waitcnt lgkmcnt(0)
    s_branch L_fq58
L_fs57:
    v_mov_b32 v2, s83
    s_waitcnt vmcnt(2)
L_ft60:
    ds_read_b32 v3, v2 offset:512
    s_waitcnt lgkmcnt(0)
    v_readfirstlane_b32 s88, v3
    s_nop 0
    s_cmp_ge_u32 s88, 2
    s_cbranch_scc1 L_fq58
    s_sub_u32 s99, s99, 1
    s_cmp_gt_i32 s99, 0
    s_cbranch_scc1 L_ft60
L_fq58:
    s_lshl2_add_u32 s1, s45, s97
    buffer_load_dwordx4 v[28:31], v4, s[16:19], s1 offen sc1
    buffer_load_dwordx4 v[64:67], v4, s[16:19], s1 offen offset:1024 sc1
    buffer_load_dwordx4 v[168:171], v4, s[16:19], s1 offen offset:2048 sc1
    buffer_load_dwordx4 v[172:175], v4, s[16:19], s1 offen offset:3072 sc1
    s_lshl2_add_u32 s3, s51, s98
    s_add_u32 s3, s3, s51
    s_add_u32 m0, s83, 0
    s_nop 0
    buffer_load_dwordx4 v4, s[16:19], s3 offen sc1 lds
    s_lshl2_add_u32 s1, s46, s97
    buffer_load_dwordx4 v[32:35], v4, s[16:19], s1 offen sc1
    buffer_load_dwordx4 v[36:39], v4, s[16:19], s1 offen offset:1024 sc1
    buffer_load_dwordx4 v[40:43], v4, s[16:19], s1 offen offset:2048 sc1
    buffer_load_dwordx4 v[44:47], v4, s[16:19], s1 offen offset:3072 sc1
    s_lshl2_add_u32 s1, s50, s97
    buffer_load_dwordx4 v[48:51], v4, s[16:19], s1 offen sc1
    buffer_load_dwordx4 v[52:55], v4, s[16:19], s1 offen offset:1024 sc1
    buffer_load_dwordx4 v[56:59], v4, s[16:19], s1 offen offset:2048 sc1
    buffer_load_dwordx4 v[60:63], v4, s[16:19], s1 offen offset:3072 sc1
    s_waitcnt vmcnt(12)
    s_waitcnt lgkmcnt(0)
    v_mfma_f32_16x16x32_bf16 v[176:179], v[108:111], v[28:31], v[176:179]
    v_mfma_f32_16x16x32_bf16 v[192:195], v[112:115], v[28:31], v[192:195]
    v_mfma_f32_16x16x32_bf16 v[208:211], v[116:119], v[28:31], v[208:211]
    v_mfma_f32_16x16x32_bf16 v[224:227], v[120:123], v[28:31], v[224:227]
    v_mfma_f32_16x16x32_bf16 v[240:243], v[124:127], v[28:31], v[240:243]
    s_lshl2_add_u32 s1, s51, s97
    buffer_load_dwordx4 v[28:31], v4, s[16:19], s1 offen sc1
    s_waitcnt vmcnt(12)
    v_mfma_f32_16x16x32_bf16 v[180:183], v[64:67], v[108:111], v[180:183]
    s_lshl2_add_u32 s3, s84, s98
    s_add_u32 s3, s3, s84
    buffer_load_dwordx4 v[76:79], v4, s[16:19], s3 offen offset:2048 sc1
    v_mfma_f32_16x16x32_bf16 v[196:199], v[64:67], v[112:115], v[196:199]
    v_mfma_f32_16x16x32_bf16 v[212:215], v[64:67], v[116:119], v[212:215]
    v_mfma_f32_16x16x32_bf16 v[228:231], v[64:67], v[120:123], v[228:231]
    v_mfma_f32_16x16x32_bf16 v[244:247], v[64:67], v[124:127], v[244:247]
    buffer_load_dwordx4 v[64:67], v4, s[16:19], s1 offen offset:1024 sc1
    s_waitcnt vmcnt(13)
    v_mfma_f32_16x16x32_bf16 v[184:187], v[168:171], v[108:111], v[184:187]
    v_mfma_f32_16x16x32_bf16 v[200:203], v[168:171], v[112:115], v[200:203]
    v_mfma_f32_16x16x32_bf16 v[216:219], v[168:171], v[116:119], v[216:219]
    v_mfma_f32_16x16x32_bf16 v[232:235], v[168:171], v[120:123], v[232:235]
    v_mfma_f32_16x16x32_bf16 v[248:251], v[168:171], v[124:127], v[248:251]
    buffer_load_dwordx4 v[168:171], v4, s[16:19], s1 offen offset:2048 sc1
    s_waitcnt vmcnt(13)
    v_mfma_f32_16x16x32_bf16 v[188:191], v[172:175], v[108:111], v[188:191]
    buffer_load_dwordx4 v[80:83], v4, s[16:19], s3 offen offset:3072 sc1
    v_mfma_f32_16x16x32_bf16 v[204:207], v[172:175], v[112:115], v[204:207]
    v_mfma_f32_16x16x32_bf16 v[220:223], v[172:175], v[116:119], v[220:223]
    v_mfma_f32_16x16x32_bf16 v[236:239], v[172:175], v[120:123], v[236:239]
    v_mfma_f32_16x16x32_bf16 v[252:255], v[172:175], v[124:127], v[252:255]
    buffer_load_dwordx4 v[172:175], v4, s[16:19], s1 offen offset:3072 sc1
    s_waitcnt vmcnt(13)
    v_mfma_f32_16x16x32_bf16 v[176:179], v[128:131], v[32:35], v[176:179]
    v_mfma_f32_16x16x32_bf16 v[192:195], v[132:135], v[32:35], v[192:195]
    v_mfma_f32_16x16x32_bf16 v[208:211], v[136:139], v[32:35], v[208:211]
    v_mfma_f32_16x16x32_bf16 v[224:227], v[140:143], v[32:35], v[224:227]
    v_mfma_f32_16x16x32_bf16 v[240:243], v[144:147], v[32:35], v[240:243]
    s_lshl2_add_u32 s1, s63, s97
    buffer_load_dwordx4 v[32:35], v4, s[16:19], s1 offen sc1
    s_waitcnt vmcnt(13)
    v_mfma_f32_16x16x32_bf16 v[180:183], v[36:39], v[128:131], v[180:183]
    buffer_load_dwordx4 v[84:87], v5, s[16:19], s3 offen sc1
    v_mfma_f32_16x16x32_bf16 v[196:199], v[36:39], v[132:135], v[196:199]
    v_mfma_f32_16x16x32_bf16 v[212:215], v[36:39], v[136:139], v[212:215]
    v_mfma_f32_16x16x32_bf16 v[228:231], v[36:39], v[140:143], v[228:231]
    v_mfma_f32_16x16x32_bf16 v[244:247], v[36:39], v[144:147], v[244:247]
    buffer_load_dwordx4 v[36:39], v4, s[16:19], s1 offen offset:1024 sc1
    s_waitcnt vmcnt(14)
    v_mfma_f32_16x16x32_bf16 v[184:187], v[40:43], v[128:131], v[184:187]
    v_mfma_f32_16x16x32_bf16 v[200:203], v[40:43], v[132:135], v[200:203]
    v_mfma_f32_16x16x32_bf16 v[216:219], v[40:43], v[136:139], v[216:219]
    v_mfma_f32_16x16x32_bf16 v[232:235], v[40:43], v[140:143], v[232:235]
    v_mfma_f32_16x16x32_bf16 v[248:251], v[40:43], v[144:147], v[248:251]
    buffer_load_dwordx4 v[40:43], v4, s[16:19], s1 offen offset:2048 sc1
    s_waitcnt vmcnt(14)
    v_mfma_f32_16x16x32_bf16 v[188:191], v[44:47], v[128:131], v[188:191]
    s_lshl2_add_u32 s3, s85, s98
    s_add_u32 s3, s3, s85
    buffer_load_dwordx4 v[88:91], v4, s[16:19], s3 offen sc1
    v_mfma_f32_16x16x32_bf16 v[204:207], v[44:47], v[132:135], v[204:207]
    v_mfma_f32_16x16x32_bf16 v[220:223], v[44:47], v[136:139], v[220:223]
    v_mfma_f32_16x16x32_bf16 v[236:239], v[44:47], v[140:143], v[236:239]
    v_mfma_f32_16x16x32_bf16 v[252:255], v[44:47], v[144:147], v[252:255]
    buffer_load_dwordx4 v[44:47], v4, s[16:19], s1 offen offset:3072 sc1
    s_cmp_lt_u32 s68, 4
    s_cbranch_scc1 L_pq
    s_setprio 1
L_pq:
    s_waitcnt vmcnt(15)
    v_mfma_f32_16x16x32_bf16 v[176:179], v[148:151], v[48:51], v[176:179]
    v_lshrrev_b32 v140, 1, v1
    v_and_b32 v140, 12, v140
    v_mfma_f32_16x16x32_bf16 v[192:195], v[152:155], v[48:51], v[192:195]
    v_lshrrev_b32_e64 v141, 5, v1
    v_bfe_u32 v142, v1, 2, 1
    v_mfma_f32_16x16x32_bf16 v[208:211], v[156:159], v[48:51], v[208:211]
    v_lshl_add_u32 v142, v141, 1, v142
    s_lshr_b32 s88, s68, 1
    s_lshl_b32 s88, s88, 3
    s_and_b32 s89, s68, 1
    s_add_u32 s88, s88, s89
    s_lshl_b32 s88, s88, 1
    v_add3_u32 v141, v140, v141, s88
    v_mfma_f32_16x16x32_bf16 v[224:227], v[160:163], v[48:51], v[224:227]
    s_lshl_b32 s88, s68, 4
    v_add3_u32 v142, v140, v142, s88
    v_and_b32_e64 v143, 7, v1
    v_mfma_f32_16x16x32_bf16 v[240:243], v[164:167], v[48:51], v[240:243]
    v_and_b32_e64 v144, 3, v1
    s_bfe_u32 s88, s60, 0x10005
    s_lshl_b32 s88, s88, 2
    s_lshl_b32 s89, s88, 2
    s_sub_u32 s89, 16, s89
    v_add_u32 v143, s88, v143
    v_add_u32 v144, s89, v144
    s_lshl2_add_u32 s1, s84, s97
    buffer_load_dwordx4 v[48:51], v4, s[16:19], s1 offen sc1
    s_waitcnt vmcnt(15)
    v_mfma_f32_16x16x32_bf16 v[180:183], v[52:55], v[148:151], v[180:183]
    buffer_load_dwordx4 v[92:95], v4, s[16:19], s3 offen offset:1024 sc1
    v_lshlrev_b32 v134, 2, v141
    v_lshlrev_b32_e64 v136, 2, v141
    v_mfma_f32_16x16x32_bf16 v[196:199], v[52:55], v[152:155], v[196:199]
    v_lshlrev_b32 v138, 2, v142
    v_lshlrev_b32 v135, 2, v143
    v_mfma_f32_16x16x32_bf16 v[212:215], v[52:55], v[156:159], v[212:215]
    v_lshlrev_b32 v139, 2, v144
    v_add_u32 v137, 32, v135
    v_mfma_f32_16x16x32_bf16 v[228:231], v[52:55], v[160:163], v[228:231]
    v_mul_u32_u24 v141, 0xa00, v141
    v_mul_u32_u24 v142, 0xa00, v142
    v_mfma_f32_16x16x32_bf16 v[244:247], v[52:55], v[164:167], v[244:247]
    v_lshl_add_u32 v129, v143, 4, v141
    v_lshl_add_u32 v133, v144, 4, v142
    buffer_load_dwordx4 v[52:55], v4, s[16:19], s1 offen offset:1024 sc1
    s_waitcnt vmcnt(16)
    v_mfma_f32_16x16x32_bf16 v[184:187], v[56:59], v[148:151], v[184:187]
    v_add_u32 v131, 0x80, v129
    v_lshrrev_b32 v140, 1, v129
    v_mfma_f32_16x16x32_bf16 v[200:203], v[56:59], v[152:155], v[200:203]
    v_lshrrev_b32 v142, 1, v131
    v_lshrrev_b32 v144, 1, v133
    v_mfma_f32_16x16x32_bf16 v[216:219], v[56:59], v[156:159], v[216:219]
    v_lshrrev_b32_e64 v146, 1, v4
    v_mfma_f32_16x16x32_bf16 v[232:235], v[56:59], v[160:163], v[232:235]
    v_mfma_f32_16x16x32_bf16 v[248:251], v[56:59], v[164:167], v[248:251]
    buffer_load_dwordx4 v[56:59], v4, s[16:19], s1 offen offset:2048 sc1
    s_waitcnt vmcnt(16)
    s_mov_b32 s88, 0
    v_lshl_add_u32 v2, v0, 4, s88
    v_mfma_f32_16x16x32_bf16 v[188:191], v[60:63], v[148:151], v[188:191]
    ds_read_b128 v[108:111], v2 offset:0
    buffer_load_dwordx4 v[96:99], v4, s[16:19], s3 offen offset:2048 sc1
    v_mfma_f32_16x16x32_bf16 v[204:207], v[60:63], v[152:155], v[204:207]
    ds_read_b128 v[112:115], v2 offset:8192
    v_mfma_f32_16x16x32_bf16 v[220:223], v[60:63], v[156:159], v[220:223]
    ds_read_b128 v[116:119], v2 offset:16384
    v_mfma_f32_16x16x32_bf16 v[236:239], v[60:63], v[160:163], v[236:239]
    ds_read_b128 v[120:123], v2 offset:24576
    v_mfma_f32_16x16x32_bf16 v[252:255], v[60:63], v[164:167], v[252:255]
    ds_read_b128 v[124:127], v2 offset:32768
    buffer_load_dwordx4 v[60:63], v4, s[16:19], s1 offen offset:3072 sc1
    s_waitcnt vmcnt(17)
    s_waitcnt lgkmcnt(0)
    v_mfma_f32_16x16x32_bf16 v[176:179], v[108:111], v[28:31], v[176:179]
    v_lshrrev_b32 v149, 4, v1
    v_xor_b32 v149, v149, v1
    v_mfma_f32_16x16x32_bf16 v[192:195], v[112:115], v[28:31], v[192:195]
    v_and_b32_e64 v149, 3, v149
    v_and_or_b32 v149, v1, 12, v149
    v_mfma_f32_16x16x32_bf16 v[208:211], v[116:119], v[28:31], v[208:211]
    s_mov_b32 s28, s52
    s_mov_b32 s29, s53
    s_mov_b32 s30, 1280
    s_mov_b32 s31, 0x20000
    s_cmp_ge_u32 s68, 4
    s_cbranch_scc1 L_rx61
    buffer_load_dwordx2 v[144:145], v144, s[12:15], s59 offen
L_rx61:
    v_and_b32_e64 v150, 3, v1
    v_lshl_add_u32 v149, v150, 4, v149
    v_mfma_f32_16x16x32_bf16 v[224:227], v[120:123], v[28:31], v[224:227]
    s_add_u32 s88, s83, 122880
    v_lshl_add_u32 v148, v149, 4, s88
    v_and_b32_e64 v164, 12, v134
    v_mfma_f32_16x16x32_bf16 v[240:243], v[124:127], v[28:31], v[240:243]
    v_and_b32_e64 v165, 48, v134
    v_lshl_add_u32 v165, v164, 4, v165
    s_lshl2_add_u32 s1, s85, s97
    buffer_load_dwordx4 v[28:31], v4, s[16:19], s1 offen sc1
    s_waitcnt vmcnt(16)
    v_mfma_f32_16x16x32_bf16 v[180:183], v[64:67], v[108:111], v[180:183]
    v_lshrrev_b32_e64 v166, 4, v135
    v_lshl_add_u32 v165, v166, 11, v165
    v_mfma_f32_16x16x32_bf16 v[196:199], v[64:67], v[112:115], v[196:199]
    buffer_load_dwordx2 v[140:141], v140, s[12:15], s59 offen
    s_lshr_b32 s88, s68, 1
    s_cmp_eq_u32 s88, 0
    s_cselect_b32 s88, 12, 0
    v_and_b32 v164, s88, v164
    v_xor_b32_e64 v164, v164, v135
    v_mfma_f32_16x16x32_bf16 v[212:215], v[64:67], v[116:119], v[212:215]
    v_and_or_b32 v164, v164, 12, v165
    s_lshr_b32 s88, s68, 1
    s_add_u32 s88, s88, 3
    s_and_b32 s88, s88, 3
    s_mul_i32 s88, s88, 40960
    v_lshl_add_u32 v128, v164, 2, s88
    v_mfma_f32_16x16x32_bf16 v[228:231], v[64:67], v[120:123], v[228:231]
    v_and_b32 v164, 12, v138
    v_and_b32_e64 v165, 48, v138
    v_mfma_f32_16x16x32_bf16 v[244:247], v[64:67], v[124:127], v[244:247]
    v_lshl_add_u32 v165, v164, 4, v165
    v_lshrrev_b32_e64 v166, 4, v139
    buffer_load_dwordx4 v[64:67], v4, s[16:19], s1 offen offset:1024 sc1
    s_waitcnt vmcnt(17)
    v_mfma_f32_16x16x32_bf16 v[184:187], v[168:171], v[108:111], v[184:187]
    buffer_load_dwordx2 v[142:143], v142, s[12:15], s59 offen
    v_lshl_add_u32 v165, v166, 11, v165
    s_lshr_b32 s88, s68, 0
    s_cmp_eq_u32 s88, 0
    s_cselect_b32 s88, 12, 0
    v_and_b32_e64 v164, s88, v164
    v_mfma_f32_16x16x32_bf16 v[200:203], v[168:171], v[112:115], v[200:203]
    v_xor_b32_e64 v164, v164, v139
    v_and_or_b32 v164, v164, 12, v165
    v_mfma_f32_16x16x32_bf16 v[216:219], v[168:171], v[116:119], v[216:219]
    s_lshr_b32 s88, s68, 0
    s_add_u32 s88, s88, 3
    s_and_b32 s88, s88, 3
    s_mul_i32 s88, s88, 40960
    v_lshl_add_u32 v132, v164, 2, s88
    v_add_u32 v130, 0x4000, v128
    v_mfma_f32_16x16x32_bf16 v[232:235], v[168:171], v[120:123], v[232:235]
    v_mfma_f32_16x16x32_bf16 v[248:251], v[168:171], v[124:127], v[248:251]
    buffer_load_dwordx2 v[146:147], v146, s[28:31], s60 offen
    buffer_load_dwordx4 v[168:171], v4, s[16:19], s1 offen offset:2048 sc1
    s_waitcnt vmcnt(18)
    v_mfma_f32_16x16x32_bf16 v[188:191], v[172:175], v[108:111], v[188:191]
    v_mfma_f32_16x16x32_bf16 v[204:207], v[172:175], v[112:115], v[204:207]
    v_mfma_f32_16x16x32_bf16 v[220:223], v[172:175], v[116:119], v[220:223]
    v_mfma_f32_16x16x32_bf16 v[236:239], v[172:175], v[120:123], v[236:239]
    buffer_load_dwordx4 v[160:163], v4, s[16:19], s61 offen sc1
    v_mfma_f32_16x16x32_bf16 v[252:255], v[172:175], v[124:127], v[252:255]
    buffer_load_dwordx4 v[172:175], v4, s[16:19], s1 offen offset:3072 sc1
    s_waitcnt vmcnt(19)
    v_mfma_f32_16x16x32_bf16 v[176:179], v[8:11], v[32:35], v[176:179]
    v_mfma_f32_16x16x32_bf16 v[192:195], v[12:15], v[32:35], v[192:195]
    v_mfma_f32_16x16x32_bf16 v[208:211], v[16:19], v[32:35], v[208:211]
    buffer_load_dwordx4 v[100:103], v4, s[16:19], s3 offen offset:3072 sc1
    v_mfma_f32_16x16x32_bf16 v[224:227], v[20:23], v[32:35], v[224:227]
    v_mfma_f32_16x16x32_bf16 v[240:243], v[24:27], v[32:35], v[240:243]
    s_waitcnt vmcnt(18)
    v_mfma_f32_16x16x32_bf16 v[180:183], v[36:39], v[8:11], v[180:183]
    v_mfma_f32_16x16x32_bf16 v[196:199], v[36:39], v[12:15], v[196:199]
    buffer_load_dwordx4 v[104:107], v5, s[16:19], s3 offen sc1
    v_mfma_f32_16x16x32_bf16 v[212:215], v[36:39], v[16:19], v[212:215]
    v_mfma_f32_16x16x32_bf16 v[228:231], v[36:39], v[20:23], v[228:231]
    v_mfma_f32_16x16x32_bf16 v[244:247], v[36:39], v[24:27], v[244:247]
    s_waitcnt vmcnt(18)
    v_mfma_f32_16x16x32_bf16 v[184:187], v[40:43], v[8:11], v[184:187]
    v_mfma_f32_16x16x32_bf16 v[200:203], v[40:43], v[12:15], v[200:203]
    v_mfma_f32_16x16x32_bf16 v[216:219], v[40:43], v[16:19], v[216:219]
    v_mfma_f32_16x16x32_bf16 v[232:235], v[40:43], v[20:23], v[232:235]
    v_mfma_f32_16x16x32_bf16 v[248:251], v[40:43], v[24:27], v[248:251]
    s_waitcnt vmcnt(16)
    v_mfma_f32_16x16x32_bf16 v[188:191], v[44:47], v[8:11], v[188:191]
    v_mfma_f32_16x16x32_bf16 v[204:207], v[44:47], v[12:15], v[204:207]
    v_mfma_f32_16x16x32_bf16 v[220:223], v[44:47], v[16:19], v[220:223]
    v_mfma_f32_16x16x32_bf16 v[236:239], v[44:47], v[20:23], v[236:239]
    v_mfma_f32_16x16x32_bf16 v[252:255], v[44:47], v[24:27], v[252:255]
    s_waitcnt vmcnt(15)
    v_mfma_f32_16x16x32_bf16 v[176:179], v[68:71], v[48:51], v[176:179]
    s_waitcnt vmcnt(3)
    v_lshlrev_b32_e64 v163, 16, v163
    v_mfma_f32_16x16x32_bf16 v[192:195], v[72:75], v[48:51], v[192:195]
    v_mul_f32 v160, 0xbede652a, v160
    s_lshl_b32 s59, s59, 1
    v_mfma_f32_16x16x32_bf16 v[208:211], v[76:79], v[48:51], v[208:211]
    ds_bpermute_b32 v108, v135, v146
    ds_bpermute_b32 v109, v135, v147
    v_mfma_f32_16x16x32_bf16 v[224:227], v[80:83], v[48:51], v[224:227]
    ds_bpermute_b32 v110, v134, v160
    ds_bpermute_b32 v111, v134, v163
    v_mfma_f32_16x16x32_bf16 v[240:243], v[84:87], v[48:51], v[240:243]
    ds_bpermute_b32 v112, v137, v146
    ds_bpermute_b32 v113, v137, v147
    v_mfma_f32_16x16x32_bf16 v[180:183], v[52:55], v[68:71], v[180:183]
    ds_bpermute_b32 v114, v136, v160
    ds_bpermute_b32 v115, v136, v163
    v_mfma_f32_16x16x32_bf16 v[196:199], v[52:55], v[72:75], v[196:199]
    ds_bpermute_b32 v116, v139, v146
    ds_bpermute_b32 v117, v139, v147
    v_mfma_f32_16x16x32_bf16 v[212:215], v[52:55], v[76:79], v[212:215]
    ds_bpermute_b32 v118, v138, v160
    ds_bpermute_b32 v119, v138, v163
    v_mfma_f32_16x16x32_bf16 v[228:231], v[52:55], v[80:83], v[228:231]
    v_mfma_f32_16x16x32_bf16 v[244:247], v[52:55], v[84:87], v[244:247]
    s_waitcnt lgkmcnt(0)
    v_lshlrev_b32_e64 v8, 16, v140
    v_mfma_f32_16x16x32_bf16 v[184:187], v[56:59], v[68:71], v[184:187]
    v_and_b32 v9, 0xffff0000, v140
    v_lshlrev_b32_e64 v20, 16, v108
    v_mfma_f32_16x16x32_bf16 v[200:203], v[56:59], v[72:75], v[200:203]
    v_and_b32 v21, 0xffff0000, v108
    v_lshlrev_b32_e64 v10, 16, v141
    v_mfma_f32_16x16x32_bf16 v[216:219], v[56:59], v[76:79], v[216:219]
    v_and_b32 v11, 0xffff0000, v141
    v_lshlrev_b32_e64 v22, 16, v109
    v_mfma_f32_16x16x32_bf16 v[232:235], v[56:59], v[80:83], v[232:235]
    v_and_b32 v23, 0xffff0000, v109
    v_add_f32_e64 v24, v8, v111
    v_mfma_f32_16x16x32_bf16 v[248:251], v[56:59], v[84:87], v[248:251]
    v_mul_f32 v20, v20, v110
    v_add_f32 v25, v9, v111
    v_mfma_f32_16x16x32_bf16 v[188:191], v[60:63], v[68:71], v[188:191]
    v_mul_f32 v21, v21, v110
    v_add_f32 v26, v10, v111
    v_mfma_f32_16x16x32_bf16 v[204:207], v[60:63], v[72:75], v[204:207]
    v_mul_f32 v22, v22, v110
    v_add_f32 v27, v11, v111
    v_mfma_f32_16x16x32_bf16 v[220:223], v[60:63], v[76:79], v[220:223]
    v_mul_f32 v23, v23, v110
    v_fmac_f32 v8, v24, v20
    v_mfma_f32_16x16x32_bf16 v[236:239], v[60:63], v[80:83], v[236:239]
    v_fmac_f32 v9, v25, v21
    v_fmac_f32 v10, v26, v22
    v_mfma_f32_16x16x32_bf16 v[252:255], v[60:63], v[84:87], v[252:255]
    v_fmac_f32 v11, v27, v23
    v_lshlrev_b32_e64 v12, 16, v142
    s_waitcnt vmcnt(0)
    v_mfma_f32_16x16x32_bf16 v[176:179], v[88:91], v[28:31], v[176:179]
    v_and_b32 v13, 0xffff0000, v142
    v_lshlrev_b32_e64 v20, 16, v112
    v_and_b32 v21, 0xffff0000, v112
    v_mfma_f32_16x16x32_bf16 v[192:195], v[92:95], v[28:31], v[192:195]
    v_lshlrev_b32_e64 v14, 16, v143
    v_and_b32 v15, 0xffff0000, v143
    v_lshlrev_b32_e64 v22, 16, v113
    v_mfma_f32_16x16x32_bf16 v[208:211], v[96:99], v[28:31], v[208:211]
    v_and_b32 v23, 0xffff0000, v113
    v_add_f32 v24, v12, v115
    v_mul_f32 v20, v20, v114
    v_mfma_f32_16x16x32_bf16 v[224:227], v[100:103], v[28:31], v[224:227]
    v_add_f32 v25, v13, v115
    v_mul_f32 v21, v21, v114
    v_add_f32_e64 v26, v14, v115
    v_mfma_f32_16x16x32_bf16 v[240:243], v[104:107], v[28:31], v[240:243]
    v_mul_f32 v22, v22, v114
    v_add_f32 v27, v15, v115
    v_mul_f32_e64 v23, v23, v114
    v_mfma_f32_16x16x32_bf16 v[180:183], v[64:67], v[88:91], v[180:183]
    ds_write_b128 v148, v[176:179] offset:0
    v_fmac_f32 v12, v24, v20
    v_fmac_f32 v13, v25, v21
    v_fmac_f32_e64 v14, v26, v22
    v_mfma_f32_16x16x32_bf16 v[196:199], v[64:67], v[92:95], v[196:199]
    ds_write_b128 v148, v[192:195] offset:8192
    v_fmac_f32 v15, v27, v23
    v_lshlrev_b32 v16, 16, v144
    v_and_b32 v17, 0xffff0000, v144
    v_mfma_f32_16x16x32_bf16 v[212:215], v[64:67], v[96:99], v[212:215]
    ds_write_b128 v148, v[208:211] offset:16384
    v_lshlrev_b32_e64 v20, 16, v116
    v_and_b32 v21, 0xffff0000, v116
    v_lshlrev_b32_e64 v18, 16, v145
    v_mfma_f32_16x16x32_bf16 v[228:231], v[64:67], v[100:103], v[228:231]
    ds_write_b128 v148, v[224:227] offset:24576
    v_and_b32 v19, 0xffff0000, v145
    v_lshlrev_b32_e64 v22, 16, v117
    v_and_b32 v23, 0xffff0000, v117
    v_mfma_f32_16x16x32_bf16 v[244:247], v[64:67], v[104:107], v[244:247]
    ds_write_b128 v148, v[240:243] offset:32768
    v_add_f32 v24, v16, v119
    v_mul_f32 v20, v20, v118
    v_add_f32 v25, v17, v119
    s_add_u32 m0, s83, 0
    v_mfma_f32_16x16x32_bf16 v[184:187], v[168:171], v[88:91], v[184:187]
    ds_write_addtid_b32 v180 offset:0
    ds_write_addtid_b32 v181 offset:256
    ds_write_addtid_b32 v182 offset:512
    ds_write_addtid_b32 v183 offset:768
    v_mfma_f32_16x16x32_bf16 v[200:203], v[168:171], v[92:95], v[200:203]
    ds_write_addtid_b32 v196 offset:8192
    ds_write_addtid_b32 v197 offset:8448
    ds_write_addtid_b32 v198 offset:8704
    ds_write_addtid_b32 v199 offset:8960
    v_mfma_f32_16x16x32_bf16 v[216:219], v[168:171], v[96:99], v[216:219]
    ds_write_addtid_b32 v212 offset:16384
    ds_write_addtid_b32 v213 offset:16640
    ds_write_addtid_b32 v214 offset:16896
    ds_write_addtid_b32 v215 offset:17152
    v_mfma_f32_16x16x32_bf16 v[232:235], v[168:171], v[100:103], v[232:235]
    ds_write_addtid_b32 v228 offset:24576
    ds_write_addtid_b32 v229 offset:24832
    ds_write_addtid_b32 v230 offset:25088
    ds_write_addtid_b32 v231 offset:25344
    v_mfma_f32_16x16x32_bf16 v[248:251], v[168:171], v[104:107], v[248:251]
    ds_write_addtid_b32 v244 offset:32768
    ds_write_addtid_b32 v245 offset:33024
    ds_write_addtid_b32 v246 offset:33280
    ds_write_addtid_b32 v247 offset:33536
    s_add_u32 m0, s83, 40960
    v_mfma_f32_16x16x32_bf16 v[188:191], v[172:175], v[88:91], v[188:191]
    ds_write_addtid_b32 v184 offset:0
    ds_write_addtid_b32 v185 offset:256
    ds_write_addtid_b32 v186 offset:512
    ds_write_addtid_b32 v187 offset:768
    v_mfma_f32_16x16x32_bf16 v[204:207], v[172:175], v[92:95], v[204:207]
    ds_write_addtid_b32 v200 offset:8192
    ds_write_addtid_b32 v201 offset:8448
    ds_write_addtid_b32 v202 offset:8704
    ds_write_addtid_b32 v203 offset:8960
    v_mfma_f32_16x16x32_bf16 v[220:223], v[172:175], v[96:99], v[220:223]
    ds_write_addtid_b32 v216 offset:16384
    ds_write_addtid_b32 v217 offset:16640
    ds_write_addtid_b32 v218 offset:16896
    ds_write_addtid_b32 v219 offset:17152
    v_mfma_f32_16x16x32_bf16 v[236:239], v[172:175], v[100:103], v[236:239]
    ds_write_addtid_b32 v232 offset:24576
    ds_write_addtid_b32 v233 offset:24832
    ds_write_addtid_b32 v234 offset:25088
    ds_write_addtid_b32 v235 offset:25344
    v_mfma_f32_16x16x32_bf16 v[252:255], v[172:175], v[104:107], v[252:255]
    ds_write_addtid_b32 v248 offset:32768
    ds_write_addtid_b32 v249 offset:33024
    ds_write_addtid_b32 v250 offset:33280
    ds_write_addtid_b32 v251 offset:33536
L_red:
    s_add_u32 m0, s83, 57344
    s_nop 0
    ds_write_addtid_b32 v188 offset:24576
    ds_write_addtid_b32 v189 offset:24832
    ds_write_addtid_b32 v190 offset:25088
    ds_write_addtid_b32 v191 offset:25344
    ds_write_addtid_b32 v204 offset:32768
    ds_write_addtid_b32 v205 offset:33024
    ds_write_addtid_b32 v206 offset:33280
    ds_write_addtid_b32 v207 offset:33536
    ds_write_addtid_b32 v220 offset:40960
    ds_write_addtid_b32 v221 offset:41216
    ds_write_addtid_b32 v222 offset:41472
    ds_write_addtid_b32 v223 offset:41728
    ds_write_addtid_b32 v236 offset:49152
    ds_write_addtid_b32 v237 offset:49408
    ds_write_addtid_b32 v238 offset:49664
    ds_write_addtid_b32 v239 offset:49920
    ds_write_addtid_b32 v252 offset:57344
    ds_write_addtid_b32 v253 offset:57600
    ds_write_addtid_b32 v254 offset:57856
    ds_write_addtid_b32 v255 offset:58112
    v_mul_f32 v21, v21, v118
    v_add_f32 v26, v18, v119
    v_mul_f32 v22, v22, v118
    v_add_f32 v27, v19, v119
    v_mul_f32 v23, v23, v118
    v_fmac_f32 v16, v24, v20
    v_fmac_f32 v17, v25, v21
    v_fmac_f32 v18, v26, v22
    v_fmac_f32 v19, v27, v23
    s_waitcnt lgkmcnt(0)
    s_barrier
    ds_read_b128 v[176:179], v128 offset:0
    ds_read_b128 v[180:183], v128 offset:1024
    ds_read_b128 v[184:187], v128 offset:2048
    ds_read_b128 v[188:191], v128 offset:3072
    ds_read_b128 v[192:195], v128 offset:4096
    ds_read_b128 v[196:199], v128 offset:5120
    ds_read_b128 v[200:203], v128 offset:6144
    ds_read_b128 v[204:207], v128 offset:7168
    ds_read_b128 v[208:211], v130 offset:0
    ds_read_b128 v[212:215], v130 offset:1024
    ds_read_b128 v[216:219], v130 offset:2048
    ds_read_b128 v[220:223], v130 offset:3072
    ds_read_b128 v[224:227], v130 offset:4096
    ds_read_b128 v[228:231], v130 offset:5120
    ds_read_b128 v[232:235], v130 offset:6144
    s_waitcnt lgkmcnt(7)
    s_nop 0
    ds_read_b128 v[236:239], v130 offset:7168
    v_pk_add_f32 v[176:177], v[176:177], v[180:181]
    v_pk_add_f32 v[178:179], v[178:179], v[182:183]
    v_pk_add_f32 v[184:185], v[184:185], v[188:189]
    v_pk_add_f32 v[186:187], v[186:187], v[190:191]
    v_pk_add_f32 v[192:193], v[192:193], v[196:197]
    v_pk_add_f32 v[194:195], v[194:195], v[198:199]
    v_pk_add_f32 v[200:201], v[200:201], v[204:205]
    v_pk_add_f32 v[202:203], v[202:203], v[206:207]
    v_pk_add_f32 v[176:177], v[176:177], v[184:185]
    v_pk_add_f32 v[178:179], v[178:179], v[186:187]
    v_pk_add_f32 v[192:193], v[192:193], v[200:201]
    v_pk_add_f32 v[194:195], v[194:195], v[202:203]
    v_pk_add_f32 v[176:177], v[176:177], v[192:193]
    v_pk_add_f32 v[178:179], v[178:179], v[194:195]
    v_pk_add_f32 v[176:177], v[176:177], v[8:9]
    v_pk_add_f32 v[178:179], v[178:179], v[10:11]
    buffer_store_dwordx4 v[176:179], v129, s[32:35], s59 offen sc1
    s_waitcnt lgkmcnt(0)
    s_cmp_ge_u32 s68, 4
    s_cbranch_scc1 L_f1
    s_nop 0
    ds_read_b128 v[68:71], v132 offset:0
    ds_read_b128 v[72:75], v132 offset:1024
    ds_read_b128 v[76:79], v132 offset:2048
    ds_read_b128 v[80:83], v132 offset:3072
    ds_read_b128 v[84:87], v132 offset:4096
    ds_read_b128 v[88:91], v132 offset:5120
    ds_read_b128 v[92:95], v132 offset:6144
    ds_read_b128 v[96:99], v132 offset:7168
L_f1:
    v_pk_add_f32 v[208:209], v[208:209], v[212:213]
    v_pk_add_f32 v[210:211], v[210:211], v[214:215]
    v_pk_add_f32 v[216:217], v[216:217], v[220:221]
    v_pk_add_f32 v[218:219], v[218:219], v[222:223]
    v_pk_add_f32 v[224:225], v[224:225], v[228:229]
    v_pk_add_f32 v[226:227], v[226:227], v[230:231]
    v_pk_add_f32 v[232:233], v[232:233], v[236:237]
    v_pk_add_f32 v[234:235], v[234:235], v[238:239]
    v_pk_add_f32 v[208:209], v[208:209], v[216:217]
    v_pk_add_f32 v[210:211], v[210:211], v[218:219]
    v_pk_add_f32 v[224:225], v[224:225], v[232:233]
    v_pk_add_f32 v[226:227], v[226:227], v[234:235]
    v_pk_add_f32 v[208:209], v[208:209], v[224:225]
    v_pk_add_f32 v[210:211], v[210:211], v[226:227]
    v_pk_add_f32 v[208:209], v[208:209], v[12:13]
    v_pk_add_f32 v[210:211], v[210:211], v[14:15]
    buffer_store_dwordx4 v[208:211], v131, s[32:35], s59 offen sc1
    s_cbranch_scc1 L_f2
    s_waitcnt lgkmcnt(0)
    v_pk_add_f32 v[68:69], v[68:69], v[72:73]
    v_pk_add_f32 v[70:71], v[70:71], v[74:75]
    v_pk_add_f32 v[76:77], v[76:77], v[80:81]
    v_pk_add_f32 v[78:79], v[78:79], v[82:83]
    v_pk_add_f32 v[84:85], v[84:85], v[88:89]
    v_pk_add_f32 v[86:87], v[86:87], v[90:91]
    v_pk_add_f32 v[92:93], v[92:93], v[96:97]
    v_pk_add_f32 v[94:95], v[94:95], v[98:99]
    v_pk_add_f32 v[68:69], v[68:69], v[76:77]
    v_pk_add_f32 v[70:71], v[70:71], v[78:79]
    v_pk_add_f32 v[84:85], v[84:85], v[92:93]
    v_pk_add_f32 v[86:87], v[86:87], v[94:95]
    v_pk_add_f32 v[68:69], v[68:69], v[84:85]
    v_pk_add_f32 v[70:71], v[70:71], v[86:87]
    v_pk_add_f32 v[68:69], v[68:69], v[16:17]
    v_pk_add_f32 v[70:71], v[70:71], v[18:19]
    buffer_store_dwordx4 v[68:71], v133, s[32:35], s59 offen sc1
L_f2:
L_end:
    s_endpgm
L_code_end:
.section .rodata,"a"
.p2align 6
.amdhsa_kernel parallel_sum__ssm_conv_s5__geglu_ffn__prompt_kernel
  .amdhsa_next_free_vgpr 256
  .amdhsa_next_free_sgpr 102
  .amdhsa_accum_offset 256
  .amdhsa_group_segment_fixed_size 0
  .amdhsa_kernarg_size 128
  .amdhsa_user_sgpr_count 2
  .amdhsa_user_sgpr_kernarg_segment_ptr 1
  .amdhsa_system_sgpr_workgroup_id_x 1
  .amdhsa_float_denorm_mode_32 3
.end_amdhsa_kernel
```
